```python
import torch

def _softmax(x, axis=-1):
    return torch.softmax(x, dim=axis)
def _gelu(x):
    return torch.nn.functional.gelu(x, approximate="tanh")
def _silu(x):
    return torch.nn.functional.silu(x)
def _sigmoid(x):
    return torch.sigmoid(x)
def _layernorm(x, axis=-1, eps=1e-5):
    m = x.mean(dim=axis, keepdim=True)
    v = x.var(dim=axis, keepdim=True, unbiased=False)
    return (x - m) / torch.sqrt(v + eps)
def _scatter_add(tgt, idx, src, axis=0):
    return tgt.clone().index_add_(axis, idx, src)
def _segment_sum(src, seg, n):
    out = torch.zeros((n,) + src.shape[1:], dtype=src.dtype)
    return out.index_add_(0, seg, src)
def _pad(x, pw):
    flat = tuple(v for pair in reversed(pw) for v in pair)
    return torch.nn.functional.pad(x, flat)

kernel_name = 'gated_mix__ssm_conv_s5__dense_activation_mish__prompt'

def setup_inputs():

    _w = (lambda a: (lambda t: t.to(torch.bfloat16) if t.is_floating_point() else t)(torch.as_tensor(a)))
    def _A_setup():
        B, S, D = 1, 2048, 640
        P = D
        Lambda_re = -0.5 * (lambda _x: torch.exp(torch.as_tensor(_x)))((lambda *s: torch.randn(*s, dtype=torch.bfloat16) * 0.2)(P))
        Lambda_im = (lambda *s: torch.randn(*s, dtype=torch.bfloat16) * 0.2)(P) * 1.0
        B_re = (lambda *s: torch.randn(*s, dtype=torch.bfloat16) * 0.2)(P, D) * (D ** -0.5)
        B_im = (lambda *s: torch.randn(*s, dtype=torch.bfloat16) * 0.2)(P, D) * (D ** -0.5)
        C_re = (lambda *s: torch.randn(*s, dtype=torch.bfloat16) * 0.2)(D, P) * (P ** -0.5)
        C_im = (lambda *s: torch.randn(*s, dtype=torch.bfloat16) * 0.2)(D, P) * (P ** -0.5)
        log_dt = (lambda *s: torch.randn(*s, dtype=torch.bfloat16) * 0.2)(P) * 0.3 - 2.0
        Dskip = (lambda *s: torch.randn(*s, dtype=torch.bfloat16) * 0.05)(D)
        return {
            "x": _w((lambda *s: torch.randn(*s, dtype=torch.bfloat16) * 0.05)(B, S, D)),
            "Lambda_re": _w(Lambda_re),
            "Lambda_im": _w(Lambda_im),
            "B_re": _w(B_re),
            "B_im": _w(B_im),
            "C_re": _w(C_re),
            "C_im": _w(C_im),
            "log_dt": _w(log_dt),
            "Dskip": _w(Dskip),
        }
    _A_in = _A_setup()

    def _B_setup():
        B, S, D, F = 1, 2048, 640, 1536
        return {
            "x": _w((lambda *s: torch.randn(*s, dtype=torch.bfloat16) * 0.05)(B, S, D)),
            "w1": _w((lambda *s: torch.randn(*s, dtype=torch.bfloat16) * 3.2)(D, F) * (D ** -0.5)),
            "b1": _w((lambda *s: torch.randn(*s, dtype=torch.bfloat16) * 0.05)(F)),
            "w2": _w((lambda *s: torch.randn(*s, dtype=torch.bfloat16) * 0.05)(F, D) * (F ** -0.5)),
        }
    _B_in = _B_setup()

    return {
        "A_x": _A_in["x"],
        "A_Lambda_re": _A_in["Lambda_re"],
        "A_Lambda_im": _A_in["Lambda_im"],
        "A_B_re": _A_in["B_re"],
        "A_B_im": _A_in["B_im"],
        "A_C_re": _A_in["C_re"],
        "A_C_im": _A_in["C_im"],
        "A_log_dt": _A_in["log_dt"],
        "A_Dskip": _A_in["Dskip"],
        "B_x": _B_in["x"],
        "B_w1": _B_in["w1"],
        "B_b1": _B_in["b1"],
        "B_w2": _B_in["w2"],
        "gate_w": _w((lambda *s: torch.randn(*s, dtype=torch.bfloat16) * 0.05)(640) * 16.0),
    }

def reference(A_x, A_Lambda_re, A_Lambda_im, A_B_re, A_B_im, A_C_re, A_C_im, A_log_dt, A_Dskip, B_x, B_w1, B_b1, B_w2, gate_w):
    def _A_ref(x, Lambda_re, Lambda_im, B_re, B_im, C_re, C_im, log_dt, Dskip):
        Bsz, L, H = x.shape
        Lam = Lambda_re + 1j * Lambda_im
        Bmat = B_re + 1j * B_im
        Cmat = C_re + 1j * C_im
        dt = torch.exp(log_dt)
        Lam_bar = torch.exp(dt * Lam)
        B_bar = ((Lam_bar - 1.0) / Lam)[:, None] * Bmat
        Bu = torch.einsum("bld,pd->blp", x + 0j, B_bar)
        h = torch.zeros_like(Bu[:, 0, :])
        hs = []
        for t in range(L):
            h = Lam_bar[None, :] * h + Bu[:, t, :]
            hs.append(h)
        hseq = torch.stack(hs, 1)
        y = 2.0 * torch.einsum("blp,dp->bld", hseq, Cmat).real + x * Dskip[None, None, :]
        return y

    def _B_ref(x, w1, b1, w2):
        h = torch.einsum("bsd,df->bsf", x, w1) + b1
        sp = torch.log1p(torch.exp(-torch.abs(h))) + torch.where(h > 0, h, torch.zeros_like(h))
        act = h * torch.tanh(sp)
        return torch.einsum("bsf,fd->bsd", act, w2)

    x = A_x
    g = _sigmoid((x * gate_w).sum(-1, keepdims=True))
    a = _A_ref(x, A_Lambda_re, A_Lambda_im, A_B_re, A_B_im, A_C_re, A_C_im, A_log_dt, A_Dskip)
    b = _B_ref(x, B_w1, B_b1, B_w2)
    return g * a + (1 - g) * b
```

```asm
; @launch kernel=k1_kernel grid=(256,1,1) block=(512,1,1) lds=163840
; @launch kernel=k3_kernel grid=(256,1,1) block=(256,1,1) lds=81920
.amdgcn_target "amdgcn-amd-amdhsa--gfx950"
.text
.globl k1_kernel
.type k1_kernel,@function
.globl k3_kernel
.type k3_kernel,@function
.p2align 8
k1_kernel:
    s_cmp_ge_u32 s2, 256
    s_cbranch_scc1 K1_END
    s_load_dwordx16 s[64:79], s[0:1], 0
    s_load_dwordx16 s[80:95], s[0:1], 64
    s_load_dwordx2 s[96:97], s[0:1], 128
    v_lshrrev_b32 v2, 6, v0
    v_and_b32 v1, 63, v0
    v_readfirstlane_b32 s52, v2
    s_and_b32 s3, s52, 3
    s_and_b32 s44, s2, 3
    s_lshl_b32 s44, s44, 2
    s_bfe_u32 s46, s2, 0x10002
    s_lshr_b32 s45, s2, 3
    s_and_b32 s43, s45, 3
    s_add_u32 s24, s44, s43
    s_lshr_b32 s43, s45, 2
    s_lshl_b32 s28, s3, 12
    s_lshl_b32 s29, s3, 13
    v_lshrrev_b32 v72, 5, v1
    s_waitcnt lgkmcnt(0)
    s_mov_b32 s8, s64
    s_and_b32 s9, s65, 0xffff
    s_mov_b32 s10, 2621440
    s_mov_b32 s11, 0x00020000
    s_mov_b32 s20, s96
    s_and_b32 s21, s97, 0xffff
    s_mov_b32 s22, 67108864
    s_mov_b32 s23, 0x00020000
    s_cmp_ge_u32 s43, 5
    s_cbranch_scc1 K1_ISMLP
    s_mul_i32 s25, s46, 5
    s_add_u32 s25, s25, s43
    s_cmp_lt_u32 s52, 4
    s_cbranch_scc1 K1_U
    v_lshrrev_b32 v2, 3, v1
    v_lshrrev_b32 v3, 4, v1
    v_and_b32 v20, 7, v1
    v_xor_b32 v21, v20, v3
    v_xor_b32 v22, 4, v21
    v_lshlrev_b32 v21, 4, v21
    v_lshlrev_b32 v22, 4, v22
    v_and_b32 v74, 3, v2
    v_lshl_add_u32 v74, v72, 5, v74
    s_movk_i32 s30, 1280
    v_mul_lo_u32 v74, v74, s30
    v_add_u32 v4, v74, v21
    v_add_u32 v5, v74, v22
    v_mul_lo_u32 v74, v2, s30
    v_add_u32 v6, v74, v21
    v_add_u32 v7, v74, v22
    s_lshl_b32 s26, s24, 7
    s_lshr_b32 s30, s3, 1
    s_lshl_b32 s30, s30, 6
    s_add_u32 s26, s26, s30
    s_and_b32 s30, s3, 1
    s_lshl_b32 s31, s30, 4
    s_add_u32 s26, s26, s31
    s_mul_i32 s26, s26, 1280
    s_lshl_b32 s27, s25, 6
    s_lshr_b32 s31, s3, 1
    s_lshl_b32 s31, s31, 5
    s_add_u32 s27, s27, s31
    s_mul_i32 s27, s27, 1280
    s_cmp_eq_u32 s30, 0
    s_cselect_b32 s12, s70, s72
    s_cselect_b32 s13, s71, s73
    s_and_b32 s13, s13, 0xffff
    s_mov_b32 s14, 819200
    s_mov_b32 s15, 0x00020000
    s_add_u32 m0, s28, 16384
    s_add_u32 s30, s26, 0
    buffer_load_dwordx4 v4, s[8:11], s30 offen lds
    s_add_u32 m0, s28, 17408
    s_add_u32 s30, s26, 5120
    buffer_load_dwordx4 v5, s[8:11], s30 offen lds
    s_add_u32 m0, s28, 18432
    s_add_u32 s30, s26, 10240
    buffer_load_dwordx4 v4, s[8:11], s30 offen lds
    s_add_u32 m0, s28, 19456
    s_add_u32 s30, s26, 15360
    buffer_load_dwordx4 v5, s[8:11], s30 offen lds
    s_add_u32 m0, s28, 65536
    s_add_u32 s30, s27, 0
    buffer_load_dwordx4 v6, s[12:15], s30 offen lds
    s_add_u32 m0, s28, 66560
    s_add_u32 s30, s27, 10240
    buffer_load_dwordx4 v7, s[12:15], s30 offen lds
    s_add_u32 m0, s28, 67584
    s_add_u32 s30, s27, 20480
    buffer_load_dwordx4 v6, s[12:15], s30 offen lds
    s_add_u32 m0, s28, 68608
    s_add_u32 s30, s27, 30720
    buffer_load_dwordx4 v7, s[12:15], s30 offen lds
    s_add_u32 m0, s28, 32768
    s_add_u32 s30, s26, 128
    buffer_load_dwordx4 v4, s[8:11], s30 offen lds
    s_add_u32 m0, s28, 33792
    s_add_u32 s30, s26, 5248
    buffer_load_dwordx4 v5, s[8:11], s30 offen lds
    s_add_u32 m0, s28, 34816
    s_add_u32 s30, s26, 10368
    buffer_load_dwordx4 v4, s[8:11], s30 offen lds
    s_add_u32 m0, s28, 35840
    s_add_u32 s30, s26, 15488
    buffer_load_dwordx4 v5, s[8:11], s30 offen lds
    s_add_u32 m0, s28, 98304
    s_add_u32 s30, s27, 128
    buffer_load_dwordx4 v6, s[12:15], s30 offen lds
    s_add_u32 m0, s28, 99328
    s_add_u32 s30, s27, 10368
    buffer_load_dwordx4 v7, s[12:15], s30 offen lds
    s_add_u32 m0, s28, 100352
    s_add_u32 s30, s27, 20608
    buffer_load_dwordx4 v6, s[12:15], s30 offen lds
    s_add_u32 m0, s28, 101376
    s_add_u32 s30, s27, 30848
    buffer_load_dwordx4 v7, s[12:15], s30 offen lds
    s_waitcnt vmcnt(8)
    s_barrier
    s_add_u32 m0, s28, 49152
    s_add_u32 s30, s26, 256
    buffer_load_dwordx4 v4, s[8:11], s30 offen lds
    s_add_u32 m0, s28, 50176
    s_add_u32 s30, s26, 5376
    buffer_load_dwordx4 v5, s[8:11], s30 offen lds
    s_add_u32 m0, s28, 51200
    s_add_u32 s30, s26, 10496
    buffer_load_dwordx4 v4, s[8:11], s30 offen lds
    s_add_u32 m0, s28, 52224
    s_add_u32 s30, s26, 15616
    buffer_load_dwordx4 v5, s[8:11], s30 offen lds
    s_add_u32 m0, s28, 131072
    s_add_u32 s30, s27, 256
    buffer_load_dwordx4 v6, s[12:15], s30 offen lds
    s_add_u32 m0, s28, 132096
    s_add_u32 s30, s27, 10496
    buffer_load_dwordx4 v7, s[12:15], s30 offen lds
    s_add_u32 m0, s28, 133120
    s_add_u32 s30, s27, 20736
    buffer_load_dwordx4 v6, s[12:15], s30 offen lds
    s_add_u32 m0, s28, 134144
    s_add_u32 s30, s27, 30976
    buffer_load_dwordx4 v7, s[12:15], s30 offen lds
    s_waitcnt vmcnt(8)
    s_barrier
    s_add_u32 m0, s28, 16384
    s_add_u32 s30, s26, 384
    buffer_load_dwordx4 v4, s[8:11], s30 offen lds
    s_add_u32 m0, s28, 17408
    s_add_u32 s30, s26, 5504
    buffer_load_dwordx4 v5, s[8:11], s30 offen lds
    s_add_u32 m0, s28, 18432
    s_add_u32 s30, s26, 10624
    buffer_load_dwordx4 v4, s[8:11], s30 offen lds
    s_add_u32 m0, s28, 19456
    s_add_u32 s30, s26, 15744
    buffer_load_dwordx4 v5, s[8:11], s30 offen lds
    s_add_u32 m0, s28, 65536
    s_add_u32 s30, s27, 384
    buffer_load_dwordx4 v6, s[12:15], s30 offen lds
    s_add_u32 m0, s28, 66560
    s_add_u32 s30, s27, 10624
    buffer_load_dwordx4 v7, s[12:15], s30 offen lds
    s_add_u32 m0, s28, 67584
    s_add_u32 s30, s27, 20864
    buffer_load_dwordx4 v6, s[12:15], s30 offen lds
    s_add_u32 m0, s28, 68608
    s_add_u32 s30, s27, 31104
    buffer_load_dwordx4 v7, s[12:15], s30 offen lds
    s_waitcnt vmcnt(8)
    s_barrier
    s_add_u32 m0, s28, 32768
    s_add_u32 s30, s26, 512
    buffer_load_dwordx4 v4, s[8:11], s30 offen lds
    s_add_u32 m0, s28, 33792
    s_add_u32 s30, s26, 5632
    buffer_load_dwordx4 v5, s[8:11], s30 offen lds
    s_add_u32 m0, s28, 34816
    s_add_u32 s30, s26, 10752
    buffer_load_dwordx4 v4, s[8:11], s30 offen lds
    s_add_u32 m0, s28, 35840
    s_add_u32 s30, s26, 15872
    buffer_load_dwordx4 v5, s[8:11], s30 offen lds
    s_add_u32 m0, s28, 98304
    s_add_u32 s30, s27, 512
    buffer_load_dwordx4 v6, s[12:15], s30 offen lds
    s_add_u32 m0, s28, 99328
    s_add_u32 s30, s27, 10752
    buffer_load_dwordx4 v7, s[12:15], s30 offen lds
    s_add_u32 m0, s28, 100352
    s_add_u32 s30, s27, 20992
    buffer_load_dwordx4 v6, s[12:15], s30 offen lds
    s_add_u32 m0, s28, 101376
    s_add_u32 s30, s27, 31232
    buffer_load_dwordx4 v7, s[12:15], s30 offen lds
    s_waitcnt vmcnt(8)
    s_barrier
    s_add_u32 m0, s28, 49152
    s_add_u32 s30, s26, 640
    buffer_load_dwordx4 v4, s[8:11], s30 offen lds
    s_add_u32 m0, s28, 50176
    s_add_u32 s30, s26, 5760
    buffer_load_dwordx4 v5, s[8:11], s30 offen lds
    s_add_u32 m0, s28, 51200
    s_add_u32 s30, s26, 10880
    buffer_load_dwordx4 v4, s[8:11], s30 offen lds
    s_add_u32 m0, s28, 52224
    s_add_u32 s30, s26, 16000
    buffer_load_dwordx4 v5, s[8:11], s30 offen lds
    s_add_u32 m0, s28, 131072
    s_add_u32 s30, s27, 640
    buffer_load_dwordx4 v6, s[12:15], s30 offen lds
    s_add_u32 m0, s28, 132096
    s_add_u32 s30, s27, 10880
    buffer_load_dwordx4 v7, s[12:15], s30 offen lds
    s_add_u32 m0, s28, 133120
    s_add_u32 s30, s27, 21120
    buffer_load_dwordx4 v6, s[12:15], s30 offen lds
    s_add_u32 m0, s28, 134144
    s_add_u32 s30, s27, 31360
    buffer_load_dwordx4 v7, s[12:15], s30 offen lds
    s_waitcnt vmcnt(8)
    s_barrier
    s_add_u32 m0, s28, 16384
    s_add_u32 s30, s26, 768
    buffer_load_dwordx4 v4, s[8:11], s30 offen lds
    s_add_u32 m0, s28, 17408
    s_add_u32 s30, s26, 5888
    buffer_load_dwordx4 v5, s[8:11], s30 offen lds
    s_add_u32 m0, s28, 18432
    s_add_u32 s30, s26, 11008
    buffer_load_dwordx4 v4, s[8:11], s30 offen lds
    s_add_u32 m0, s28, 19456
    s_add_u32 s30, s26, 16128
    buffer_load_dwordx4 v5, s[8:11], s30 offen lds
    s_add_u32 m0, s28, 65536
    s_add_u32 s30, s27, 768
    buffer_load_dwordx4 v6, s[12:15], s30 offen lds
    s_add_u32 m0, s28, 66560
    s_add_u32 s30, s27, 11008
    buffer_load_dwordx4 v7, s[12:15], s30 offen lds
    s_add_u32 m0, s28, 67584
    s_add_u32 s30, s27, 21248
    buffer_load_dwordx4 v6, s[12:15], s30 offen lds
    s_add_u32 m0, s28, 68608
    s_add_u32 s30, s27, 31488
    buffer_load_dwordx4 v7, s[12:15], s30 offen lds
    s_waitcnt vmcnt(8)
    s_barrier
    s_add_u32 m0, s28, 32768
    s_add_u32 s30, s26, 896
    buffer_load_dwordx4 v4, s[8:11], s30 offen lds
    s_add_u32 m0, s28, 33792
    s_add_u32 s30, s26, 6016
    buffer_load_dwordx4 v5, s[8:11], s30 offen lds
    s_add_u32 m0, s28, 34816
    s_add_u32 s30, s26, 11136
    buffer_load_dwordx4 v4, s[8:11], s30 offen lds
    s_add_u32 m0, s28, 35840
    s_add_u32 s30, s26, 16256
    buffer_load_dwordx4 v5, s[8:11], s30 offen lds
    s_add_u32 m0, s28, 98304
    s_add_u32 s30, s27, 896
    buffer_load_dwordx4 v6, s[12:15], s30 offen lds
    s_add_u32 m0, s28, 99328
    s_add_u32 s30, s27, 11136
    buffer_load_dwordx4 v7, s[12:15], s30 offen lds
    s_add_u32 m0, s28, 100352
    s_add_u32 s30, s27, 21376
    buffer_load_dwordx4 v6, s[12:15], s30 offen lds
    s_add_u32 m0, s28, 101376
    s_add_u32 s30, s27, 31616
    buffer_load_dwordx4 v7, s[12:15], s30 offen lds
    s_waitcnt vmcnt(8)
    s_barrier
    s_add_u32 m0, s28, 49152
    s_add_u32 s30, s26, 1024
    buffer_load_dwordx4 v4, s[8:11], s30 offen lds
    s_add_u32 m0, s28, 50176
    s_add_u32 s30, s26, 6144
    buffer_load_dwordx4 v5, s[8:11], s30 offen lds
    s_add_u32 m0, s28, 51200
    s_add_u32 s30, s26, 11264
    buffer_load_dwordx4 v4, s[8:11], s30 offen lds
    s_add_u32 m0, s28, 52224
    s_add_u32 s30, s26, 16384
    buffer_load_dwordx4 v5, s[8:11], s30 offen lds
    s_add_u32 m0, s28, 131072
    s_add_u32 s30, s27, 1024
    buffer_load_dwordx4 v6, s[12:15], s30 offen lds
    s_add_u32 m0, s28, 132096
    s_add_u32 s30, s27, 11264
    buffer_load_dwordx4 v7, s[12:15], s30 offen lds
    s_add_u32 m0, s28, 133120
    s_add_u32 s30, s27, 21504
    buffer_load_dwordx4 v6, s[12:15], s30 offen lds
    s_add_u32 m0, s28, 134144
    s_add_u32 s30, s27, 31744
    buffer_load_dwordx4 v7, s[12:15], s30 offen lds
    s_waitcnt vmcnt(8)
    s_barrier
    s_add_u32 m0, s28, 16384
    s_add_u32 s30, s26, 1152
    buffer_load_dwordx4 v4, s[8:11], s30 offen lds
    s_add_u32 m0, s28, 17408
    s_add_u32 s30, s26, 6272
    buffer_load_dwordx4 v5, s[8:11], s30 offen lds
    s_add_u32 m0, s28, 18432
    s_add_u32 s30, s26, 11392
    buffer_load_dwordx4 v4, s[8:11], s30 offen lds
    s_add_u32 m0, s28, 19456
    s_add_u32 s30, s26, 16512
    buffer_load_dwordx4 v5, s[8:11], s30 offen lds
    s_add_u32 m0, s28, 65536
    s_add_u32 s30, s27, 1152
    buffer_load_dwordx4 v6, s[12:15], s30 offen lds
    s_add_u32 m0, s28, 66560
    s_add_u32 s30, s27, 11392
    buffer_load_dwordx4 v7, s[12:15], s30 offen lds
    s_add_u32 m0, s28, 67584
    s_add_u32 s30, s27, 21632
    buffer_load_dwordx4 v6, s[12:15], s30 offen lds
    s_add_u32 m0, s28, 68608
    s_add_u32 s30, s27, 31872
    buffer_load_dwordx4 v7, s[12:15], s30 offen lds
    s_waitcnt vmcnt(8)
    s_barrier
    s_waitcnt vmcnt(0)
    s_barrier
    s_mul_i32 s24, s24, 10
    s_add_u32 s24, s24, s25
    s_lshl_b32 s24, s24, 2
    s_add_u32 s24, s24, s3
    v_lshlrev_b32 v2, 2, v1
    v_and_b32 v3, 15, v1
    v_lshrrev_b32 v6, 4, v1
    s_movk_i32 s30, 10240
    v_mul_lo_u32 v4, v6, s30
    v_lshl_add_u32 v4, v3, 1, v4
    v_lshlrev_b32 v5, 4, v1
    s_movk_i32 s30, 1280
    v_mul_lo_u32 v7, v3, s30
    v_lshl_add_u32 v7, v6, 4, v7
    s_mov_b32 s12, s88
    s_and_b32 s13, s89, 0xffff
    s_mov_b32 s14, 1966080
    s_mov_b32 s15, 0x00020000
    s_mov_b32 s16, s74
    s_and_b32 s17, s75, 0xffff
    s_mov_b32 s18, 819200
    s_mov_b32 s19, 0x00020000
    s_mov_b32 s48, s76
    s_and_b32 s49, s77, 0xffff
    s_mov_b32 s50, 819200
    s_mov_b32 s51, 0x00020000
    global_load_dword v10, v2, s[90:91] offset:0
    global_load_dword v11, v2, s[90:91] offset:256
    global_load_dword v12, v2, s[90:91] offset:512
    global_load_dword v13, v2, s[90:91] offset:768
    global_load_dword v14, v2, s[90:91] offset:1024
    s_add_u32 s30, s24, 0
    s_mul_i32 s30, s30, 1280
    buffer_load_dword v16, v2, s[8:11], s30 offen offset:0
    buffer_load_dword v17, v2, s[8:11], s30 offen offset:256
    buffer_load_dword v18, v2, s[8:11], s30 offen offset:512
    buffer_load_dword v19, v2, s[8:11], s30 offen offset:768
    buffer_load_dword v20, v2, s[8:11], s30 offen offset:1024
    s_add_u32 s30, s24, 640
    s_mul_i32 s30, s30, 1280
    buffer_load_dword v21, v2, s[8:11], s30 offen offset:0
    buffer_load_dword v22, v2, s[8:11], s30 offen offset:256
    buffer_load_dword v23, v2, s[8:11], s30 offen offset:512
    buffer_load_dword v24, v2, s[8:11], s30 offen offset:768
    buffer_load_dword v25, v2, s[8:11], s30 offen offset:1024
    s_add_u32 s30, s24, 1280
    s_mul_i32 s30, s30, 1280
    buffer_load_dword v26, v2, s[8:11], s30 offen offset:0
    buffer_load_dword v27, v2, s[8:11], s30 offen offset:256
    buffer_load_dword v28, v2, s[8:11], s30 offen offset:512
    buffer_load_dword v29, v2, s[8:11], s30 offen offset:768
    buffer_load_dword v30, v2, s[8:11], s30 offen offset:1024
    s_add_u32 s30, s24, 1920
    s_mul_i32 s30, s30, 1280
    buffer_load_dword v31, v2, s[8:11], s30 offen offset:0
    buffer_load_dword v32, v2, s[8:11], s30 offen offset:256
    buffer_load_dword v33, v2, s[8:11], s30 offen offset:512
    buffer_load_dword v34, v2, s[8:11], s30 offen offset:768
    buffer_load_dword v35, v2, s[8:11], s30 offen offset:1024
    s_add_u32 s25, s24, 0
    s_mov_b32 s30, 0x01111112
    s_mul_hi_u32 s40, s25, s30
    s_mul_i32 s41, s40, 240
    s_sub_u32 s41, s25, s41
    s_mov_b32 s30, 0x33333334
    s_mul_hi_u32 s42, s41, s30
    s_mul_i32 s43, s42, 5
    s_sub_u32 s43, s41, s43
    s_mul_i32 s40, s40, 160
    s_lshl_b32 s43, s43, 5
    s_mul_i32 s42, s42, 40960
    s_add_u32 s30, s40, s43
    s_add_u32 s30, s30, s42
    buffer_load_ushort v40, v4, s[12:15], s30 offen
    s_add_u32 s30, s30, 1280
    buffer_load_ushort v41, v4, s[12:15], s30 offen
    s_add_u32 s30, s30, 1280
    buffer_load_ushort v42, v4, s[12:15], s30 offen
    s_add_u32 s30, s30, 1280
    buffer_load_ushort v43, v4, s[12:15], s30 offen
    s_add_u32 s30, s30, 1280
    buffer_load_ushort v44, v4, s[12:15], s30 offen
    s_add_u32 s30, s30, 1280
    buffer_load_ushort v45, v4, s[12:15], s30 offen
    s_add_u32 s30, s30, 1280
    buffer_load_ushort v46, v4, s[12:15], s30 offen
    s_add_u32 s30, s30, 1280
    buffer_load_ushort v47, v4, s[12:15], s30 offen
    s_add_u32 s25, s24, 640
    s_mov_b32 s30, 0x01111112
    s_mul_hi_u32 s40, s25, s30
    s_mul_i32 s41, s40, 240
    s_sub_u32 s41, s25, s41
    s_mov_b32 s30, 0x33333334
    s_mul_hi_u32 s42, s41, s30
    s_mul_i32 s43, s42, 5
    s_sub_u32 s43, s41, s43
    s_mul_i32 s40, s40, 160
    s_lshl_b32 s43, s43, 5
    s_mul_i32 s42, s42, 40960
    s_add_u32 s30, s40, s43
    s_add_u32 s30, s30, s42
    buffer_load_ushort v48, v4, s[12:15], s30 offen
    s_add_u32 s30, s30, 1280
    buffer_load_ushort v49, v4, s[12:15], s30 offen
    s_add_u32 s30, s30, 1280
    buffer_load_ushort v50, v4, s[12:15], s30 offen
    s_add_u32 s30, s30, 1280
    buffer_load_ushort v51, v4, s[12:15], s30 offen
    s_add_u32 s30, s30, 1280
    buffer_load_ushort v52, v4, s[12:15], s30 offen
    s_add_u32 s30, s30, 1280
    buffer_load_ushort v53, v4, s[12:15], s30 offen
    s_add_u32 s30, s30, 1280
    buffer_load_ushort v54, v4, s[12:15], s30 offen
    s_add_u32 s30, s30, 1280
    buffer_load_ushort v55, v4, s[12:15], s30 offen
    s_add_u32 s25, s24, 1280
    s_mov_b32 s30, 0x01111112
    s_mul_hi_u32 s40, s25, s30
    s_mul_i32 s41, s40, 240
    s_sub_u32 s41, s25, s41
    s_mov_b32 s30, 0x33333334
    s_mul_hi_u32 s42, s41, s30
    s_mul_i32 s43, s42, 5
    s_sub_u32 s43, s41, s43
    s_mul_i32 s40, s40, 160
    s_lshl_b32 s43, s43, 5
    s_mul_i32 s42, s42, 40960
    s_add_u32 s30, s40, s43
    s_add_u32 s30, s30, s42
    buffer_load_ushort v56, v4, s[12:15], s30 offen
    s_add_u32 s30, s30, 1280
    buffer_load_ushort v57, v4, s[12:15], s30 offen
    s_add_u32 s30, s30, 1280
    buffer_load_ushort v58, v4, s[12:15], s30 offen
    s_add_u32 s30, s30, 1280
    buffer_load_ushort v59, v4, s[12:15], s30 offen
    s_add_u32 s30, s30, 1280
    buffer_load_ushort v60, v4, s[12:15], s30 offen
    s_add_u32 s30, s30, 1280
    buffer_load_ushort v61, v4, s[12:15], s30 offen
    s_add_u32 s30, s30, 1280
    buffer_load_ushort v62, v4, s[12:15], s30 offen
    s_add_u32 s30, s30, 1280
    buffer_load_ushort v63, v4, s[12:15], s30 offen
    s_add_u32 s25, s24, 0
    s_mov_b32 s30, 0x0147ae15
    s_mul_hi_u32 s40, s25, s30
    s_mul_i32 s41, s40, 200
    s_sub_u32 s41, s25, s41
    s_mov_b32 s30, 0x33333334
    s_mul_hi_u32 s42, s41, s30
    s_mul_i32 s43, s42, 5
    s_sub_u32 s43, s41, s43
    s_mul_i32 s40, s40, 102400
    s_mul_i32 s43, s43, 20480
    s_add_u32 s30, s40, s43
    s_cmp_ge_u32 s42, 20
    s_cbranch_scc1 K1_CF_1_im
    s_lshl_b32 s42, s42, 6
    s_add_u32 s30, s30, s42
    buffer_load_dwordx4 v[64:67], v7, s[16:19], s30 offen
    s_branch K1_CF_1_done
K1_CF_1_im:
    s_sub_u32 s42, s42, 20
    s_lshl_b32 s42, s42, 6
    s_add_u32 s30, s30, s42
    buffer_load_dwordx4 v[64:67], v7, s[48:51], s30 offen
K1_CF_1_done:
    s_add_u32 s25, s24, 640
    s_mov_b32 s30, 0x0147ae15
    s_mul_hi_u32 s40, s25, s30
    s_mul_i32 s41, s40, 200
    s_sub_u32 s41, s25, s41
    s_mov_b32 s30, 0x33333334
    s_mul_hi_u32 s42, s41, s30
    s_mul_i32 s43, s42, 5
    s_sub_u32 s43, s41, s43
    s_mul_i32 s40, s40, 102400
    s_mul_i32 s43, s43, 20480
    s_add_u32 s30, s40, s43
    s_cmp_ge_u32 s42, 20
    s_cbranch_scc1 K1_CF_2_im
    s_lshl_b32 s42, s42, 6
    s_add_u32 s30, s30, s42
    buffer_load_dwordx4 v[68:71], v7, s[16:19], s30 offen
    s_branch K1_CF_2_done
K1_CF_2_im:
    s_sub_u32 s42, s42, 20
    s_lshl_b32 s42, s42, 6
    s_add_u32 s30, s30, s42
    buffer_load_dwordx4 v[68:71], v7, s[48:51], s30 offen
K1_CF_2_done:
    s_add_u32 s25, s24, 1280
    s_mov_b32 s30, 0x0147ae15
    s_mul_hi_u32 s40, s25, s30
    s_mul_i32 s41, s40, 200
    s_sub_u32 s41, s25, s41
    s_mov_b32 s30, 0x33333334
    s_mul_hi_u32 s42, s41, s30
    s_mul_i32 s43, s42, 5
    s_sub_u32 s43, s41, s43
    s_mul_i32 s40, s40, 102400
    s_mul_i32 s43, s43, 20480
    s_add_u32 s30, s40, s43
    s_cmp_ge_u32 s42, 20
    s_cbranch_scc1 K1_CF_3_im
    s_lshl_b32 s42, s42, 6
    s_add_u32 s30, s30, s42
    buffer_load_dwordx4 v[72:75], v7, s[16:19], s30 offen
    s_branch K1_CF_3_done
K1_CF_3_im:
    s_sub_u32 s42, s42, 20
    s_lshl_b32 s42, s42, 6
    s_add_u32 s30, s30, s42
    buffer_load_dwordx4 v[72:75], v7, s[48:51], s30 offen
K1_CF_3_done:
    s_barrier
    s_waitcnt vmcnt(0)
    v_lshl_or_b32 v80, v41, 16, v40
    v_lshl_or_b32 v81, v43, 16, v42
    v_lshl_or_b32 v82, v45, 16, v44
    v_lshl_or_b32 v83, v47, 16, v46
    s_add_u32 s30, s24, 0
    s_lshl_b32 s30, s30, 10
    s_add_u32 s30, s30, 16777216
    buffer_store_dwordx4 v[80:83], v5, s[20:23], s30 offen sc1
    v_lshl_or_b32 v84, v49, 16, v48
    v_lshl_or_b32 v85, v51, 16, v50
    v_lshl_or_b32 v86, v53, 16, v52
    v_lshl_or_b32 v87, v55, 16, v54
    s_add_u32 s30, s24, 640
    s_lshl_b32 s30, s30, 10
    s_add_u32 s30, s30, 16777216
    buffer_store_dwordx4 v[84:87], v5, s[20:23], s30 offen sc1
    v_lshl_or_b32 v88, v57, 16, v56
    v_lshl_or_b32 v89, v59, 16, v58
    v_lshl_or_b32 v90, v61, 16, v60
    v_lshl_or_b32 v91, v63, 16, v62
    s_add_u32 s30, s24, 1280
    s_lshl_b32 s30, s30, 10
    s_add_u32 s30, s30, 16777216
    buffer_store_dwordx4 v[88:91], v5, s[20:23], s30 offen sc1
    s_add_u32 s30, s24, 0
    s_lshl_b32 s30, s30, 10
    s_add_u32 s30, s30, 18874368
    buffer_store_dwordx4 v[64:67], v5, s[20:23], s30 offen sc1
K1_CFS_4:
    s_add_u32 s30, s24, 640
    s_lshl_b32 s30, s30, 10
    s_add_u32 s30, s30, 18874368
    buffer_store_dwordx4 v[68:71], v5, s[20:23], s30 offen sc1
K1_CFS_5:
    s_add_u32 s30, s24, 1280
    s_cmp_ge_u32 s30, 1600
    s_cbranch_scc1 K1_CFS_6
    s_lshl_b32 s30, s30, 10
    s_add_u32 s30, s30, 18874368
    buffer_store_dwordx4 v[72:75], v5, s[20:23], s30 offen sc1
K1_CFS_6:
    v_lshlrev_b32 v100, 16, v10
    v_and_b32 v101, 0xffff0000, v10
    v_lshlrev_b32 v102, 16, v11
    v_and_b32 v103, 0xffff0000, v11
    v_lshlrev_b32 v104, 16, v12
    v_and_b32 v105, 0xffff0000, v12
    v_lshlrev_b32 v106, 16, v13
    v_and_b32 v107, 0xffff0000, v13
    v_lshlrev_b32 v108, 16, v14
    v_and_b32 v109, 0xffff0000, v14
    s_mov_b32 s60, 0xbfb8aa3b
    s_add_u32 s25, s24, 0
    v_mov_b32 v120, 0
    v_lshlrev_b32 v110, 16, v16
    v_and_b32 v111, 0xffff0000, v16
    v_mul_f32 v110, v110, v100
    v_mul_f32 v111, v111, v101
    v_cvt_pk_bf16_f32 v112, v110, v111
    v_lshlrev_b32 v110, 16, v112
    v_and_b32 v111, 0xffff0000, v112
    v_add_f32 v120, v120, v110
    v_add_f32 v120, v120, v111
    v_lshlrev_b32 v110, 16, v17
    v_and_b32 v111, 0xffff0000, v17
    v_mul_f32 v110, v110, v102
    v_mul_f32 v111, v111, v103
    v_cvt_pk_bf16_f32 v112, v110, v111
    v_lshlrev_b32 v110, 16, v112
    v_and_b32 v111, 0xffff0000, v112
    v_add_f32 v120, v120, v110
    v_add_f32 v120, v120, v111
    v_lshlrev_b32 v110, 16, v18
    v_and_b32 v111, 0xffff0000, v18
    v_mul_f32 v110, v110, v104
    v_mul_f32 v111, v111, v105
    v_cvt_pk_bf16_f32 v112, v110, v111
    v_lshlrev_b32 v110, 16, v112
    v_and_b32 v111, 0xffff0000, v112
    v_add_f32 v120, v120, v110
    v_add_f32 v120, v120, v111
    v_lshlrev_b32 v110, 16, v19
    v_and_b32 v111, 0xffff0000, v19
    v_mul_f32 v110, v110, v106
    v_mul_f32 v111, v111, v107
    v_cvt_pk_bf16_f32 v112, v110, v111
    v_lshlrev_b32 v110, 16, v112
    v_and_b32 v111, 0xffff0000, v112
    v_add_f32 v120, v120, v110
    v_add_f32 v120, v120, v111
    v_lshlrev_b32 v110, 16, v20
    v_and_b32 v111, 0xffff0000, v20
    v_mul_f32 v110, v110, v108
    v_mul_f32 v111, v111, v109
    v_cvt_pk_bf16_f32 v112, v110, v111
    v_lshlrev_b32 v110, 16, v112
    v_and_b32 v111, 0xffff0000, v112
    v_add_f32 v120, v120, v110
    v_add_f32 v120, v120, v111
    s_nop 1
    v_add_f32_dpp v120, v120, v120 row_shr:1 row_mask:0xf bank_mask:0xf
    s_nop 1
    v_add_f32_dpp v120, v120, v120 row_shr:2 row_mask:0xf bank_mask:0xf
    s_nop 1
    v_add_f32_dpp v120, v120, v120 row_shr:4 row_mask:0xf bank_mask:0xf
    s_nop 1
    v_add_f32_dpp v120, v120, v120 row_shr:8 row_mask:0xf bank_mask:0xf
    s_nop 1
    v_readlane_b32 s40, v120, 15
    v_readlane_b32 s41, v120, 31
    v_readlane_b32 s42, v120, 47
    v_readlane_b32 s43, v120, 63
    s_nop 1
    v_mov_b32 v121, s40
    v_add_f32 v121, s41, v121
    v_add_f32 v121, s42, v121
    v_add_f32 v121, s43, v121
    v_cvt_pk_bf16_f32 v121, v121, v121
    v_lshlrev_b32 v121, 16, v121
    v_mul_f32 v122, s60, v121
    v_exp_f32 v122, v122
    s_nop 0
    v_add_f32 v122, 1.0, v122
    v_rcp_f32 v122, v122
    s_nop 0
    v_cvt_pk_bf16_f32 v122, v122, v122
    v_lshlrev_b32 v122, 16, v122
    v_sub_f32 v123, 1.0, v122
    v_cvt_pk_bf16_f32 v123, v123, v123
    v_lshlrev_b32 v123, 16, v123
    s_lshl_b32 s30, s25, 3
    s_add_u32 s30, s30, 34603008
    v_mov_b32 v124, 0
    s_mov_b64 s[40:41], exec
    s_mov_b64 exec, 1
    buffer_store_dwordx2 v[122:123], v124, s[20:23], s30 offen sc1
    s_mov_b64 exec, s[40:41]
K1_G_7:
    s_add_u32 s25, s24, 640
    v_mov_b32 v120, 0
    v_lshlrev_b32 v110, 16, v21
    v_and_b32 v111, 0xffff0000, v21
    v_mul_f32 v110, v110, v100
    v_mul_f32 v111, v111, v101
    v_cvt_pk_bf16_f32 v112, v110, v111
    v_lshlrev_b32 v110, 16, v112
    v_and_b32 v111, 0xffff0000, v112
    v_add_f32 v120, v120, v110
    v_add_f32 v120, v120, v111
    v_lshlrev_b32 v110, 16, v22
    v_and_b32 v111, 0xffff0000, v22
    v_mul_f32 v110, v110, v102
    v_mul_f32 v111, v111, v103
    v_cvt_pk_bf16_f32 v112, v110, v111
    v_lshlrev_b32 v110, 16, v112
    v_and_b32 v111, 0xffff0000, v112
    v_add_f32 v120, v120, v110
    v_add_f32 v120, v120, v111
    v_lshlrev_b32 v110, 16, v23
    v_and_b32 v111, 0xffff0000, v23
    v_mul_f32 v110, v110, v104
    v_mul_f32 v111, v111, v105
    v_cvt_pk_bf16_f32 v112, v110, v111
    v_lshlrev_b32 v110, 16, v112
    v_and_b32 v111, 0xffff0000, v112
    v_add_f32 v120, v120, v110
    v_add_f32 v120, v120, v111
    v_lshlrev_b32 v110, 16, v24
    v_and_b32 v111, 0xffff0000, v24
    v_mul_f32 v110, v110, v106
    v_mul_f32 v111, v111, v107
    v_cvt_pk_bf16_f32 v112, v110, v111
    v_lshlrev_b32 v110, 16, v112
    v_and_b32 v111, 0xffff0000, v112
    v_add_f32 v120, v120, v110
    v_add_f32 v120, v120, v111
    v_lshlrev_b32 v110, 16, v25
    v_and_b32 v111, 0xffff0000, v25
    v_mul_f32 v110, v110, v108
    v_mul_f32 v111, v111, v109
    v_cvt_pk_bf16_f32 v112, v110, v111
    v_lshlrev_b32 v110, 16, v112
    v_and_b32 v111, 0xffff0000, v112
    v_add_f32 v120, v120, v110
    v_add_f32 v120, v120, v111
    s_nop 1
    v_add_f32_dpp v120, v120, v120 row_shr:1 row_mask:0xf bank_mask:0xf
    s_nop 1
    v_add_f32_dpp v120, v120, v120 row_shr:2 row_mask:0xf bank_mask:0xf
    s_nop 1
    v_add_f32_dpp v120, v120, v120 row_shr:4 row_mask:0xf bank_mask:0xf
    s_nop 1
    v_add_f32_dpp v120, v120, v120 row_shr:8 row_mask:0xf bank_mask:0xf
    s_nop 1
    v_readlane_b32 s40, v120, 15
    v_readlane_b32 s41, v120, 31
    v_readlane_b32 s42, v120, 47
    v_readlane_b32 s43, v120, 63
    s_nop 1
    v_mov_b32 v121, s40
    v_add_f32 v121, s41, v121
    v_add_f32 v121, s42, v121
    v_add_f32 v121, s43, v121
    v_cvt_pk_bf16_f32 v121, v121, v121
    v_lshlrev_b32 v121, 16, v121
    v_mul_f32 v122, s60, v121
    v_exp_f32 v122, v122
    s_nop 0
    v_add_f32 v122, 1.0, v122
    v_rcp_f32 v122, v122
    s_nop 0
    v_cvt_pk_bf16_f32 v122, v122, v122
    v_lshlrev_b32 v122, 16, v122
    v_sub_f32 v123, 1.0, v122
    v_cvt_pk_bf16_f32 v123, v123, v123
    v_lshlrev_b32 v123, 16, v123
    s_lshl_b32 s30, s25, 3
    s_add_u32 s30, s30, 34603008
    v_mov_b32 v124, 0
    s_mov_b64 s[40:41], exec
    s_mov_b64 exec, 1
    buffer_store_dwordx2 v[122:123], v124, s[20:23], s30 offen sc1
    s_mov_b64 exec, s[40:41]
K1_G_8:
    s_add_u32 s25, s24, 1280
    v_mov_b32 v120, 0
    v_lshlrev_b32 v110, 16, v26
    v_and_b32 v111, 0xffff0000, v26
    v_mul_f32 v110, v110, v100
    v_mul_f32 v111, v111, v101
    v_cvt_pk_bf16_f32 v112, v110, v111
    v_lshlrev_b32 v110, 16, v112
    v_and_b32 v111, 0xffff0000, v112
    v_add_f32 v120, v120, v110
    v_add_f32 v120, v120, v111
    v_lshlrev_b32 v110, 16, v27
    v_and_b32 v111, 0xffff0000, v27
    v_mul_f32 v110, v110, v102
    v_mul_f32 v111, v111, v103
    v_cvt_pk_bf16_f32 v112, v110, v111
    v_lshlrev_b32 v110, 16, v112
    v_and_b32 v111, 0xffff0000, v112
    v_add_f32 v120, v120, v110
    v_add_f32 v120, v120, v111
    v_lshlrev_b32 v110, 16, v28
    v_and_b32 v111, 0xffff0000, v28
    v_mul_f32 v110, v110, v104
    v_mul_f32 v111, v111, v105
    v_cvt_pk_bf16_f32 v112, v110, v111
    v_lshlrev_b32 v110, 16, v112
    v_and_b32 v111, 0xffff0000, v112
    v_add_f32 v120, v120, v110
    v_add_f32 v120, v120, v111
    v_lshlrev_b32 v110, 16, v29
    v_and_b32 v111, 0xffff0000, v29
    v_mul_f32 v110, v110, v106
    v_mul_f32 v111, v111, v107
    v_cvt_pk_bf16_f32 v112, v110, v111
    v_lshlrev_b32 v110, 16, v112
    v_and_b32 v111, 0xffff0000, v112
    v_add_f32 v120, v120, v110
    v_add_f32 v120, v120, v111
    v_lshlrev_b32 v110, 16, v30
    v_and_b32 v111, 0xffff0000, v30
    v_mul_f32 v110, v110, v108
    v_mul_f32 v111, v111, v109
    v_cvt_pk_bf16_f32 v112, v110, v111
    v_lshlrev_b32 v110, 16, v112
    v_and_b32 v111, 0xffff0000, v112
    v_add_f32 v120, v120, v110
    v_add_f32 v120, v120, v111
    s_nop 1
    v_add_f32_dpp v120, v120, v120 row_shr:1 row_mask:0xf bank_mask:0xf
    s_nop 1
    v_add_f32_dpp v120, v120, v120 row_shr:2 row_mask:0xf bank_mask:0xf
    s_nop 1
    v_add_f32_dpp v120, v120, v120 row_shr:4 row_mask:0xf bank_mask:0xf
    s_nop 1
    v_add_f32_dpp v120, v120, v120 row_shr:8 row_mask:0xf bank_mask:0xf
    s_nop 1
    v_readlane_b32 s40, v120, 15
    v_readlane_b32 s41, v120, 31
    v_readlane_b32 s42, v120, 47
    v_readlane_b32 s43, v120, 63
    s_nop 1
    v_mov_b32 v121, s40
    v_add_f32 v121, s41, v121
    v_add_f32 v121, s42, v121
    v_add_f32 v121, s43, v121
    v_cvt_pk_bf16_f32 v121, v121, v121
    v_lshlrev_b32 v121, 16, v121
    v_mul_f32 v122, s60, v121
    v_exp_f32 v122, v122
    s_nop 0
    v_add_f32 v122, 1.0, v122
    v_rcp_f32 v122, v122
    s_nop 0
    v_cvt_pk_bf16_f32 v122, v122, v122
    v_lshlrev_b32 v122, 16, v122
    v_sub_f32 v123, 1.0, v122
    v_cvt_pk_bf16_f32 v123, v123, v123
    v_lshlrev_b32 v123, 16, v123
    s_lshl_b32 s30, s25, 3
    s_add_u32 s30, s30, 34603008
    v_mov_b32 v124, 0
    s_mov_b64 s[40:41], exec
    s_mov_b64 exec, 1
    buffer_store_dwordx2 v[122:123], v124, s[20:23], s30 offen sc1
    s_mov_b64 exec, s[40:41]
K1_G_9:
    s_add_u32 s25, s24, 1920
    s_cmp_ge_u32 s25, 2048
    s_cbranch_scc1 K1_G_10
    v_mov_b32 v120, 0
    v_lshlrev_b32 v110, 16, v31
    v_and_b32 v111, 0xffff0000, v31
    v_mul_f32 v110, v110, v100
    v_mul_f32 v111, v111, v101
    v_cvt_pk_bf16_f32 v112, v110, v111
    v_lshlrev_b32 v110, 16, v112
    v_and_b32 v111, 0xffff0000, v112
    v_add_f32 v120, v120, v110
    v_add_f32 v120, v120, v111
    v_lshlrev_b32 v110, 16, v32
    v_and_b32 v111, 0xffff0000, v32
    v_mul_f32 v110, v110, v102
    v_mul_f32 v111, v111, v103
    v_cvt_pk_bf16_f32 v112, v110, v111
    v_lshlrev_b32 v110, 16, v112
    v_and_b32 v111, 0xffff0000, v112
    v_add_f32 v120, v120, v110
    v_add_f32 v120, v120, v111
    v_lshlrev_b32 v110, 16, v33
    v_and_b32 v111, 0xffff0000, v33
    v_mul_f32 v110, v110, v104
    v_mul_f32 v111, v111, v105
    v_cvt_pk_bf16_f32 v112, v110, v111
    v_lshlrev_b32 v110, 16, v112
    v_and_b32 v111, 0xffff0000, v112
    v_add_f32 v120, v120, v110
    v_add_f32 v120, v120, v111
    v_lshlrev_b32 v110, 16, v34
    v_and_b32 v111, 0xffff0000, v34
    v_mul_f32 v110, v110, v106
    v_mul_f32 v111, v111, v107
    v_cvt_pk_bf16_f32 v112, v110, v111
    v_lshlrev_b32 v110, 16, v112
    v_and_b32 v111, 0xffff0000, v112
    v_add_f32 v120, v120, v110
    v_add_f32 v120, v120, v111
    v_lshlrev_b32 v110, 16, v35
    v_and_b32 v111, 0xffff0000, v35
    v_mul_f32 v110, v110, v108
    v_mul_f32 v111, v111, v109
    v_cvt_pk_bf16_f32 v112, v110, v111
    v_lshlrev_b32 v110, 16, v112
    v_and_b32 v111, 0xffff0000, v112
    v_add_f32 v120, v120, v110
    v_add_f32 v120, v120, v111
    s_nop 1
    v_add_f32_dpp v120, v120, v120 row_shr:1 row_mask:0xf bank_mask:0xf
    s_nop 1
    v_add_f32_dpp v120, v120, v120 row_shr:2 row_mask:0xf bank_mask:0xf
    s_nop 1
    v_add_f32_dpp v120, v120, v120 row_shr:4 row_mask:0xf bank_mask:0xf
    s_nop 1
    v_add_f32_dpp v120, v120, v120 row_shr:8 row_mask:0xf bank_mask:0xf
    s_nop 1
    v_readlane_b32 s40, v120, 15
    v_readlane_b32 s41, v120, 31
    v_readlane_b32 s42, v120, 47
    v_readlane_b32 s43, v120, 63
    s_nop 1
    v_mov_b32 v121, s40
    v_add_f32 v121, s41, v121
    v_add_f32 v121, s42, v121
    v_add_f32 v121, s43, v121
    v_cvt_pk_bf16_f32 v121, v121, v121
    v_lshlrev_b32 v121, 16, v121
    v_mul_f32 v122, s60, v121
    v_exp_f32 v122, v122
    s_nop 0
    v_add_f32 v122, 1.0, v122
    v_rcp_f32 v122, v122
    s_nop 0
    v_cvt_pk_bf16_f32 v122, v122, v122
    v_lshlrev_b32 v122, 16, v122
    v_sub_f32 v123, 1.0, v122
    v_cvt_pk_bf16_f32 v123, v123, v123
    v_lshlrev_b32 v123, 16, v123
    s_lshl_b32 s30, s25, 3
    s_add_u32 s30, s30, 34603008
    v_mov_b32 v124, 0
    s_mov_b64 s[40:41], exec
    s_mov_b64 exec, 1
    buffer_store_dwordx2 v[122:123], v124, s[20:23], s30 offen sc1
    s_mov_b64 exec, s[40:41]
K1_G_10:
    s_endpgm
K1_U:
    v_and_b32 v23, 31, v1
    v_lshlrev_b32 v23, 7, v23
    v_bfe_u32 v73, v1, 1, 3
    s_lshr_b32 s47, s3, 1
    s_and_b32 s46, s3, 1
    s_lshl_b32 s30, s47, 13
    s_lshl_b32 s31, s46, 13
    s_add_u32 s31, s31, 65536
    v_add_u32 v74, 0, v72
    v_xor_b32 v74, v74, v73
    v_lshl_add_u32 v74, v74, 4, v23
    v_add_u32 v8, s30, v74
    v_add_u32 v12, s31, v74
    v_add_u32 v16, 0x10000, v12
    v_add_u32 v74, 2, v72
    v_xor_b32 v74, v74, v73
    v_lshl_add_u32 v74, v74, 4, v23
    v_add_u32 v9, s30, v74
    v_add_u32 v13, s31, v74
    v_add_u32 v17, 0x10000, v13
    v_add_u32 v74, 4, v72
    v_xor_b32 v74, v74, v73
    v_lshl_add_u32 v74, v74, 4, v23
    v_add_u32 v10, s30, v74
    v_add_u32 v14, s31, v74
    v_add_u32 v18, 0x10000, v14
    v_add_u32 v74, 6, v72
    v_xor_b32 v74, v74, v73
    v_lshl_add_u32 v74, v74, 4, v23
    v_add_u32 v11, s30, v74
    v_add_u32 v15, s31, v74
    v_add_u32 v19, 0x10000, v15
    s_lshl_b32 s42, s25, 6
    s_lshl_b32 s30, s46, 5
    s_add_u32 s42, s42, s30
    v_and_b32 v75, 31, v1
    v_add_u32 v75, s42, v75
    v_lshlrev_b32 v76, 1, v75
    global_load_ushort v77, v76, s[66:67]
    global_load_ushort v78, v76, s[68:69]
    global_load_ushort v79, v76, s[78:79]
    v_lshlrev_b32 v83, 3, v75
    v_add_u32 v83, 33554432, v83
    s_mul_i32 s31, s24, 5120
    v_mov_b32 v48, -1
    v_mov_b32 v49, -1
    s_cmp_lg_u32 s47, 0
    s_cbranch_scc1 K1_U_NOCLR
    buffer_store_dwordx2 v[48:49], v83, s[20:23], s31 offen sc1
K1_U_NOCLR:
    v_mov_b32 v128, 0
    v_mov_b32 v129, 0
    v_mov_b32 v130, 0
    v_mov_b32 v131, 0
    v_mov_b32 v132, 0
    v_mov_b32 v133, 0
    v_mov_b32 v134, 0
    v_mov_b32 v135, 0
    v_mov_b32 v136, 0
    v_mov_b32 v137, 0
    v_mov_b32 v138, 0
    v_mov_b32 v139, 0
    v_mov_b32 v140, 0
    v_mov_b32 v141, 0
    v_mov_b32 v142, 0
    v_mov_b32 v143, 0
    v_mov_b32 v144, 0
    v_mov_b32 v145, 0
    v_mov_b32 v146, 0
    v_mov_b32 v147, 0
    v_mov_b32 v148, 0
    v_mov_b32 v149, 0
    v_mov_b32 v150, 0
    v_mov_b32 v151, 0
    v_mov_b32 v152, 0
    v_mov_b32 v153, 0
    v_mov_b32 v154, 0
    v_mov_b32 v155, 0
    v_mov_b32 v156, 0
    v_mov_b32 v157, 0
    v_mov_b32 v158, 0
    v_mov_b32 v159, 0
    v_mov_b32 v160, 0
    v_mov_b32 v161, 0
    v_mov_b32 v162, 0
    v_mov_b32 v163, 0
    v_mov_b32 v164, 0
    v_mov_b32 v165, 0
    v_mov_b32 v166, 0
    v_mov_b32 v167, 0
    v_mov_b32 v168, 0
    v_mov_b32 v169, 0
    v_mov_b32 v170, 0
    v_mov_b32 v171, 0
    v_mov_b32 v172, 0
    v_mov_b32 v173, 0
    v_mov_b32 v174, 0
    v_mov_b32 v175, 0
    v_mov_b32 v176, 0
    v_mov_b32 v177, 0
    v_mov_b32 v178, 0
    v_mov_b32 v179, 0
    v_mov_b32 v180, 0
    v_mov_b32 v181, 0
    v_mov_b32 v182, 0
    v_mov_b32 v183, 0
    v_mov_b32 v184, 0
    v_mov_b32 v185, 0
    v_mov_b32 v186, 0
    v_mov_b32 v187, 0
    v_mov_b32 v188, 0
    v_mov_b32 v189, 0
    v_mov_b32 v190, 0
    v_mov_b32 v191, 0
    s_waitcnt vmcnt(0)
    s_mov_b32 s58, 0x3fb8aa3b
    s_mov_b32 s59, 0x3e22f983
    v_lshlrev_b32 v77, 16, v77
    v_lshlrev_b32 v78, 16, v78
    v_lshlrev_b32 v79, 16, v79
    v_mul_f32 v82, s58, v79
    v_exp_f32 v82, v82
    s_nop 0
    v_cvt_pk_bf16_f32 v82, v82, v82
    v_lshlrev_b32 v79, 16, v82
    v_mul_f32 v82, v79, v77
    v_mul_f32 v83, v79, v78
    v_mul_f32 v82, s58, v82
    v_mul_f32 v83, s59, v83
    v_exp_f32 v82, v82
    v_fract_f32 v83, v83
    v_cos_f32 v80, v83
    v_sin_f32 v81, v83
    s_nop 0
    v_mul_f32 v80, v80, v82
    v_mul_f32 v81, v81, v82
    v_add_f32 v48, -1.0, v80
    v_mul_f32 v49, v77, v77
    v_fma_f32 v49, v78, v78, v49
    v_rcp_f32 v49, v49
    v_mul_f32 v84, v48, v77
    v_fma_f32 v84, v81, v78, v84
    v_mul_f32 v85, v81, v77
    v_fma_f32 v85, -v48, v78, v85
    v_add_f32 v49, v49, v49
    v_mul_f32 v84, v84, v49
    v_mul_f32 v85, v85, v49
    v_mul_f32 v48, v81, v81
    v_mul_f32 v49, v80, v81
    v_fma_f32 v86, v80, v80, -v48
    v_add_f32 v87, v49, v49
    v_mul_f32 v48, v87, v87
    v_mul_f32 v49, v86, v87
    v_fma_f32 v86, v86, v86, -v48
    v_add_f32 v87, v49, v49
    v_mul_f32 v48, v87, v87
    v_mul_f32 v49, v86, v87
    v_fma_f32 v86, v86, v86, -v48
    v_add_f32 v87, v49, v49
    v_mul_f32 v48, v87, v87
    v_mul_f32 v49, v86, v87
    v_fma_f32 v86, v86, v86, -v48
    v_add_f32 v87, v49, v49
    v_mul_f32 v48, v87, v87
    v_mul_f32 v49, v86, v87
    v_fma_f32 v86, v86, v86, -v48
    v_add_f32 v87, v49, v49
    v_mul_f32 v48, v87, v87
    v_mul_f32 v49, v86, v87
    v_fma_f32 v88, v86, v86, -v48
    v_add_f32 v89, v49, v49
    v_mul_f32 v48, v89, v89
    v_mul_f32 v49, v88, v89
    v_fma_f32 v88, v88, v88, -v48
    v_add_f32 v89, v49, v49
    s_lshl_b32 s53, 1, s24
    s_sub_u32 s54, s53, 1
    s_lshl_b32 s30, s25, 2
    v_mov_b32 v82, s30
    v_mov_b32 v83, s53
    s_barrier
    s_cmp_lg_u32 s3, 0
    s_cbranch_scc1 K1_U_NOAT
    s_mov_b64 s[56:57], exec
    s_mov_b64 exec, 1
    global_atomic_or v82, v83, s[94:95]
    s_mov_b64 exec, s[56:57]
K1_U_NOAT:
    ds_read_b128 v[24:27], v8 offset:16384
    ds_read_b128 v[28:31], v8 offset:20480
    ds_read_b128 v[40:43], v12 offset:0
    ds_read_b128 v[44:47], v12 offset:4096
    ds_read_b128 v[48:51], v9 offset:16384
    ds_read_b128 v[52:55], v9 offset:20480
    ds_read_b128 v[64:67], v13 offset:0
    ds_read_b128 v[68:71], v13 offset:4096
    s_waitcnt lgkmcnt(4)
    v_mfma_f32_32x32x16_bf16 v[128:143], v[24:27], v[40:43], v[128:143]
    v_mfma_f32_32x32x16_bf16 v[144:159], v[24:27], v[44:47], v[144:159]
    v_mfma_f32_32x32x16_bf16 v[160:175], v[28:31], v[40:43], v[160:175]
    v_mfma_f32_32x32x16_bf16 v[176:191], v[28:31], v[44:47], v[176:191]
    ds_read_b128 v[24:27], v10 offset:16384
    ds_read_b128 v[28:31], v10 offset:20480
    ds_read_b128 v[40:43], v14 offset:0
    ds_read_b128 v[44:47], v14 offset:4096
    s_waitcnt lgkmcnt(4)
    v_mfma_f32_32x32x16_bf16 v[128:143], v[48:51], v[64:67], v[128:143]
    v_mfma_f32_32x32x16_bf16 v[144:159], v[48:51], v[68:71], v[144:159]
    v_mfma_f32_32x32x16_bf16 v[160:175], v[52:55], v[64:67], v[160:175]
    v_mfma_f32_32x32x16_bf16 v[176:191], v[52:55], v[68:71], v[176:191]
    ds_read_b128 v[48:51], v11 offset:16384
    ds_read_b128 v[52:55], v11 offset:20480
    ds_read_b128 v[64:67], v15 offset:0
    ds_read_b128 v[68:71], v15 offset:4096
    s_waitcnt lgkmcnt(4)
    v_mfma_f32_32x32x16_bf16 v[128:143], v[24:27], v[40:43], v[128:143]
    v_mfma_f32_32x32x16_bf16 v[144:159], v[24:27], v[44:47], v[144:159]
    v_mfma_f32_32x32x16_bf16 v[160:175], v[28:31], v[40:43], v[160:175]
    v_mfma_f32_32x32x16_bf16 v[176:191], v[28:31], v[44:47], v[176:191]
    s_waitcnt lgkmcnt(0)
    v_mfma_f32_32x32x16_bf16 v[128:143], v[48:51], v[64:67], v[128:143]
    v_mfma_f32_32x32x16_bf16 v[144:159], v[48:51], v[68:71], v[144:159]
    v_mfma_f32_32x32x16_bf16 v[160:175], v[52:55], v[64:67], v[160:175]
    v_mfma_f32_32x32x16_bf16 v[176:191], v[52:55], v[68:71], v[176:191]
    s_barrier
    ds_read_b128 v[24:27], v8 offset:32768
    ds_read_b128 v[28:31], v8 offset:36864
    ds_read_b128 v[40:43], v12 offset:32768
    ds_read_b128 v[44:47], v12 offset:36864
    ds_read_b128 v[48:51], v9 offset:32768
    ds_read_b128 v[52:55], v9 offset:36864
    ds_read_b128 v[64:67], v13 offset:32768
    ds_read_b128 v[68:71], v13 offset:36864
    s_waitcnt lgkmcnt(4)
    v_mfma_f32_32x32x16_bf16 v[128:143], v[24:27], v[40:43], v[128:143]
    v_mfma_f32_32x32x16_bf16 v[144:159], v[24:27], v[44:47], v[144:159]
    v_mfma_f32_32x32x16_bf16 v[160:175], v[28:31], v[40:43], v[160:175]
    v_mfma_f32_32x32x16_bf16 v[176:191], v[28:31], v[44:47], v[176:191]
    ds_read_b128 v[24:27], v10 offset:32768
    ds_read_b128 v[28:31], v10 offset:36864
    ds_read_b128 v[40:43], v14 offset:32768
    ds_read_b128 v[44:47], v14 offset:36864
    s_waitcnt lgkmcnt(4)
    v_mfma_f32_32x32x16_bf16 v[128:143], v[48:51], v[64:67], v[128:143]
    v_mfma_f32_32x32x16_bf16 v[144:159], v[48:51], v[68:71], v[144:159]
    v_mfma_f32_32x32x16_bf16 v[160:175], v[52:55], v[64:67], v[160:175]
    v_mfma_f32_32x32x16_bf16 v[176:191], v[52:55], v[68:71], v[176:191]
    ds_read_b128 v[48:51], v11 offset:32768
    ds_read_b128 v[52:55], v11 offset:36864
    ds_read_b128 v[64:67], v15 offset:32768
    ds_read_b128 v[68:71], v15 offset:36864
    s_waitcnt lgkmcnt(4)
    v_mfma_f32_32x32x16_bf16 v[128:143], v[24:27], v[40:43], v[128:143]
    v_mfma_f32_32x32x16_bf16 v[144:159], v[24:27], v[44:47], v[144:159]
    v_mfma_f32_32x32x16_bf16 v[160:175], v[28:31], v[40:43], v[160:175]
    v_mfma_f32_32x32x16_bf16 v[176:191], v[28:31], v[44:47], v[176:191]
    s_waitcnt lgkmcnt(0)
    v_mfma_f32_32x32x16_bf16 v[128:143], v[48:51], v[64:67], v[128:143]
    v_mfma_f32_32x32x16_bf16 v[144:159], v[48:51], v[68:71], v[144:159]
    v_mfma_f32_32x32x16_bf16 v[160:175], v[52:55], v[64:67], v[160:175]
    v_mfma_f32_32x32x16_bf16 v[176:191], v[52:55], v[68:71], v[176:191]
    s_barrier
    ds_read_b128 v[24:27], v8 offset:49152
    ds_read_b128 v[28:31], v8 offset:53248
    ds_read_b128 v[40:43], v16 offset:0
    ds_read_b128 v[44:47], v16 offset:4096
    ds_read_b128 v[48:51], v9 offset:49152
    ds_read_b128 v[52:55], v9 offset:53248
    ds_read_b128 v[64:67], v17 offset:0
    ds_read_b128 v[68:71], v17 offset:4096
    s_waitcnt lgkmcnt(4)
    v_mfma_f32_32x32x16_bf16 v[128:143], v[24:27], v[40:43], v[128:143]
    v_mfma_f32_32x32x16_bf16 v[144:159], v[24:27], v[44:47], v[144:159]
    v_mfma_f32_32x32x16_bf16 v[160:175], v[28:31], v[40:43], v[160:175]
    v_mfma_f32_32x32x16_bf16 v[176:191], v[28:31], v[44:47], v[176:191]
    ds_read_b128 v[24:27], v10 offset:49152
    ds_read_b128 v[28:31], v10 offset:53248
    ds_read_b128 v[40:43], v18 offset:0
    ds_read_b128 v[44:47], v18 offset:4096
    s_waitcnt lgkmcnt(4)
    v_mfma_f32_32x32x16_bf16 v[128:143], v[48:51], v[64:67], v[128:143]
    v_mfma_f32_32x32x16_bf16 v[144:159], v[48:51], v[68:71], v[144:159]
    v_mfma_f32_32x32x16_bf16 v[160:175], v[52:55], v[64:67], v[160:175]
    v_mfma_f32_32x32x16_bf16 v[176:191], v[52:55], v[68:71], v[176:191]
    ds_read_b128 v[48:51], v11 offset:49152
    ds_read_b128 v[52:55], v11 offset:53248
    ds_read_b128 v[64:67], v19 offset:0
    ds_read_b128 v[68:71], v19 offset:4096
    s_waitcnt lgkmcnt(4)
    v_mfma_f32_32x32x16_bf16 v[128:143], v[24:27], v[40:43], v[128:143]
    v_mfma_f32_32x32x16_bf16 v[144:159], v[24:27], v[44:47], v[144:159]
    v_mfma_f32_32x32x16_bf16 v[160:175], v[28:31], v[40:43], v[160:175]
    v_mfma_f32_32x32x16_bf16 v[176:191], v[28:31], v[44:47], v[176:191]
    s_waitcnt lgkmcnt(0)
    v_mfma_f32_32x32x16_bf16 v[128:143], v[48:51], v[64:67], v[128:143]
    v_mfma_f32_32x32x16_bf16 v[144:159], v[48:51], v[68:71], v[144:159]
    v_mfma_f32_32x32x16_bf16 v[160:175], v[52:55], v[64:67], v[160:175]
    v_mfma_f32_32x32x16_bf16 v[176:191], v[52:55], v[68:71], v[176:191]
    s_barrier
    ds_read_b128 v[24:27], v8 offset:16384
    ds_read_b128 v[28:31], v8 offset:20480
    ds_read_b128 v[40:43], v12 offset:0
    ds_read_b128 v[44:47], v12 offset:4096
    ds_read_b128 v[48:51], v9 offset:16384
    ds_read_b128 v[52:55], v9 offset:20480
    ds_read_b128 v[64:67], v13 offset:0
    ds_read_b128 v[68:71], v13 offset:4096
    s_waitcnt lgkmcnt(4)
    v_mfma_f32_32x32x16_bf16 v[128:143], v[24:27], v[40:43], v[128:143]
    v_mfma_f32_32x32x16_bf16 v[144:159], v[24:27], v[44:47], v[144:159]
    v_mfma_f32_32x32x16_bf16 v[160:175], v[28:31], v[40:43], v[160:175]
    v_mfma_f32_32x32x16_bf16 v[176:191], v[28:31], v[44:47], v[176:191]
    ds_read_b128 v[24:27], v10 offset:16384
    ds_read_b128 v[28:31], v10 offset:20480
    ds_read_b128 v[40:43], v14 offset:0
    ds_read_b128 v[44:47], v14 offset:4096
    s_waitcnt lgkmcnt(4)
    v_mfma_f32_32x32x16_bf16 v[128:143], v[48:51], v[64:67], v[128:143]
    v_mfma_f32_32x32x16_bf16 v[144:159], v[48:51], v[68:71], v[144:159]
    v_mfma_f32_32x32x16_bf16 v[160:175], v[52:55], v[64:67], v[160:175]
    v_mfma_f32_32x32x16_bf16 v[176:191], v[52:55], v[68:71], v[176:191]
    ds_read_b128 v[48:51], v11 offset:16384
    ds_read_b128 v[52:55], v11 offset:20480
    ds_read_b128 v[64:67], v15 offset:0
    ds_read_b128 v[68:71], v15 offset:4096
    s_waitcnt lgkmcnt(4)
    v_mfma_f32_32x32x16_bf16 v[128:143], v[24:27], v[40:43], v[128:143]
    v_mfma_f32_32x32x16_bf16 v[144:159], v[24:27], v[44:47], v[144:159]
    v_mfma_f32_32x32x16_bf16 v[160:175], v[28:31], v[40:43], v[160:175]
    v_mfma_f32_32x32x16_bf16 v[176:191], v[28:31], v[44:47], v[176:191]
    s_waitcnt lgkmcnt(0)
    v_mfma_f32_32x32x16_bf16 v[128:143], v[48:51], v[64:67], v[128:143]
    v_mfma_f32_32x32x16_bf16 v[144:159], v[48:51], v[68:71], v[144:159]
    v_mfma_f32_32x32x16_bf16 v[160:175], v[52:55], v[64:67], v[160:175]
    v_mfma_f32_32x32x16_bf16 v[176:191], v[52:55], v[68:71], v[176:191]
    s_barrier
    ds_read_b128 v[24:27], v8 offset:32768
    ds_read_b128 v[28:31], v8 offset:36864
    ds_read_b128 v[40:43], v12 offset:32768
    ds_read_b128 v[44:47], v12 offset:36864
    ds_read_b128 v[48:51], v9 offset:32768
    ds_read_b128 v[52:55], v9 offset:36864
    ds_read_b128 v[64:67], v13 offset:32768
    ds_read_b128 v[68:71], v13 offset:36864
    s_waitcnt lgkmcnt(4)
    v_mfma_f32_32x32x16_bf16 v[128:143], v[24:27], v[40:43], v[128:143]
    v_mfma_f32_32x32x16_bf16 v[144:159], v[24:27], v[44:47], v[144:159]
    v_mfma_f32_32x32x16_bf16 v[160:175], v[28:31], v[40:43], v[160:175]
    v_mfma_f32_32x32x16_bf16 v[176:191], v[28:31], v[44:47], v[176:191]
    ds_read_b128 v[24:27], v10 offset:32768
    ds_read_b128 v[28:31], v10 offset:36864
    ds_read_b128 v[40:43], v14 offset:32768
    ds_read_b128 v[44:47], v14 offset:36864
    s_waitcnt lgkmcnt(4)
    v_mfma_f32_32x32x16_bf16 v[128:143], v[48:51], v[64:67], v[128:143]
    v_mfma_f32_32x32x16_bf16 v[144:159], v[48:51], v[68:71], v[144:159]
    v_mfma_f32_32x32x16_bf16 v[160:175], v[52:55], v[64:67], v[160:175]
    v_mfma_f32_32x32x16_bf16 v[176:191], v[52:55], v[68:71], v[176:191]
    ds_read_b128 v[48:51], v11 offset:32768
    ds_read_b128 v[52:55], v11 offset:36864
    ds_read_b128 v[64:67], v15 offset:32768
    ds_read_b128 v[68:71], v15 offset:36864
    s_waitcnt lgkmcnt(4)
    v_mfma_f32_32x32x16_bf16 v[128:143], v[24:27], v[40:43], v[128:143]
    v_mfma_f32_32x32x16_bf16 v[144:159], v[24:27], v[44:47], v[144:159]
    v_mfma_f32_32x32x16_bf16 v[160:175], v[28:31], v[40:43], v[160:175]
    v_mfma_f32_32x32x16_bf16 v[176:191], v[28:31], v[44:47], v[176:191]
    s_waitcnt lgkmcnt(0)
    v_mfma_f32_32x32x16_bf16 v[128:143], v[48:51], v[64:67], v[128:143]
    v_mfma_f32_32x32x16_bf16 v[144:159], v[48:51], v[68:71], v[144:159]
    v_mfma_f32_32x32x16_bf16 v[160:175], v[52:55], v[64:67], v[160:175]
    v_mfma_f32_32x32x16_bf16 v[176:191], v[52:55], v[68:71], v[176:191]
    s_barrier
    ds_read_b128 v[24:27], v8 offset:49152
    ds_read_b128 v[28:31], v8 offset:53248
    ds_read_b128 v[40:43], v16 offset:0
    ds_read_b128 v[44:47], v16 offset:4096
    ds_read_b128 v[48:51], v9 offset:49152
    ds_read_b128 v[52:55], v9 offset:53248
    ds_read_b128 v[64:67], v17 offset:0
    ds_read_b128 v[68:71], v17 offset:4096
    s_waitcnt lgkmcnt(4)
    v_mfma_f32_32x32x16_bf16 v[128:143], v[24:27], v[40:43], v[128:143]
    v_mfma_f32_32x32x16_bf16 v[144:159], v[24:27], v[44:47], v[144:159]
    v_mfma_f32_32x32x16_bf16 v[160:175], v[28:31], v[40:43], v[160:175]
    v_mfma_f32_32x32x16_bf16 v[176:191], v[28:31], v[44:47], v[176:191]
    ds_read_b128 v[24:27], v10 offset:49152
    ds_read_b128 v[28:31], v10 offset:53248
    ds_read_b128 v[40:43], v18 offset:0
    ds_read_b128 v[44:47], v18 offset:4096
    s_waitcnt lgkmcnt(4)
    v_mfma_f32_32x32x16_bf16 v[128:143], v[48:51], v[64:67], v[128:143]
    v_mfma_f32_32x32x16_bf16 v[144:159], v[48:51], v[68:71], v[144:159]
    v_mfma_f32_32x32x16_bf16 v[160:175], v[52:55], v[64:67], v[160:175]
    v_mfma_f32_32x32x16_bf16 v[176:191], v[52:55], v[68:71], v[176:191]
    ds_read_b128 v[48:51], v11 offset:49152
    ds_read_b128 v[52:55], v11 offset:53248
    ds_read_b128 v[64:67], v19 offset:0
    ds_read_b128 v[68:71], v19 offset:4096
    s_waitcnt lgkmcnt(4)
    v_mfma_f32_32x32x16_bf16 v[128:143], v[24:27], v[40:43], v[128:143]
    v_mfma_f32_32x32x16_bf16 v[144:159], v[24:27], v[44:47], v[144:159]
    v_mfma_f32_32x32x16_bf16 v[160:175], v[28:31], v[40:43], v[160:175]
    v_mfma_f32_32x32x16_bf16 v[176:191], v[28:31], v[44:47], v[176:191]
    s_waitcnt lgkmcnt(0)
    v_mfma_f32_32x32x16_bf16 v[128:143], v[48:51], v[64:67], v[128:143]
    v_mfma_f32_32x32x16_bf16 v[144:159], v[48:51], v[68:71], v[144:159]
    v_mfma_f32_32x32x16_bf16 v[160:175], v[52:55], v[64:67], v[160:175]
    v_mfma_f32_32x32x16_bf16 v[176:191], v[52:55], v[68:71], v[176:191]
    s_barrier
    ds_read_b128 v[24:27], v8 offset:16384
    ds_read_b128 v[28:31], v8 offset:20480
    ds_read_b128 v[40:43], v12 offset:0
    ds_read_b128 v[44:47], v12 offset:4096
    ds_read_b128 v[48:51], v9 offset:16384
    ds_read_b128 v[52:55], v9 offset:20480
    ds_read_b128 v[64:67], v13 offset:0
    ds_read_b128 v[68:71], v13 offset:4096
    s_waitcnt lgkmcnt(4)
    v_mfma_f32_32x32x16_bf16 v[128:143], v[24:27], v[40:43], v[128:143]
    v_mfma_f32_32x32x16_bf16 v[144:159], v[24:27], v[44:47], v[144:159]
    v_mfma_f32_32x32x16_bf16 v[160:175], v[28:31], v[40:43], v[160:175]
    v_mfma_f32_32x32x16_bf16 v[176:191], v[28:31], v[44:47], v[176:191]
    ds_read_b128 v[24:27], v10 offset:16384
    ds_read_b128 v[28:31], v10 offset:20480
    ds_read_b128 v[40:43], v14 offset:0
    ds_read_b128 v[44:47], v14 offset:4096
    s_waitcnt lgkmcnt(4)
    v_mfma_f32_32x32x16_bf16 v[128:143], v[48:51], v[64:67], v[128:143]
    v_mfma_f32_32x32x16_bf16 v[144:159], v[48:51], v[68:71], v[144:159]
    v_mfma_f32_32x32x16_bf16 v[160:175], v[52:55], v[64:67], v[160:175]
    v_mfma_f32_32x32x16_bf16 v[176:191], v[52:55], v[68:71], v[176:191]
    ds_read_b128 v[48:51], v11 offset:16384
    ds_read_b128 v[52:55], v11 offset:20480
    ds_read_b128 v[64:67], v15 offset:0
    ds_read_b128 v[68:71], v15 offset:4096
    s_waitcnt lgkmcnt(4)
    v_mfma_f32_32x32x16_bf16 v[128:143], v[24:27], v[40:43], v[128:143]
    v_mfma_f32_32x32x16_bf16 v[144:159], v[24:27], v[44:47], v[144:159]
    v_mfma_f32_32x32x16_bf16 v[160:175], v[28:31], v[40:43], v[160:175]
    v_mfma_f32_32x32x16_bf16 v[176:191], v[28:31], v[44:47], v[176:191]
    s_waitcnt lgkmcnt(0)
    v_mfma_f32_32x32x16_bf16 v[128:143], v[48:51], v[64:67], v[128:143]
    v_mfma_f32_32x32x16_bf16 v[144:159], v[48:51], v[68:71], v[144:159]
    v_mfma_f32_32x32x16_bf16 v[160:175], v[52:55], v[64:67], v[160:175]
    v_mfma_f32_32x32x16_bf16 v[176:191], v[52:55], v[68:71], v[176:191]
    s_barrier
    ds_read_b128 v[24:27], v8 offset:32768
    ds_read_b128 v[28:31], v8 offset:36864
    ds_read_b128 v[40:43], v12 offset:32768
    ds_read_b128 v[44:47], v12 offset:36864
    ds_read_b128 v[48:51], v9 offset:32768
    ds_read_b128 v[52:55], v9 offset:36864
    ds_read_b128 v[64:67], v13 offset:32768
    ds_read_b128 v[68:71], v13 offset:36864
    s_waitcnt lgkmcnt(4)
    v_mfma_f32_32x32x16_bf16 v[128:143], v[24:27], v[40:43], v[128:143]
    v_mfma_f32_32x32x16_bf16 v[144:159], v[24:27], v[44:47], v[144:159]
    v_mfma_f32_32x32x16_bf16 v[160:175], v[28:31], v[40:43], v[160:175]
    v_mfma_f32_32x32x16_bf16 v[176:191], v[28:31], v[44:47], v[176:191]
    ds_read_b128 v[24:27], v10 offset:32768
    ds_read_b128 v[28:31], v10 offset:36864
    ds_read_b128 v[40:43], v14 offset:32768
    ds_read_b128 v[44:47], v14 offset:36864
    s_waitcnt lgkmcnt(4)
    v_mfma_f32_32x32x16_bf16 v[128:143], v[48:51], v[64:67], v[128:143]
    v_mfma_f32_32x32x16_bf16 v[144:159], v[48:51], v[68:71], v[144:159]
    v_mfma_f32_32x32x16_bf16 v[160:175], v[52:55], v[64:67], v[160:175]
    v_mfma_f32_32x32x16_bf16 v[176:191], v[52:55], v[68:71], v[176:191]
    ds_read_b128 v[48:51], v11 offset:32768
    ds_read_b128 v[52:55], v11 offset:36864
    ds_read_b128 v[64:67], v15 offset:32768
    ds_read_b128 v[68:71], v15 offset:36864
    s_waitcnt lgkmcnt(4)
    v_mfma_f32_32x32x16_bf16 v[128:143], v[24:27], v[40:43], v[128:143]
    v_mfma_f32_32x32x16_bf16 v[144:159], v[24:27], v[44:47], v[144:159]
    v_mfma_f32_32x32x16_bf16 v[160:175], v[28:31], v[40:43], v[160:175]
    v_mfma_f32_32x32x16_bf16 v[176:191], v[28:31], v[44:47], v[176:191]
    s_waitcnt lgkmcnt(0)
    v_mfma_f32_32x32x16_bf16 v[128:143], v[48:51], v[64:67], v[128:143]
    v_mfma_f32_32x32x16_bf16 v[144:159], v[48:51], v[68:71], v[144:159]
    v_mfma_f32_32x32x16_bf16 v[160:175], v[52:55], v[64:67], v[160:175]
    v_mfma_f32_32x32x16_bf16 v[176:191], v[52:55], v[68:71], v[176:191]
    s_barrier
    ds_read_b128 v[24:27], v8 offset:49152
    ds_read_b128 v[28:31], v8 offset:53248
    ds_read_b128 v[40:43], v16 offset:0
    ds_read_b128 v[44:47], v16 offset:4096
    ds_read_b128 v[48:51], v9 offset:49152
    ds_read_b128 v[52:55], v9 offset:53248
    ds_read_b128 v[64:67], v17 offset:0
    ds_read_b128 v[68:71], v17 offset:4096
    s_waitcnt lgkmcnt(4)
    v_mfma_f32_32x32x16_bf16 v[128:143], v[24:27], v[40:43], v[128:143]
    v_mfma_f32_32x32x16_bf16 v[144:159], v[24:27], v[44:47], v[144:159]
    v_mfma_f32_32x32x16_bf16 v[160:175], v[28:31], v[40:43], v[160:175]
    v_mfma_f32_32x32x16_bf16 v[176:191], v[28:31], v[44:47], v[176:191]
    ds_read_b128 v[24:27], v10 offset:49152
    ds_read_b128 v[28:31], v10 offset:53248
    ds_read_b128 v[40:43], v18 offset:0
    ds_read_b128 v[44:47], v18 offset:4096
    s_waitcnt lgkmcnt(4)
    v_mfma_f32_32x32x16_bf16 v[128:143], v[48:51], v[64:67], v[128:143]
    v_mfma_f32_32x32x16_bf16 v[144:159], v[48:51], v[68:71], v[144:159]
    v_mfma_f32_32x32x16_bf16 v[160:175], v[52:55], v[64:67], v[160:175]
    v_mfma_f32_32x32x16_bf16 v[176:191], v[52:55], v[68:71], v[176:191]
    ds_read_b128 v[48:51], v11 offset:49152
    ds_read_b128 v[52:55], v11 offset:53248
    ds_read_b128 v[64:67], v19 offset:0
    ds_read_b128 v[68:71], v19 offset:4096
    s_waitcnt lgkmcnt(4)
    v_mfma_f32_32x32x16_bf16 v[128:143], v[24:27], v[40:43], v[128:143]
    v_mfma_f32_32x32x16_bf16 v[144:159], v[24:27], v[44:47], v[144:159]
    v_mfma_f32_32x32x16_bf16 v[160:175], v[28:31], v[40:43], v[160:175]
    v_mfma_f32_32x32x16_bf16 v[176:191], v[28:31], v[44:47], v[176:191]
    s_waitcnt lgkmcnt(0)
    v_mfma_f32_32x32x16_bf16 v[128:143], v[48:51], v[64:67], v[128:143]
    v_mfma_f32_32x32x16_bf16 v[144:159], v[48:51], v[68:71], v[144:159]
    v_mfma_f32_32x32x16_bf16 v[160:175], v[52:55], v[64:67], v[160:175]
    v_mfma_f32_32x32x16_bf16 v[176:191], v[52:55], v[68:71], v[176:191]
    s_barrier
    ds_read_b128 v[24:27], v8 offset:16384
    ds_read_b128 v[28:31], v8 offset:20480
    ds_read_b128 v[40:43], v12 offset:0
    ds_read_b128 v[44:47], v12 offset:4096
    ds_read_b128 v[48:51], v9 offset:16384
    ds_read_b128 v[52:55], v9 offset:20480
    ds_read_b128 v[64:67], v13 offset:0
    ds_read_b128 v[68:71], v13 offset:4096
    s_waitcnt lgkmcnt(4)
    v_mfma_f32_32x32x16_bf16 v[128:143], v[24:27], v[40:43], v[128:143]
    v_mfma_f32_32x32x16_bf16 v[144:159], v[24:27], v[44:47], v[144:159]
    v_mfma_f32_32x32x16_bf16 v[160:175], v[28:31], v[40:43], v[160:175]
    v_mfma_f32_32x32x16_bf16 v[176:191], v[28:31], v[44:47], v[176:191]
    ds_read_b128 v[24:27], v10 offset:16384
    ds_read_b128 v[28:31], v10 offset:20480
    ds_read_b128 v[40:43], v14 offset:0
    ds_read_b128 v[44:47], v14 offset:4096
    s_waitcnt lgkmcnt(4)
    v_mfma_f32_32x32x16_bf16 v[128:143], v[48:51], v[64:67], v[128:143]
    v_mfma_f32_32x32x16_bf16 v[144:159], v[48:51], v[68:71], v[144:159]
    v_mfma_f32_32x32x16_bf16 v[160:175], v[52:55], v[64:67], v[160:175]
    v_mfma_f32_32x32x16_bf16 v[176:191], v[52:55], v[68:71], v[176:191]
    ds_read_b128 v[48:51], v11 offset:16384
    ds_read_b128 v[52:55], v11 offset:20480
    ds_read_b128 v[64:67], v15 offset:0
    ds_read_b128 v[68:71], v15 offset:4096
    s_waitcnt lgkmcnt(4)
    v_mfma_f32_32x32x16_bf16 v[128:143], v[24:27], v[40:43], v[128:143]
    v_mfma_f32_32x32x16_bf16 v[144:159], v[24:27], v[44:47], v[144:159]
    v_mfma_f32_32x32x16_bf16 v[160:175], v[28:31], v[40:43], v[160:175]
    v_mfma_f32_32x32x16_bf16 v[176:191], v[28:31], v[44:47], v[176:191]
    s_waitcnt lgkmcnt(0)
    v_mfma_f32_32x32x16_bf16 v[128:143], v[48:51], v[64:67], v[128:143]
    v_mfma_f32_32x32x16_bf16 v[144:159], v[48:51], v[68:71], v[144:159]
    v_mfma_f32_32x32x16_bf16 v[160:175], v[52:55], v[64:67], v[160:175]
    v_mfma_f32_32x32x16_bf16 v[176:191], v[52:55], v[68:71], v[176:191]
    global_load_dword v83, v82, s[94:95] sc1
    s_nop 15
    v_fma_f32 v129, -v81, v144, v129
    v_fma_f32 v145, v81, v128, v145
    v_fma_f32 v129, v80, v128, v129
    v_fma_f32 v145, v80, v144, v145
    v_fma_f32 v130, -v81, v145, v130
    v_fma_f32 v146, v81, v129, v146
    v_fma_f32 v130, v80, v129, v130
    v_fma_f32 v146, v80, v145, v146
    v_fma_f32 v131, -v81, v146, v131
    v_fma_f32 v147, v81, v130, v147
    v_fma_f32 v131, v80, v130, v131
    v_fma_f32 v147, v80, v146, v147
    v_fma_f32 v132, -v81, v147, v132
    v_fma_f32 v148, v81, v131, v148
    v_fma_f32 v132, v80, v131, v132
    v_fma_f32 v148, v80, v147, v148
    v_fma_f32 v133, -v81, v148, v133
    v_fma_f32 v149, v81, v132, v149
    v_fma_f32 v133, v80, v132, v133
    v_fma_f32 v149, v80, v148, v149
    v_fma_f32 v134, -v81, v149, v134
    v_fma_f32 v150, v81, v133, v150
    v_fma_f32 v134, v80, v133, v134
    v_fma_f32 v150, v80, v149, v150
    v_fma_f32 v135, -v81, v150, v135
    v_fma_f32 v151, v81, v134, v151
    v_fma_f32 v135, v80, v134, v135
    v_fma_f32 v151, v80, v150, v151
    v_fma_f32 v136, -v81, v151, v136
    v_fma_f32 v152, v81, v135, v152
    v_fma_f32 v136, v80, v135, v136
    v_fma_f32 v152, v80, v151, v152
    v_fma_f32 v137, -v81, v152, v137
    v_fma_f32 v153, v81, v136, v153
    v_fma_f32 v137, v80, v136, v137
    v_fma_f32 v153, v80, v152, v153
    v_fma_f32 v138, -v81, v153, v138
    v_fma_f32 v154, v81, v137, v154
    v_fma_f32 v138, v80, v137, v138
    v_fma_f32 v154, v80, v153, v154
    v_fma_f32 v139, -v81, v154, v139
    v_fma_f32 v155, v81, v138, v155
    v_fma_f32 v139, v80, v138, v139
    v_fma_f32 v155, v80, v154, v155
    v_fma_f32 v140, -v81, v155, v140
    v_fma_f32 v156, v81, v139, v156
    v_fma_f32 v140, v80, v139, v140
    v_fma_f32 v156, v80, v155, v156
    v_fma_f32 v141, -v81, v156, v141
    v_fma_f32 v157, v81, v140, v157
    v_fma_f32 v141, v80, v140, v141
    v_fma_f32 v157, v80, v156, v157
    v_fma_f32 v142, -v81, v157, v142
    v_fma_f32 v158, v81, v141, v158
    v_fma_f32 v142, v80, v141, v142
    v_fma_f32 v158, v80, v157, v158
    v_fma_f32 v143, -v81, v158, v143
    v_fma_f32 v159, v81, v142, v159
    v_fma_f32 v143, v80, v142, v143
    v_fma_f32 v159, v80, v158, v159
    v_fma_f32 v160, -v81, v159, v160
    v_fma_f32 v176, v81, v143, v176
    v_fma_f32 v160, v80, v143, v160
    v_fma_f32 v176, v80, v159, v176
    v_fma_f32 v161, -v81, v176, v161
    v_fma_f32 v177, v81, v160, v177
    v_fma_f32 v161, v80, v160, v161
    v_fma_f32 v177, v80, v176, v177
    v_fma_f32 v162, -v81, v177, v162
    v_fma_f32 v178, v81, v161, v178
    v_fma_f32 v162, v80, v161, v162
    v_fma_f32 v178, v80, v177, v178
    v_fma_f32 v163, -v81, v178, v163
    v_fma_f32 v179, v81, v162, v179
    v_fma_f32 v163, v80, v162, v163
    v_fma_f32 v179, v80, v178, v179
    v_fma_f32 v164, -v81, v179, v164
    v_fma_f32 v180, v81, v163, v180
    v_fma_f32 v164, v80, v163, v164
    v_fma_f32 v180, v80, v179, v180
    v_fma_f32 v165, -v81, v180, v165
    v_fma_f32 v181, v81, v164, v181
    v_fma_f32 v165, v80, v164, v165
    v_fma_f32 v181, v80, v180, v181
    v_fma_f32 v166, -v81, v181, v166
    v_fma_f32 v182, v81, v165, v182
    v_fma_f32 v166, v80, v165, v166
    v_fma_f32 v182, v80, v181, v182
    v_fma_f32 v167, -v81, v182, v167
    v_fma_f32 v183, v81, v166, v183
    v_fma_f32 v167, v80, v166, v167
    v_fma_f32 v183, v80, v182, v183
    v_fma_f32 v168, -v81, v183, v168
    v_fma_f32 v184, v81, v167, v184
    v_fma_f32 v168, v80, v167, v168
    v_fma_f32 v184, v80, v183, v184
    v_fma_f32 v169, -v81, v184, v169
    v_fma_f32 v185, v81, v168, v185
    v_fma_f32 v169, v80, v168, v169
    v_fma_f32 v185, v80, v184, v185
    v_fma_f32 v170, -v81, v185, v170
    v_fma_f32 v186, v81, v169, v186
    v_fma_f32 v170, v80, v169, v170
    v_fma_f32 v186, v80, v185, v186
    v_fma_f32 v171, -v81, v186, v171
    v_fma_f32 v187, v81, v170, v187
    v_fma_f32 v171, v80, v170, v171
    v_fma_f32 v187, v80, v186, v187
    v_fma_f32 v172, -v81, v187, v172
    v_fma_f32 v188, v81, v171, v188
    v_fma_f32 v172, v80, v171, v172
    v_fma_f32 v188, v80, v187, v188
    v_fma_f32 v173, -v81, v188, v173
    v_fma_f32 v189, v81, v172, v189
    v_fma_f32 v173, v80, v172, v173
    v_fma_f32 v189, v80, v188, v189
    v_fma_f32 v174, -v81, v189, v174
    v_fma_f32 v190, v81, v173, v190
    v_fma_f32 v174, v80, v173, v174
    v_fma_f32 v190, v80, v189, v190
    v_fma_f32 v175, -v81, v190, v175
    v_fma_f32 v191, v81, v174, v191
    v_fma_f32 v175, v80, v174, v175
    v_fma_f32 v191, v80, v190, v191
    v_and_b32 v56, 31, v1
    s_lshl_b32 s30, s46, 5
    v_add_u32 v56, s30, v56
    v_lshlrev_b32 v56, 3, v56
    v_lshl_add_u32 v57, v72, 9, v56
    s_lshl_b32 s30, s47, 10
    v_add_u32 v57, s30, v57
    v_mov_b32 v48, v175
    v_mov_b32 v49, v191
    ds_write_b64 v57, v[48:49]
    s_waitcnt lgkmcnt(0)
    s_barrier
    ds_read_b64 v[40:41], v56 offset:0
    ds_read_b64 v[42:43], v56 offset:512
    ds_read_b64 v[44:45], v56 offset:1024
    ds_read_b64 v[46:47], v56 offset:1536
    v_lshlrev_b32 v56, 3, v75
    v_add_u32 v56, 33554432, v56
    s_mul_i32 s31, s24, 5120
    s_waitcnt lgkmcnt(0)
    v_fma_f32 v52, -v87, v41, v42
    v_fma_f32 v53, v87, v40, v43
    v_fma_f32 v48, v86, v40, v52
    v_fma_f32 v49, v86, v41, v53
    v_fma_f32 v52, -v87, v49, v44
    v_fma_f32 v53, v87, v48, v45
    v_fma_f32 v48, v86, v48, v52
    v_fma_f32 v49, v86, v49, v53
    v_fma_f32 v52, -v87, v49, v46
    v_fma_f32 v53, v87, v48, v47
    v_fma_f32 v48, v86, v48, v52
    v_fma_f32 v49, v86, v49, v53
    s_cmp_lg_u32 s47, 0
    s_cbranch_scc1 K1_U_NOPUB
    buffer_store_dwordx2 v[48:49], v56, s[20:23], s31 offen sc1
K1_U_NOPUB:
    v_mul_f32 v58, v85, v144
    v_mul_f32 v59, v85, v128
    v_fma_f32 v128, v84, v128, -v58
    v_fma_f32 v144, -v84, v144, -v59
    v_mul_f32 v58, v85, v145
    v_mul_f32 v59, v85, v129
    v_fma_f32 v129, v84, v129, -v58
    v_fma_f32 v145, -v84, v145, -v59
    v_mul_f32 v58, v85, v146
    v_mul_f32 v59, v85, v130
    v_fma_f32 v130, v84, v130, -v58
    v_fma_f32 v146, -v84, v146, -v59
    v_mul_f32 v58, v85, v147
    v_mul_f32 v59, v85, v131
    v_fma_f32 v131, v84, v131, -v58
    v_fma_f32 v147, -v84, v147, -v59
    v_mul_f32 v58, v85, v148
    v_mul_f32 v59, v85, v132
    v_fma_f32 v132, v84, v132, -v58
    v_fma_f32 v148, -v84, v148, -v59
    v_mul_f32 v58, v85, v149
    v_mul_f32 v59, v85, v133
    v_fma_f32 v133, v84, v133, -v58
    v_fma_f32 v149, -v84, v149, -v59
    v_mul_f32 v58, v85, v150
    v_mul_f32 v59, v85, v134
    v_fma_f32 v134, v84, v134, -v58
    v_fma_f32 v150, -v84, v150, -v59
    v_mul_f32 v58, v85, v151
    v_mul_f32 v59, v85, v135
    v_fma_f32 v135, v84, v135, -v58
    v_fma_f32 v151, -v84, v151, -v59
    v_mul_f32 v58, v85, v152
    v_mul_f32 v59, v85, v136
    v_fma_f32 v136, v84, v136, -v58
    v_fma_f32 v152, -v84, v152, -v59
    v_mul_f32 v58, v85, v153
    v_mul_f32 v59, v85, v137
    v_fma_f32 v137, v84, v137, -v58
    v_fma_f32 v153, -v84, v153, -v59
    v_mul_f32 v58, v85, v154
    v_mul_f32 v59, v85, v138
    v_fma_f32 v138, v84, v138, -v58
    v_fma_f32 v154, -v84, v154, -v59
    v_mul_f32 v58, v85, v155
    v_mul_f32 v59, v85, v139
    v_fma_f32 v139, v84, v139, -v58
    v_fma_f32 v155, -v84, v155, -v59
    v_mul_f32 v58, v85, v156
    v_mul_f32 v59, v85, v140
    v_fma_f32 v140, v84, v140, -v58
    v_fma_f32 v156, -v84, v156, -v59
    v_mul_f32 v58, v85, v157
    v_mul_f32 v59, v85, v141
    v_fma_f32 v141, v84, v141, -v58
    v_fma_f32 v157, -v84, v157, -v59
    v_mul_f32 v58, v85, v158
    v_mul_f32 v59, v85, v142
    v_fma_f32 v142, v84, v142, -v58
    v_fma_f32 v158, -v84, v158, -v59
    v_mul_f32 v58, v85, v159
    v_mul_f32 v59, v85, v143
    v_fma_f32 v143, v84, v143, -v58
    v_fma_f32 v159, -v84, v159, -v59
    v_mul_f32 v58, v85, v176
    v_mul_f32 v59, v85, v160
    v_fma_f32 v160, v84, v160, -v58
    v_fma_f32 v176, -v84, v176, -v59
    v_mul_f32 v58, v85, v177
    v_mul_f32 v59, v85, v161
    v_fma_f32 v161, v84, v161, -v58
    v_fma_f32 v177, -v84, v177, -v59
    v_mul_f32 v58, v85, v178
    v_mul_f32 v59, v85, v162
    v_fma_f32 v162, v84, v162, -v58
    v_fma_f32 v178, -v84, v178, -v59
    v_mul_f32 v58, v85, v179
    v_mul_f32 v59, v85, v163
    v_fma_f32 v163, v84, v163, -v58
    v_fma_f32 v179, -v84, v179, -v59
    v_mul_f32 v58, v85, v180
    v_mul_f32 v59, v85, v164
    v_fma_f32 v164, v84, v164, -v58
    v_fma_f32 v180, -v84, v180, -v59
    v_mul_f32 v58, v85, v181
    v_mul_f32 v59, v85, v165
    v_fma_f32 v165, v84, v165, -v58
    v_fma_f32 v181, -v84, v181, -v59
    v_mul_f32 v58, v85, v182
    v_mul_f32 v59, v85, v166
    v_fma_f32 v166, v84, v166, -v58
    v_fma_f32 v182, -v84, v182, -v59
    v_mul_f32 v58, v85, v183
    v_mul_f32 v59, v85, v167
    v_fma_f32 v167, v84, v167, -v58
    v_fma_f32 v183, -v84, v183, -v59
    v_mul_f32 v58, v85, v184
    v_mul_f32 v59, v85, v168
    v_fma_f32 v168, v84, v168, -v58
    v_fma_f32 v184, -v84, v184, -v59
    v_mul_f32 v58, v85, v185
    v_mul_f32 v59, v85, v169
    v_fma_f32 v169, v84, v169, -v58
    v_fma_f32 v185, -v84, v185, -v59
    v_mul_f32 v58, v85, v186
    v_mul_f32 v59, v85, v170
    v_fma_f32 v170, v84, v170, -v58
    v_fma_f32 v186, -v84, v186, -v59
    v_mul_f32 v58, v85, v187
    v_mul_f32 v59, v85, v171
    v_fma_f32 v171, v84, v171, -v58
    v_fma_f32 v187, -v84, v187, -v59
    v_mul_f32 v58, v85, v188
    v_mul_f32 v59, v85, v172
    v_fma_f32 v172, v84, v172, -v58
    v_fma_f32 v188, -v84, v188, -v59
    v_mul_f32 v58, v85, v189
    v_mul_f32 v59, v85, v173
    v_fma_f32 v173, v84, v173, -v58
    v_fma_f32 v189, -v84, v189, -v59
    v_mul_f32 v58, v85, v190
    v_mul_f32 v59, v85, v174
    v_fma_f32 v174, v84, v174, -v58
    v_fma_f32 v190, -v84, v190, -v59
    v_mul_f32 v58, v85, v191
    v_mul_f32 v59, v85, v175
    v_fma_f32 v175, v84, v175, -v58
    v_fma_f32 v191, -v84, v191, -v59
    v_mov_b32 v50, 0
    v_mov_b32 v51, 0
    s_cmp_eq_u32 s24, 0
    s_cbranch_scc1 K1_U_CARRY
    s_mov_b32 s55, 0
K1_U_FPOLL:
    s_waitcnt vmcnt(0)
    v_readfirstlane_b32 s30, v83
    s_and_b32 s30, s30, s54
    s_cmp_eq_u32 s30, s54
    s_cbranch_scc1 K1_U_POLL
    s_add_u32 s55, s55, 1
    s_cmp_gt_u32 s55, 0x40000
    s_cbranch_scc1 K1_U_POLL
    s_sleep 1
    global_load_dword v83, v82, s[94:95] sc1
    s_branch K1_U_FPOLL
K1_U_POLL:
    s_mov_b32 s30, 0
    buffer_load_dwordx2 v[192:193], v56, s[20:23], s30 offen sc1
    s_cmp_le_u32 s24, 1
    s_cbranch_scc1 K1_U_ELD
    s_mov_b32 s30, 5120
    buffer_load_dwordx2 v[194:195], v56, s[20:23], s30 offen sc1
    s_cmp_le_u32 s24, 2
    s_cbranch_scc1 K1_U_ELD
    s_mov_b32 s30, 10240
    buffer_load_dwordx2 v[196:197], v56, s[20:23], s30 offen sc1
    s_cmp_le_u32 s24, 3
    s_cbranch_scc1 K1_U_ELD
    s_mov_b32 s30, 15360
    buffer_load_dwordx2 v[198:199], v56, s[20:23], s30 offen sc1
    s_cmp_le_u32 s24, 4
    s_cbranch_scc1 K1_U_ELD
    s_mov_b32 s30, 20480
    buffer_load_dwordx2 v[200:201], v56, s[20:23], s30 offen sc1
    s_cmp_le_u32 s24, 5
    s_cbranch_scc1 K1_U_ELD
    s_mov_b32 s30, 25600
    buffer_load_dwordx2 v[202:203], v56, s[20:23], s30 offen sc1
    s_cmp_le_u32 s24, 6
    s_cbranch_scc1 K1_U_ELD
    s_mov_b32 s30, 30720
    buffer_load_dwordx2 v[204:205], v56, s[20:23], s30 offen sc1
    s_cmp_le_u32 s24, 7
    s_cbranch_scc1 K1_U_ELD
    s_mov_b32 s30, 35840
    buffer_load_dwordx2 v[206:207], v56, s[20:23], s30 offen sc1
    s_cmp_le_u32 s24, 8
    s_cbranch_scc1 K1_U_ELD
    s_mov_b32 s30, 40960
    buffer_load_dwordx2 v[208:209], v56, s[20:23], s30 offen sc1
    s_cmp_le_u32 s24, 9
    s_cbranch_scc1 K1_U_ELD
    s_mov_b32 s30, 46080
    buffer_load_dwordx2 v[210:211], v56, s[20:23], s30 offen sc1
    s_cmp_le_u32 s24, 10
    s_cbranch_scc1 K1_U_ELD
    s_mov_b32 s30, 51200
    buffer_load_dwordx2 v[212:213], v56, s[20:23], s30 offen sc1
    s_cmp_le_u32 s24, 11
    s_cbranch_scc1 K1_U_ELD
    s_mov_b32 s30, 56320
    buffer_load_dwordx2 v[214:215], v56, s[20:23], s30 offen sc1
    s_cmp_le_u32 s24, 12
    s_cbranch_scc1 K1_U_ELD
    s_mov_b32 s30, 61440
    buffer_load_dwordx2 v[216:217], v56, s[20:23], s30 offen sc1
    s_cmp_le_u32 s24, 13
    s_cbranch_scc1 K1_U_ELD
    s_mov_b32 s30, 66560
    buffer_load_dwordx2 v[218:219], v56, s[20:23], s30 offen sc1
    s_cmp_le_u32 s24, 14
    s_cbranch_scc1 K1_U_ELD
    s_mov_b32 s30, 71680
    buffer_load_dwordx2 v[220:221], v56, s[20:23], s30 offen sc1
K1_U_ELD:
    s_mov_b64 s[56:57], 0
    s_waitcnt vmcnt(0)
    v_cmp_eq_u32 vcc, -1, v192
    s_or_b64 s[56:57], s[56:57], vcc
    s_cmp_le_u32 s24, 1
    s_cbranch_scc1 K1_U_CHK
    v_cmp_eq_u32 vcc, -1, v194
    s_or_b64 s[56:57], s[56:57], vcc
    s_cmp_le_u32 s24, 2
    s_cbranch_scc1 K1_U_CHK
    v_cmp_eq_u32 vcc, -1, v196
    s_or_b64 s[56:57], s[56:57], vcc
    s_cmp_le_u32 s24, 3
    s_cbranch_scc1 K1_U_CHK
    v_cmp_eq_u32 vcc, -1, v198
    s_or_b64 s[56:57], s[56:57], vcc
    s_cmp_le_u32 s24, 4
    s_cbranch_scc1 K1_U_CHK
    v_cmp_eq_u32 vcc, -1, v200
    s_or_b64 s[56:57], s[56:57], vcc
    s_cmp_le_u32 s24, 5
    s_cbranch_scc1 K1_U_CHK
    v_cmp_eq_u32 vcc, -1, v202
    s_or_b64 s[56:57], s[56:57], vcc
    s_cmp_le_u32 s24, 6
    s_cbranch_scc1 K1_U_CHK
    v_cmp_eq_u32 vcc, -1, v204
    s_or_b64 s[56:57], s[56:57], vcc
    s_cmp_le_u32 s24, 7
    s_cbranch_scc1 K1_U_CHK
    v_cmp_eq_u32 vcc, -1, v206
    s_or_b64 s[56:57], s[56:57], vcc
    s_cmp_le_u32 s24, 8
    s_cbranch_scc1 K1_U_CHK
    v_cmp_eq_u32 vcc, -1, v208
    s_or_b64 s[56:57], s[56:57], vcc
    s_cmp_le_u32 s24, 9
    s_cbranch_scc1 K1_U_CHK
    v_cmp_eq_u32 vcc, -1, v210
    s_or_b64 s[56:57], s[56:57], vcc
    s_cmp_le_u32 s24, 10
    s_cbranch_scc1 K1_U_CHK
    v_cmp_eq_u32 vcc, -1, v212
    s_or_b64 s[56:57], s[56:57], vcc
    s_cmp_le_u32 s24, 11
    s_cbranch_scc1 K1_U_CHK
    v_cmp_eq_u32 vcc, -1, v214
    s_or_b64 s[56:57], s[56:57], vcc
    s_cmp_le_u32 s24, 12
    s_cbranch_scc1 K1_U_CHK
    v_cmp_eq_u32 vcc, -1, v216
    s_or_b64 s[56:57], s[56:57], vcc
    s_cmp_le_u32 s24, 13
    s_cbranch_scc1 K1_U_CHK
    v_cmp_eq_u32 vcc, -1, v218
    s_or_b64 s[56:57], s[56:57], vcc
    s_cmp_le_u32 s24, 14
    s_cbranch_scc1 K1_U_CHK
    v_cmp_eq_u32 vcc, -1, v220
    s_or_b64 s[56:57], s[56:57], vcc
K1_U_CHK:
    s_cmp_eq_u64 s[56:57], 0
    s_cbranch_scc1 K1_U_GOT
    s_add_u32 s55, s55, 1
    s_cmp_gt_u32 s55, 0x40000
    s_cbranch_scc1 K1_U_GOT
    s_sleep 1
    s_branch K1_U_POLL
K1_U_GOT:
    v_fma_f32 v52, -v89, v51, v192
    v_fma_f32 v53, v89, v50, v193
    v_fma_f32 v50, v88, v50, v52
    v_fma_f32 v51, v88, v51, v53
    s_cmp_eq_u32 s24, 1
    s_cbranch_scc1 K1_U_CARRY
    v_fma_f32 v52, -v89, v51, v194
    v_fma_f32 v53, v89, v50, v195
    v_fma_f32 v50, v88, v50, v52
    v_fma_f32 v51, v88, v51, v53
    s_cmp_eq_u32 s24, 2
    s_cbranch_scc1 K1_U_CARRY
    v_fma_f32 v52, -v89, v51, v196
    v_fma_f32 v53, v89, v50, v197
    v_fma_f32 v50, v88, v50, v52
    v_fma_f32 v51, v88, v51, v53
    s_cmp_eq_u32 s24, 3
    s_cbranch_scc1 K1_U_CARRY
    v_fma_f32 v52, -v89, v51, v198
    v_fma_f32 v53, v89, v50, v199
    v_fma_f32 v50, v88, v50, v52
    v_fma_f32 v51, v88, v51, v53
    s_cmp_eq_u32 s24, 4
    s_cbranch_scc1 K1_U_CARRY
    v_fma_f32 v52, -v89, v51, v200
    v_fma_f32 v53, v89, v50, v201
    v_fma_f32 v50, v88, v50, v52
    v_fma_f32 v51, v88, v51, v53
    s_cmp_eq_u32 s24, 5
    s_cbranch_scc1 K1_U_CARRY
    v_fma_f32 v52, -v89, v51, v202
    v_fma_f32 v53, v89, v50, v203
    v_fma_f32 v50, v88, v50, v52
    v_fma_f32 v51, v88, v51, v53
    s_cmp_eq_u32 s24, 6
    s_cbranch_scc1 K1_U_CARRY
    v_fma_f32 v52, -v89, v51, v204
    v_fma_f32 v53, v89, v50, v205
    v_fma_f32 v50, v88, v50, v52
    v_fma_f32 v51, v88, v51, v53
    s_cmp_eq_u32 s24, 7
    s_cbranch_scc1 K1_U_CARRY
    v_fma_f32 v52, -v89, v51, v206
    v_fma_f32 v53, v89, v50, v207
    v_fma_f32 v50, v88, v50, v52
    v_fma_f32 v51, v88, v51, v53
    s_cmp_eq_u32 s24, 8
    s_cbranch_scc1 K1_U_CARRY
    v_fma_f32 v52, -v89, v51, v208
    v_fma_f32 v53, v89, v50, v209
    v_fma_f32 v50, v88, v50, v52
    v_fma_f32 v51, v88, v51, v53
    s_cmp_eq_u32 s24, 9
    s_cbranch_scc1 K1_U_CARRY
    v_fma_f32 v52, -v89, v51, v210
    v_fma_f32 v53, v89, v50, v211
    v_fma_f32 v50, v88, v50, v52
    v_fma_f32 v51, v88, v51, v53
    s_cmp_eq_u32 s24, 10
    s_cbranch_scc1 K1_U_CARRY
    v_fma_f32 v52, -v89, v51, v212
    v_fma_f32 v53, v89, v50, v213
    v_fma_f32 v50, v88, v50, v52
    v_fma_f32 v51, v88, v51, v53
    s_cmp_eq_u32 s24, 11
    s_cbranch_scc1 K1_U_CARRY
    v_fma_f32 v52, -v89, v51, v214
    v_fma_f32 v53, v89, v50, v215
    v_fma_f32 v50, v88, v50, v52
    v_fma_f32 v51, v88, v51, v53
    s_cmp_eq_u32 s24, 12
    s_cbranch_scc1 K1_U_CARRY
    v_fma_f32 v52, -v89, v51, v216
    v_fma_f32 v53, v89, v50, v217
    v_fma_f32 v50, v88, v50, v52
    v_fma_f32 v51, v88, v51, v53
    s_cmp_eq_u32 s24, 13
    s_cbranch_scc1 K1_U_CARRY
    v_fma_f32 v52, -v89, v51, v218
    v_fma_f32 v53, v89, v50, v219
    v_fma_f32 v50, v88, v50, v52
    v_fma_f32 v51, v88, v51, v53
    s_cmp_eq_u32 s24, 14
    s_cbranch_scc1 K1_U_CARRY
    v_fma_f32 v52, -v89, v51, v220
    v_fma_f32 v53, v89, v50, v221
    v_fma_f32 v50, v88, v50, v52
    v_fma_f32 v51, v88, v51, v53
    s_cmp_eq_u32 s24, 15
    s_cbranch_scc1 K1_U_CARRY
K1_U_CARRY:
    s_cmp_eq_u32 s47, 0
    s_cbranch_scc1 K1_U_RH0
    v_fma_f32 v52, -v87, v51, v40
    v_fma_f32 v53, v87, v50, v41
    v_fma_f32 v50, v86, v50, v52
    v_fma_f32 v51, v86, v51, v53
    v_fma_f32 v52, -v87, v51, v42
    v_fma_f32 v53, v87, v50, v43
    v_fma_f32 v50, v86, v50, v52
    v_fma_f32 v51, v86, v51, v53
    v_mov_b32 v40, v44
    v_mov_b32 v41, v45
K1_U_RH0:
    v_fma_f32 v52, -v87, v51, v40
    v_fma_f32 v53, v87, v50, v41
    v_fma_f32 v54, v86, v50, v52
    v_fma_f32 v55, v86, v51, v53
    v_cmp_eq_u32 vcc, 1, v72
    s_nop 1
    v_cndmask_b32 v50, v50, v54, vcc
    v_cndmask_b32 v51, v51, v55, vcc
    v_mul_f32 v52, v81, v51
    v_mul_f32 v53, v81, v50
    v_fma_f32 v54, v80, v50, -v52
    v_fma_f32 v55, v80, v51, v53
    v_and_b32 v56, 31, v1
    s_lshl_b32 s30, s46, 5
    v_add_u32 v56, s30, v56
    v_mul_u32_u24 v56, 272, v56
    v_lshl_add_u32 v56, v72, 6, v56
    s_lshl_b32 s31, s47, 7
    v_add_u32 v56, s31, v56
    v_mul_f32 v52, v85, v55
    v_mul_f32 v53, v85, v54
    v_fma_f32 v57, v84, v54, -v52
    v_fma_f32 v55, -v84, v55, -v53
    v_mov_b32 v54, v57
    v_add_f32 v128, v128, v54
    v_add_f32 v144, v144, v55
    v_mul_f32 v52, v81, v55
    v_mul_f32 v53, v81, v54
    v_fma_f32 v54, v80, v54, v52
    v_fma_f32 v55, v80, v55, -v53
    v_add_f32 v129, v129, v54
    v_add_f32 v145, v145, v55
    v_mul_f32 v52, v81, v55
    v_mul_f32 v53, v81, v54
    v_fma_f32 v54, v80, v54, v52
    v_fma_f32 v55, v80, v55, -v53
    v_add_f32 v130, v130, v54
    v_add_f32 v146, v146, v55
    v_mul_f32 v52, v81, v55
    v_mul_f32 v53, v81, v54
    v_fma_f32 v54, v80, v54, v52
    v_fma_f32 v55, v80, v55, -v53
    v_add_f32 v131, v131, v54
    v_add_f32 v147, v147, v55
    v_mul_f32 v52, v81, v55
    v_mul_f32 v53, v81, v54
    v_fma_f32 v54, v80, v54, v52
    v_fma_f32 v55, v80, v55, -v53
    v_add_f32 v132, v132, v54
    v_add_f32 v148, v148, v55
    v_mul_f32 v52, v81, v55
    v_mul_f32 v53, v81, v54
    v_fma_f32 v54, v80, v54, v52
    v_fma_f32 v55, v80, v55, -v53
    v_add_f32 v133, v133, v54
    v_add_f32 v149, v149, v55
    v_mul_f32 v52, v81, v55
    v_mul_f32 v53, v81, v54
    v_fma_f32 v54, v80, v54, v52
    v_fma_f32 v55, v80, v55, -v53
    v_add_f32 v134, v134, v54
    v_add_f32 v150, v150, v55
    v_mul_f32 v52, v81, v55
    v_mul_f32 v53, v81, v54
    v_fma_f32 v54, v80, v54, v52
    v_fma_f32 v55, v80, v55, -v53
    v_add_f32 v135, v135, v54
    v_add_f32 v151, v151, v55
    v_mul_f32 v52, v81, v55
    v_mul_f32 v53, v81, v54
    v_fma_f32 v54, v80, v54, v52
    v_fma_f32 v55, v80, v55, -v53
    v_cvt_pk_bf16_f32 v60, v128, v129
    v_cvt_pk_bf16_f32 v61, v130, v131
    v_cvt_pk_bf16_f32 v62, v132, v133
    v_cvt_pk_bf16_f32 v63, v134, v135
    ds_write_b128 v56, v[60:63] offset:16384
    v_cvt_pk_bf16_f32 v64, v144, v145
    v_cvt_pk_bf16_f32 v65, v146, v147
    v_cvt_pk_bf16_f32 v66, v148, v149
    v_cvt_pk_bf16_f32 v67, v150, v151
    ds_write_b128 v56, v[64:67] offset:33792
    v_add_f32 v136, v136, v54
    v_add_f32 v152, v152, v55
    v_mul_f32 v52, v81, v55
    v_mul_f32 v53, v81, v54
    v_fma_f32 v54, v80, v54, v52
    v_fma_f32 v55, v80, v55, -v53
    v_add_f32 v137, v137, v54
    v_add_f32 v153, v153, v55
    v_mul_f32 v52, v81, v55
    v_mul_f32 v53, v81, v54
    v_fma_f32 v54, v80, v54, v52
    v_fma_f32 v55, v80, v55, -v53
    v_add_f32 v138, v138, v54
    v_add_f32 v154, v154, v55
    v_mul_f32 v52, v81, v55
    v_mul_f32 v53, v81, v54
    v_fma_f32 v54, v80, v54, v52
    v_fma_f32 v55, v80, v55, -v53
    v_add_f32 v139, v139, v54
    v_add_f32 v155, v155, v55
    v_mul_f32 v52, v81, v55
    v_mul_f32 v53, v81, v54
    v_fma_f32 v54, v80, v54, v52
    v_fma_f32 v55, v80, v55, -v53
    v_add_f32 v140, v140, v54
    v_add_f32 v156, v156, v55
    v_mul_f32 v52, v81, v55
    v_mul_f32 v53, v81, v54
    v_fma_f32 v54, v80, v54, v52
    v_fma_f32 v55, v80, v55, -v53
    v_add_f32 v141, v141, v54
    v_add_f32 v157, v157, v55
    v_mul_f32 v52, v81, v55
    v_mul_f32 v53, v81, v54
    v_fma_f32 v54, v80, v54, v52
    v_fma_f32 v55, v80, v55, -v53
    v_add_f32 v142, v142, v54
    v_add_f32 v158, v158, v55
    v_mul_f32 v52, v81, v55
    v_mul_f32 v53, v81, v54
    v_fma_f32 v54, v80, v54, v52
    v_fma_f32 v55, v80, v55, -v53
    v_add_f32 v143, v143, v54
    v_add_f32 v159, v159, v55
    v_mul_f32 v52, v81, v55
    v_mul_f32 v53, v81, v54
    v_fma_f32 v54, v80, v54, v52
    v_fma_f32 v55, v80, v55, -v53
    v_cvt_pk_bf16_f32 v60, v136, v137
    v_cvt_pk_bf16_f32 v61, v138, v139
    v_cvt_pk_bf16_f32 v62, v140, v141
    v_cvt_pk_bf16_f32 v63, v142, v143
    ds_write_b128 v56, v[60:63] offset:16400
    v_cvt_pk_bf16_f32 v64, v152, v153
    v_cvt_pk_bf16_f32 v65, v154, v155
    v_cvt_pk_bf16_f32 v66, v156, v157
    v_cvt_pk_bf16_f32 v67, v158, v159
    ds_write_b128 v56, v[64:67] offset:33808
    v_add_f32 v160, v160, v54
    v_add_f32 v176, v176, v55
    v_mul_f32 v52, v81, v55
    v_mul_f32 v53, v81, v54
    v_fma_f32 v54, v80, v54, v52
    v_fma_f32 v55, v80, v55, -v53
    v_add_f32 v161, v161, v54
    v_add_f32 v177, v177, v55
    v_mul_f32 v52, v81, v55
    v_mul_f32 v53, v81, v54
    v_fma_f32 v54, v80, v54, v52
    v_fma_f32 v55, v80, v55, -v53
    v_add_f32 v162, v162, v54
    v_add_f32 v178, v178, v55
    v_mul_f32 v52, v81, v55
    v_mul_f32 v53, v81, v54
    v_fma_f32 v54, v80, v54, v52
    v_fma_f32 v55, v80, v55, -v53
    v_add_f32 v163, v163, v54
    v_add_f32 v179, v179, v55
    v_mul_f32 v52, v81, v55
    v_mul_f32 v53, v81, v54
    v_fma_f32 v54, v80, v54, v52
    v_fma_f32 v55, v80, v55, -v53
    v_add_f32 v164, v164, v54
    v_add_f32 v180, v180, v55
    v_mul_f32 v52, v81, v55
    v_mul_f32 v53, v81, v54
    v_fma_f32 v54, v80, v54, v52
    v_fma_f32 v55, v80, v55, -v53
    v_add_f32 v165, v165, v54
    v_add_f32 v181, v181, v55
    v_mul_f32 v52, v81, v55
    v_mul_f32 v53, v81, v54
    v_fma_f32 v54, v80, v54, v52
    v_fma_f32 v55, v80, v55, -v53
    v_add_f32 v166, v166, v54
    v_add_f32 v182, v182, v55
    v_mul_f32 v52, v81, v55
    v_mul_f32 v53, v81, v54
    v_fma_f32 v54, v80, v54, v52
    v_fma_f32 v55, v80, v55, -v53
    v_add_f32 v167, v167, v54
    v_add_f32 v183, v183, v55
    v_mul_f32 v52, v81, v55
    v_mul_f32 v53, v81, v54
    v_fma_f32 v54, v80, v54, v52
    v_fma_f32 v55, v80, v55, -v53
    v_cvt_pk_bf16_f32 v60, v160, v161
    v_cvt_pk_bf16_f32 v61, v162, v163
    v_cvt_pk_bf16_f32 v62, v164, v165
    v_cvt_pk_bf16_f32 v63, v166, v167
    ds_write_b128 v56, v[60:63] offset:16416
    v_cvt_pk_bf16_f32 v64, v176, v177
    v_cvt_pk_bf16_f32 v65, v178, v179
    v_cvt_pk_bf16_f32 v66, v180, v181
    v_cvt_pk_bf16_f32 v67, v182, v183
    ds_write_b128 v56, v[64:67] offset:33824
    v_add_f32 v168, v168, v54
    v_add_f32 v184, v184, v55
    v_mul_f32 v52, v81, v55
    v_mul_f32 v53, v81, v54
    v_fma_f32 v54, v80, v54, v52
    v_fma_f32 v55, v80, v55, -v53
    v_add_f32 v169, v169, v54
    v_add_f32 v185, v185, v55
    v_mul_f32 v52, v81, v55
    v_mul_f32 v53, v81, v54
    v_fma_f32 v54, v80, v54, v52
    v_fma_f32 v55, v80, v55, -v53
    v_add_f32 v170, v170, v54
    v_add_f32 v186, v186, v55
    v_mul_f32 v52, v81, v55
    v_mul_f32 v53, v81, v54
    v_fma_f32 v54, v80, v54, v52
    v_fma_f32 v55, v80, v55, -v53
    v_add_f32 v171, v171, v54
    v_add_f32 v187, v187, v55
    v_mul_f32 v52, v81, v55
    v_mul_f32 v53, v81, v54
    v_fma_f32 v54, v80, v54, v52
    v_fma_f32 v55, v80, v55, -v53
    v_add_f32 v172, v172, v54
    v_add_f32 v188, v188, v55
    v_mul_f32 v52, v81, v55
    v_mul_f32 v53, v81, v54
    v_fma_f32 v54, v80, v54, v52
    v_fma_f32 v55, v80, v55, -v53
    v_add_f32 v173, v173, v54
    v_add_f32 v189, v189, v55
    v_mul_f32 v52, v81, v55
    v_mul_f32 v53, v81, v54
    v_fma_f32 v54, v80, v54, v52
    v_fma_f32 v55, v80, v55, -v53
    v_add_f32 v174, v174, v54
    v_add_f32 v190, v190, v55
    v_mul_f32 v52, v81, v55
    v_mul_f32 v53, v81, v54
    v_fma_f32 v54, v80, v54, v52
    v_fma_f32 v55, v80, v55, -v53
    v_add_f32 v175, v175, v54
    v_add_f32 v191, v191, v55
    v_cvt_pk_bf16_f32 v60, v168, v169
    v_cvt_pk_bf16_f32 v61, v170, v171
    v_cvt_pk_bf16_f32 v62, v172, v173
    v_cvt_pk_bf16_f32 v63, v174, v175
    ds_write_b128 v56, v[60:63] offset:16432
    v_cvt_pk_bf16_f32 v64, v184, v185
    v_cvt_pk_bf16_f32 v65, v186, v187
    v_cvt_pk_bf16_f32 v66, v188, v189
    v_cvt_pk_bf16_f32 v67, v190, v191
    ds_write_b128 v56, v[64:67] offset:33840
    v_lshrrev_b32 v57, 4, v1
    v_bfe_u32 v58, v1, 2, 2
    v_lshl_add_u32 v57, v57, 3, v58
    v_add_u32 v57, s30, v57
    v_mul_u32_u24 v57, 272, v57
    v_and_b32 v58, 3, v1
    v_lshl_add_u32 v57, v58, 3, v57
    v_add_u32 v57, s31, v57
    v_lshlrev_b32 v58, 4, v1
    s_lshl_b32 s31, s24, 1
    s_add_u32 s31, s31, s47
    s_mul_i32 s31, s31, 40
    s_lshl_b32 s30, s25, 1
    s_add_u32 s31, s31, s30
    s_add_u32 s31, s31, s46
    s_lshl_b32 s31, s31, 12
    s_add_u32 s31, s31, 8388608
    s_waitcnt lgkmcnt(0)
    ds_read_b64_tr_b16 v[192:193], v57 offset:16384
    ds_read_b64_tr_b16 v[194:195], v57 offset:17472
    ds_read_b64_tr_b16 v[196:197], v57 offset:16416
    ds_read_b64_tr_b16 v[198:199], v57 offset:17504
    ds_read_b64_tr_b16 v[200:201], v57 offset:16448
    ds_read_b64_tr_b16 v[202:203], v57 offset:17536
    ds_read_b64_tr_b16 v[204:205], v57 offset:16480
    ds_read_b64_tr_b16 v[206:207], v57 offset:17568
    ds_read_b64_tr_b16 v[208:209], v57 offset:33792
    ds_read_b64_tr_b16 v[210:211], v57 offset:34880
    ds_read_b64_tr_b16 v[212:213], v57 offset:33824
    ds_read_b64_tr_b16 v[214:215], v57 offset:34912
    ds_read_b64_tr_b16 v[216:217], v57 offset:33856
    ds_read_b64_tr_b16 v[218:219], v57 offset:34944
    ds_read_b64_tr_b16 v[220:221], v57 offset:33888
    ds_read_b64_tr_b16 v[222:223], v57 offset:34976
    s_waitcnt lgkmcnt(14)
    s_add_u32 s30, s31, 0
    buffer_store_dwordx4 v[192:195], v58, s[20:23], s30 offen sc1
    s_waitcnt lgkmcnt(12)
    s_add_u32 s30, s31, 1024
    buffer_store_dwordx4 v[196:199], v58, s[20:23], s30 offen sc1
    s_waitcnt lgkmcnt(10)
    s_add_u32 s30, s31, 2048
    buffer_store_dwordx4 v[200:203], v58, s[20:23], s30 offen sc1
    s_waitcnt lgkmcnt(8)
    s_add_u32 s30, s31, 3072
    buffer_store_dwordx4 v[204:207], v58, s[20:23], s30 offen sc1
    s_waitcnt lgkmcnt(6)
    s_add_u32 s30, s31, 81920
    buffer_store_dwordx4 v[208:211], v58, s[20:23], s30 offen sc1
    s_waitcnt lgkmcnt(4)
    s_add_u32 s30, s31, 82944
    buffer_store_dwordx4 v[212:215], v58, s[20:23], s30 offen sc1
    s_waitcnt lgkmcnt(2)
    s_add_u32 s30, s31, 83968
    buffer_store_dwordx4 v[216:219], v58, s[20:23], s30 offen sc1
    s_waitcnt lgkmcnt(0)
    s_add_u32 s30, s31, 84992
    buffer_store_dwordx4 v[220:223], v58, s[20:23], s30 offen sc1
    s_branch K1_END
K1_ISMLP:
    s_mul_i32 s25, s46, 3
    s_add_u32 s25, s25, s43
    s_sub_u32 s25, s25, 5
    s_cmp_lt_u32 s52, 4
    s_cbranch_scc1 K1_MLP
    v_lshrrev_b32 v2, 3, v1
    v_lshrrev_b32 v3, 4, v1
    v_and_b32 v20, 7, v1
    v_xor_b32 v21, v20, v3
    v_xor_b32 v22, 4, v21
    v_lshlrev_b32 v21, 4, v21
    v_lshlrev_b32 v22, 4, v22
    s_movk_i32 s30, 1280
    v_mul_lo_u32 v74, v2, s30
    v_add_u32 v4, v74, v21
    v_add_u32 v5, v74, v22
    v_and_b32 v74, 31, v1
    v_lshlrev_b32 v75, 2, v72
    v_xor_b32 v74, v74, v75
    v_xor_b32 v75, 8, v74
    s_movk_i32 s30, 3072
    v_mul_lo_u32 v76, v72, s30
    v_lshl_add_u32 v6, v74, 4, v76
    v_lshl_add_u32 v7, v75, 4, v76
    s_lshl_b32 s26, s24, 7
    s_lshl_b32 s30, s3, 5
    s_add_u32 s26, s26, s30
    s_mul_i32 s26, s26, 1280
    s_mul_i32 s27, s3, 49152
    s_lshl_b32 s30, s25, 9
    s_add_u32 s27, s27, s30
    s_mov_b32 s12, s84
    s_and_b32 s13, s85, 0xffff
    s_mov_b32 s14, 1966080
    s_mov_b32 s15, 0x00020000
    s_add_u32 m0, s28, 16384
    s_add_u32 s30, s26, 0
    buffer_load_dwordx4 v4, s[8:11], s30 offen lds
    s_add_u32 m0, s28, 17408
    s_add_u32 s30, s26, 10240
    buffer_load_dwordx4 v5, s[8:11], s30 offen lds
    s_add_u32 m0, s28, 18432
    s_add_u32 s30, s26, 20480
    buffer_load_dwordx4 v4, s[8:11], s30 offen lds
    s_add_u32 m0, s28, 19456
    s_add_u32 s30, s26, 30720
    buffer_load_dwordx4 v5, s[8:11], s30 offen lds
    s_add_u32 m0, s29, 65536
    s_add_u32 s30, s27, 0
    buffer_load_dwordx4 v6, s[12:15], s30 offen lds
    s_add_u32 m0, s29, 66560
    s_add_u32 s30, s27, 6144
    buffer_load_dwordx4 v7, s[12:15], s30 offen lds
    s_add_u32 m0, s29, 67584
    s_add_u32 s30, s27, 12288
    buffer_load_dwordx4 v6, s[12:15], s30 offen lds
    s_add_u32 m0, s29, 68608
    s_add_u32 s30, s27, 18432
    buffer_load_dwordx4 v7, s[12:15], s30 offen lds
    s_add_u32 m0, s29, 69632
    s_add_u32 s30, s27, 24576
    buffer_load_dwordx4 v6, s[12:15], s30 offen lds
    s_add_u32 m0, s29, 70656
    s_add_u32 s30, s27, 30720
    buffer_load_dwordx4 v7, s[12:15], s30 offen lds
    s_add_u32 m0, s29, 71680
    s_add_u32 s30, s27, 36864
    buffer_load_dwordx4 v6, s[12:15], s30 offen lds
    s_add_u32 m0, s29, 72704
    s_add_u32 s30, s27, 43008
    buffer_load_dwordx4 v7, s[12:15], s30 offen lds
    s_add_u32 m0, s28, 32768
    s_add_u32 s30, s26, 128
    buffer_load_dwordx4 v4, s[8:11], s30 offen lds
    s_add_u32 m0, s28, 33792
    s_add_u32 s30, s26, 10368
    buffer_load_dwordx4 v5, s[8:11], s30 offen lds
    s_add_u32 m0, s28, 34816
    s_add_u32 s30, s26, 20608
    buffer_load_dwordx4 v4, s[8:11], s30 offen lds
    s_add_u32 m0, s28, 35840
    s_add_u32 s30, s26, 30848
    buffer_load_dwordx4 v5, s[8:11], s30 offen lds
    s_add_u32 m0, s29, 98304
    s_add_u32 s30, s27, 196608
    buffer_load_dwordx4 v6, s[12:15], s30 offen lds
    s_add_u32 m0, s29, 99328
    s_add_u32 s30, s27, 202752
    buffer_load_dwordx4 v7, s[12:15], s30 offen lds
    s_add_u32 m0, s29, 100352
    s_add_u32 s30, s27, 208896
    buffer_load_dwordx4 v6, s[12:15], s30 offen lds
    s_add_u32 m0, s29, 101376
    s_add_u32 s30, s27, 215040
    buffer_load_dwordx4 v7, s[12:15], s30 offen lds
    s_add_u32 m0, s29, 102400
    s_add_u32 s30, s27, 221184
    buffer_load_dwordx4 v6, s[12:15], s30 offen lds
    s_add_u32 m0, s29, 103424
    s_add_u32 s30, s27, 227328
    buffer_load_dwordx4 v7, s[12:15], s30 offen lds
    s_add_u32 m0, s29, 104448
    s_add_u32 s30, s27, 233472
    buffer_load_dwordx4 v6, s[12:15], s30 offen lds
    s_add_u32 m0, s29, 105472
    s_add_u32 s30, s27, 239616
    buffer_load_dwordx4 v7, s[12:15], s30 offen lds
    s_waitcnt vmcnt(12)
    s_barrier
    s_add_u32 m0, s28, 49152
    s_add_u32 s30, s26, 256
    buffer_load_dwordx4 v4, s[8:11], s30 offen lds
    s_add_u32 m0, s28, 50176
    s_add_u32 s30, s26, 10496
    buffer_load_dwordx4 v5, s[8:11], s30 offen lds
    s_add_u32 m0, s28, 51200
    s_add_u32 s30, s26, 20736
    buffer_load_dwordx4 v4, s[8:11], s30 offen lds
    s_add_u32 m0, s28, 52224
    s_add_u32 s30, s26, 30976
    buffer_load_dwordx4 v5, s[8:11], s30 offen lds
    s_add_u32 m0, s29, 131072
    s_add_u32 s30, s27, 393216
    buffer_load_dwordx4 v6, s[12:15], s30 offen lds
    s_add_u32 m0, s29, 132096
    s_add_u32 s30, s27, 399360
    buffer_load_dwordx4 v7, s[12:15], s30 offen lds
    s_add_u32 m0, s29, 133120
    s_add_u32 s30, s27, 405504
    buffer_load_dwordx4 v6, s[12:15], s30 offen lds
    s_add_u32 m0, s29, 134144
    s_add_u32 s30, s27, 411648
    buffer_load_dwordx4 v7, s[12:15], s30 offen lds
    s_add_u32 m0, s29, 135168
    s_add_u32 s30, s27, 417792
    buffer_load_dwordx4 v6, s[12:15], s30 offen lds
    s_add_u32 m0, s29, 136192
    s_add_u32 s30, s27, 423936
    buffer_load_dwordx4 v7, s[12:15], s30 offen lds
    s_add_u32 m0, s29, 137216
    s_add_u32 s30, s27, 430080
    buffer_load_dwordx4 v6, s[12:15], s30 offen lds
    s_add_u32 m0, s29, 138240
    s_add_u32 s30, s27, 436224
    buffer_load_dwordx4 v7, s[12:15], s30 offen lds
    s_waitcnt vmcnt(12)
    s_barrier
    s_add_u32 m0, s28, 16384
    s_add_u32 s30, s26, 384
    buffer_load_dwordx4 v4, s[8:11], s30 offen lds
    s_add_u32 m0, s28, 17408
    s_add_u32 s30, s26, 10624
    buffer_load_dwordx4 v5, s[8:11], s30 offen lds
    s_add_u32 m0, s28, 18432
    s_add_u32 s30, s26, 20864
    buffer_load_dwordx4 v4, s[8:11], s30 offen lds
    s_add_u32 m0, s28, 19456
    s_add_u32 s30, s26, 31104
    buffer_load_dwordx4 v5, s[8:11], s30 offen lds
    s_add_u32 m0, s29, 65536
    s_add_u32 s30, s27, 589824
    buffer_load_dwordx4 v6, s[12:15], s30 offen lds
    s_add_u32 m0, s29, 66560
    s_add_u32 s30, s27, 595968
    buffer_load_dwordx4 v7, s[12:15], s30 offen lds
    s_add_u32 m0, s29, 67584
    s_add_u32 s30, s27, 602112
    buffer_load_dwordx4 v6, s[12:15], s30 offen lds
    s_add_u32 m0, s29, 68608
    s_add_u32 s30, s27, 608256
    buffer_load_dwordx4 v7, s[12:15], s30 offen lds
    s_add_u32 m0, s29, 69632
    s_add_u32 s30, s27, 614400
    buffer_load_dwordx4 v6, s[12:15], s30 offen lds
    s_add_u32 m0, s29, 70656
    s_add_u32 s30, s27, 620544
    buffer_load_dwordx4 v7, s[12:15], s30 offen lds
    s_add_u32 m0, s29, 71680
    s_add_u32 s30, s27, 626688
    buffer_load_dwordx4 v6, s[12:15], s30 offen lds
    s_add_u32 m0, s29, 72704
    s_add_u32 s30, s27, 632832
    buffer_load_dwordx4 v7, s[12:15], s30 offen lds
    s_waitcnt vmcnt(12)
    s_barrier
    s_add_u32 m0, s28, 32768
    s_add_u32 s30, s26, 512
    buffer_load_dwordx4 v4, s[8:11], s30 offen lds
    s_add_u32 m0, s28, 33792
    s_add_u32 s30, s26, 10752
    buffer_load_dwordx4 v5, s[8:11], s30 offen lds
    s_add_u32 m0, s28, 34816
    s_add_u32 s30, s26, 20992
    buffer_load_dwordx4 v4, s[8:11], s30 offen lds
    s_add_u32 m0, s28, 35840
    s_add_u32 s30, s26, 31232
    buffer_load_dwordx4 v5, s[8:11], s30 offen lds
    s_add_u32 m0, s29, 98304
    s_add_u32 s30, s27, 786432
    buffer_load_dwordx4 v6, s[12:15], s30 offen lds
    s_add_u32 m0, s29, 99328
    s_add_u32 s30, s27, 792576
    buffer_load_dwordx4 v7, s[12:15], s30 offen lds
    s_add_u32 m0, s29, 100352
    s_add_u32 s30, s27, 798720
    buffer_load_dwordx4 v6, s[12:15], s30 offen lds
    s_add_u32 m0, s29, 101376
    s_add_u32 s30, s27, 804864
    buffer_load_dwordx4 v7, s[12:15], s30 offen lds
    s_add_u32 m0, s29, 102400
    s_add_u32 s30, s27, 811008
    buffer_load_dwordx4 v6, s[12:15], s30 offen lds
    s_add_u32 m0, s29, 103424
    s_add_u32 s30, s27, 817152
    buffer_load_dwordx4 v7, s[12:15], s30 offen lds
    s_add_u32 m0, s29, 104448
    s_add_u32 s30, s27, 823296
    buffer_load_dwordx4 v6, s[12:15], s30 offen lds
    s_add_u32 m0, s29, 105472
    s_add_u32 s30, s27, 829440
    buffer_load_dwordx4 v7, s[12:15], s30 offen lds
    s_waitcnt vmcnt(12)
    s_barrier
    s_add_u32 m0, s28, 49152
    s_add_u32 s30, s26, 640
    buffer_load_dwordx4 v4, s[8:11], s30 offen lds
    s_add_u32 m0, s28, 50176
    s_add_u32 s30, s26, 10880
    buffer_load_dwordx4 v5, s[8:11], s30 offen lds
    s_add_u32 m0, s28, 51200
    s_add_u32 s30, s26, 21120
    buffer_load_dwordx4 v4, s[8:11], s30 offen lds
    s_add_u32 m0, s28, 52224
    s_add_u32 s30, s26, 31360
    buffer_load_dwordx4 v5, s[8:11], s30 offen lds
    s_add_u32 m0, s29, 131072
    s_add_u32 s30, s27, 983040
    buffer_load_dwordx4 v6, s[12:15], s30 offen lds
    s_add_u32 m0, s29, 132096
    s_add_u32 s30, s27, 989184
    buffer_load_dwordx4 v7, s[12:15], s30 offen lds
    s_add_u32 m0, s29, 133120
    s_add_u32 s30, s27, 995328
    buffer_load_dwordx4 v6, s[12:15], s30 offen lds
    s_add_u32 m0, s29, 134144
    s_add_u32 s30, s27, 1001472
    buffer_load_dwordx4 v7, s[12:15], s30 offen lds
    s_add_u32 m0, s29, 135168
    s_add_u32 s30, s27, 1007616
    buffer_load_dwordx4 v6, s[12:15], s30 offen lds
    s_add_u32 m0, s29, 136192
    s_add_u32 s30, s27, 1013760
    buffer_load_dwordx4 v7, s[12:15], s30 offen lds
    s_add_u32 m0, s29, 137216
    s_add_u32 s30, s27, 1019904
    buffer_load_dwordx4 v6, s[12:15], s30 offen lds
    s_add_u32 m0, s29, 138240
    s_add_u32 s30, s27, 1026048
    buffer_load_dwordx4 v7, s[12:15], s30 offen lds
    s_waitcnt vmcnt(12)
    s_barrier
    s_add_u32 m0, s28, 16384
    s_add_u32 s30, s26, 768
    buffer_load_dwordx4 v4, s[8:11], s30 offen lds
    s_add_u32 m0, s28, 17408
    s_add_u32 s30, s26, 11008
    buffer_load_dwordx4 v5, s[8:11], s30 offen lds
    s_add_u32 m0, s28, 18432
    s_add_u32 s30, s26, 21248
    buffer_load_dwordx4 v4, s[8:11], s30 offen lds
    s_add_u32 m0, s28, 19456
    s_add_u32 s30, s26, 31488
    buffer_load_dwordx4 v5, s[8:11], s30 offen lds
    s_add_u32 m0, s29, 65536
    s_add_u32 s30, s27, 1179648
    buffer_load_dwordx4 v6, s[12:15], s30 offen lds
    s_add_u32 m0, s29, 66560
    s_add_u32 s30, s27, 1185792
    buffer_load_dwordx4 v7, s[12:15], s30 offen lds
    s_add_u32 m0, s29, 67584
    s_add_u32 s30, s27, 1191936
    buffer_load_dwordx4 v6, s[12:15], s30 offen lds
    s_add_u32 m0, s29, 68608
    s_add_u32 s30, s27, 1198080
    buffer_load_dwordx4 v7, s[12:15], s30 offen lds
    s_add_u32 m0, s29, 69632
    s_add_u32 s30, s27, 1204224
    buffer_load_dwordx4 v6, s[12:15], s30 offen lds
    s_add_u32 m0, s29, 70656
    s_add_u32 s30, s27, 1210368
    buffer_load_dwordx4 v7, s[12:15], s30 offen lds
    s_add_u32 m0, s29, 71680
    s_add_u32 s30, s27, 1216512
    buffer_load_dwordx4 v6, s[12:15], s30 offen lds
    s_add_u32 m0, s29, 72704
    s_add_u32 s30, s27, 1222656
    buffer_load_dwordx4 v7, s[12:15], s30 offen lds
    s_waitcnt vmcnt(12)
    s_barrier
    s_add_u32 m0, s28, 32768
    s_add_u32 s30, s26, 896
    buffer_load_dwordx4 v4, s[8:11], s30 offen lds
    s_add_u32 m0, s28, 33792
    s_add_u32 s30, s26, 11136
    buffer_load_dwordx4 v5, s[8:11], s30 offen lds
    s_add_u32 m0, s28, 34816
    s_add_u32 s30, s26, 21376
    buffer_load_dwordx4 v4, s[8:11], s30 offen lds
    s_add_u32 m0, s28, 35840
    s_add_u32 s30, s26, 31616
    buffer_load_dwordx4 v5, s[8:11], s30 offen lds
    s_add_u32 m0, s29, 98304
    s_add_u32 s30, s27, 1376256
    buffer_load_dwordx4 v6, s[12:15], s30 offen lds
    s_add_u32 m0, s29, 99328
    s_add_u32 s30, s27, 1382400
    buffer_load_dwordx4 v7, s[12:15], s30 offen lds
    s_add_u32 m0, s29, 100352
    s_add_u32 s30, s27, 1388544
    buffer_load_dwordx4 v6, s[12:15], s30 offen lds
    s_add_u32 m0, s29, 101376
    s_add_u32 s30, s27, 1394688
    buffer_load_dwordx4 v7, s[12:15], s30 offen lds
    s_add_u32 m0, s29, 102400
    s_add_u32 s30, s27, 1400832
    buffer_load_dwordx4 v6, s[12:15], s30 offen lds
    s_add_u32 m0, s29, 103424
    s_add_u32 s30, s27, 1406976
    buffer_load_dwordx4 v7, s[12:15], s30 offen lds
    s_add_u32 m0, s29, 104448
    s_add_u32 s30, s27, 1413120
    buffer_load_dwordx4 v6, s[12:15], s30 offen lds
    s_add_u32 m0, s29, 105472
    s_add_u32 s30, s27, 1419264
    buffer_load_dwordx4 v7, s[12:15], s30 offen lds
    s_waitcnt vmcnt(12)
    s_barrier
    s_add_u32 m0, s28, 49152
    s_add_u32 s30, s26, 1024
    buffer_load_dwordx4 v4, s[8:11], s30 offen lds
    s_add_u32 m0, s28, 50176
    s_add_u32 s30, s26, 11264
    buffer_load_dwordx4 v5, s[8:11], s30 offen lds
    s_add_u32 m0, s28, 51200
    s_add_u32 s30, s26, 21504
    buffer_load_dwordx4 v4, s[8:11], s30 offen lds
    s_add_u32 m0, s28, 52224
    s_add_u32 s30, s26, 31744
    buffer_load_dwordx4 v5, s[8:11], s30 offen lds
    s_add_u32 m0, s29, 131072
    s_add_u32 s30, s27, 1572864
    buffer_load_dwordx4 v6, s[12:15], s30 offen lds
    s_add_u32 m0, s29, 132096
    s_add_u32 s30, s27, 1579008
    buffer_load_dwordx4 v7, s[12:15], s30 offen lds
    s_add_u32 m0, s29, 133120
    s_add_u32 s30, s27, 1585152
    buffer_load_dwordx4 v6, s[12:15], s30 offen lds
    s_add_u32 m0, s29, 134144
    s_add_u32 s30, s27, 1591296
    buffer_load_dwordx4 v7, s[12:15], s30 offen lds
    s_add_u32 m0, s29, 135168
    s_add_u32 s30, s27, 1597440
    buffer_load_dwordx4 v6, s[12:15], s30 offen lds
    s_add_u32 m0, s29, 136192
    s_add_u32 s30, s27, 1603584
    buffer_load_dwordx4 v7, s[12:15], s30 offen lds
    s_add_u32 m0, s29, 137216
    s_add_u32 s30, s27, 1609728
    buffer_load_dwordx4 v6, s[12:15], s30 offen lds
    s_add_u32 m0, s29, 138240
    s_add_u32 s30, s27, 1615872
    buffer_load_dwordx4 v7, s[12:15], s30 offen lds
    s_waitcnt vmcnt(12)
    s_barrier
    s_add_u32 m0, s28, 16384
    s_add_u32 s30, s26, 1152
    buffer_load_dwordx4 v4, s[8:11], s30 offen lds
    s_add_u32 m0, s28, 17408
    s_add_u32 s30, s26, 11392
    buffer_load_dwordx4 v5, s[8:11], s30 offen lds
    s_add_u32 m0, s28, 18432
    s_add_u32 s30, s26, 21632
    buffer_load_dwordx4 v4, s[8:11], s30 offen lds
    s_add_u32 m0, s28, 19456
    s_add_u32 s30, s26, 31872
    buffer_load_dwordx4 v5, s[8:11], s30 offen lds
    s_add_u32 m0, s29, 65536
    s_add_u32 s30, s27, 1769472
    buffer_load_dwordx4 v6, s[12:15], s30 offen lds
    s_add_u32 m0, s29, 66560
    s_add_u32 s30, s27, 1775616
    buffer_load_dwordx4 v7, s[12:15], s30 offen lds
    s_add_u32 m0, s29, 67584
    s_add_u32 s30, s27, 1781760
    buffer_load_dwordx4 v6, s[12:15], s30 offen lds
    s_add_u32 m0, s29, 68608
    s_add_u32 s30, s27, 1787904
    buffer_load_dwordx4 v7, s[12:15], s30 offen lds
    s_add_u32 m0, s29, 69632
    s_add_u32 s30, s27, 1794048
    buffer_load_dwordx4 v6, s[12:15], s30 offen lds
    s_add_u32 m0, s29, 70656
    s_add_u32 s30, s27, 1800192
    buffer_load_dwordx4 v7, s[12:15], s30 offen lds
    s_add_u32 m0, s29, 71680
    s_add_u32 s30, s27, 1806336
    buffer_load_dwordx4 v6, s[12:15], s30 offen lds
    s_add_u32 m0, s29, 72704
    s_add_u32 s30, s27, 1812480
    buffer_load_dwordx4 v7, s[12:15], s30 offen lds
    s_waitcnt vmcnt(12)
    s_barrier
    s_waitcnt vmcnt(0)
    s_barrier
    s_lshl_b32 s42, s25, 8
    s_lshl_b32 s30, s3, 6
    s_add_u32 s42, s42, s30
    v_lshlrev_b32 v74, 4, v72
    s_lshl_b32 s30, s42, 1
    v_add_u32 v74, s30, v74
    global_load_dwordx4 v[96:99], v74, s[86:87] offset:0
    global_load_dwordx4 v[100:103], v74, s[86:87] offset:32
    global_load_dwordx4 v[104:107], v74, s[86:87] offset:64
    global_load_dwordx4 v[108:111], v74, s[86:87] offset:96
    s_mov_b32 s32, 0x3fb8aa3b
    s_mov_b32 s33, 0x3f317218
    s_mov_b32 s34, 0xc038aa3b
    s_mov_b32 s35, 0x39800000
    s_mov_b32 s36, 0x3c800000
    v_lshlrev_b32 v2, 4, v1
    s_lshl_b32 s30, s3, 14
    s_add_u32 s30, s30, 98304
    v_add_u32 v2, s30, v2
    s_barrier
    ds_read_b128 v[192:195], v2 offset:0
    ds_read_b128 v[196:199], v2 offset:1024
    ds_read_b128 v[200:203], v2 offset:2048
    ds_read_b128 v[204:207], v2 offset:3072
    ds_read_b128 v[208:211], v2 offset:4096
    ds_read_b128 v[212:215], v2 offset:5120
    ds_read_b128 v[216:219], v2 offset:6144
    ds_read_b128 v[220:223], v2 offset:7168
    ds_read_b128 v[224:227], v2 offset:8192
    ds_read_b128 v[228:231], v2 offset:9216
    ds_read_b128 v[232:235], v2 offset:10240
    ds_read_b128 v[236:239], v2 offset:11264
    ds_read_b128 v[240:243], v2 offset:12288
    ds_read_b128 v[244:247], v2 offset:13312
    ds_read_b128 v[248:251], v2 offset:14336
    ds_read_b128 v[252:255], v2 offset:15360
    s_waitcnt vmcnt(0) lgkmcnt(0)
    v_lshlrev_b32 v24, 16, v96
    v_and_b32 v25, 0xffff0000, v96
    v_lshlrev_b32 v26, 16, v97
    v_and_b32 v27, 0xffff0000, v97
    v_lshlrev_b32 v28, 16, v98
    v_and_b32 v29, 0xffff0000, v98
    v_lshlrev_b32 v30, 16, v99
    v_and_b32 v31, 0xffff0000, v99
    v_lshlrev_b32 v32, 16, v100
    v_and_b32 v33, 0xffff0000, v100
    v_lshlrev_b32 v34, 16, v101
    v_and_b32 v35, 0xffff0000, v101
    v_lshlrev_b32 v36, 16, v102
    v_and_b32 v37, 0xffff0000, v102
    v_lshlrev_b32 v38, 16, v103
    v_and_b32 v39, 0xffff0000, v103
    v_lshlrev_b32 v40, 16, v104
    v_and_b32 v41, 0xffff0000, v104
    v_lshlrev_b32 v42, 16, v105
    v_and_b32 v43, 0xffff0000, v105
    v_lshlrev_b32 v44, 16, v106
    v_and_b32 v45, 0xffff0000, v106
    v_lshlrev_b32 v46, 16, v107
    v_and_b32 v47, 0xffff0000, v107
    v_lshlrev_b32 v48, 16, v108
    v_and_b32 v49, 0xffff0000, v108
    v_lshlrev_b32 v50, 16, v109
    v_and_b32 v51, 0xffff0000, v109
    v_lshlrev_b32 v52, 16, v110
    v_and_b32 v53, 0xffff0000, v110
    v_lshlrev_b32 v54, 16, v111
    v_and_b32 v55, 0xffff0000, v111
    v_bfe_u32 v74, v1, 4, 1
    v_lshlrev_b32 v74, 10, v74
    v_and_b32 v75, 15, v1
    v_lshl_add_u32 v74, v75, 4, v74
    v_lshl_add_u32 v74, v72, 8, v74
    s_mul_i32 s31, s24, 393216
    s_lshl_b32 s30, s42, 7
    s_add_u32 s31, s31, s30
    s_mov_b32 s37, 1962964224
    v_mov_b32 v75, 0
    v_cvt_pk_bf16_f32 v112, v192, v193
    v_lshlrev_b32 v192, 16, v112
    v_and_b32 v193, 0xffff0000, v112
    v_pk_add_f32 v[192:193], v[192:193], v[24:25]
    v_cvt_pk_bf16_f32 v112, v192, v193
    v_lshlrev_b32 v192, 16, v112
    v_and_b32 v193, 0xffff0000, v112
    v_pk_lshlrev_b16 v113, 1, v112 op_sel_hi:[0,1]
    v_pk_lshrrev_b16 v112, 15, v112 op_sel_hi:[0,1]
    v_or_b32 v112, v112, v113
    v_pk_sub_u16 v112, v112, s37 clamp
    v_pk_max_u16 v75, v75, v112
    v_lshlrev_b32_sdwa v113, 2, v112 dst_sel:DWORD dst_unused:UNUSED_PAD src0_sel:DWORD src1_sel:WORD_1
    v_lshlrev_b32_sdwa v112, 2, v112 dst_sel:DWORD dst_unused:UNUSED_PAD src0_sel:DWORD src1_sel:WORD_0
    ds_read_b32 v96, v112 offset:0
    ds_read_b32 v97, v113 offset:0
    v_cvt_pk_bf16_f32 v114, v194, v195
    v_lshlrev_b32 v194, 16, v114
    v_and_b32 v195, 0xffff0000, v114
    v_pk_add_f32 v[194:195], v[194:195], v[26:27]
    v_cvt_pk_bf16_f32 v114, v194, v195
    v_lshlrev_b32 v194, 16, v114
    v_and_b32 v195, 0xffff0000, v114
    v_pk_lshlrev_b16 v115, 1, v114 op_sel_hi:[0,1]
    v_pk_lshrrev_b16 v114, 15, v114 op_sel_hi:[0,1]
    v_or_b32 v114, v114, v115
    v_pk_sub_u16 v114, v114, s37 clamp
    v_pk_max_u16 v75, v75, v114
    v_lshlrev_b32_sdwa v115, 2, v114 dst_sel:DWORD dst_unused:UNUSED_PAD src0_sel:DWORD src1_sel:WORD_1
    v_lshlrev_b32_sdwa v114, 2, v114 dst_sel:DWORD dst_unused:UNUSED_PAD src0_sel:DWORD src1_sel:WORD_0
    ds_read_b32 v98, v114 offset:0
    ds_read_b32 v99, v115 offset:0
    v_cvt_pk_bf16_f32 v116, v196, v197
    v_lshlrev_b32 v196, 16, v116
    v_and_b32 v197, 0xffff0000, v116
    v_pk_add_f32 v[196:197], v[196:197], v[28:29]
    v_cvt_pk_bf16_f32 v116, v196, v197
    v_lshlrev_b32 v196, 16, v116
    v_and_b32 v197, 0xffff0000, v116
    v_pk_lshlrev_b16 v117, 1, v116 op_sel_hi:[0,1]
    v_pk_lshrrev_b16 v116, 15, v116 op_sel_hi:[0,1]
    v_or_b32 v116, v116, v117
    v_pk_sub_u16 v116, v116, s37 clamp
    v_pk_max_u16 v75, v75, v116
    v_lshlrev_b32_sdwa v117, 2, v116 dst_sel:DWORD dst_unused:UNUSED_PAD src0_sel:DWORD src1_sel:WORD_1
    v_lshlrev_b32_sdwa v116, 2, v116 dst_sel:DWORD dst_unused:UNUSED_PAD src0_sel:DWORD src1_sel:WORD_0
    ds_read_b32 v100, v116 offset:0
    ds_read_b32 v101, v117 offset:0
    v_cvt_pk_bf16_f32 v118, v198, v199
    v_lshlrev_b32 v198, 16, v118
    v_and_b32 v199, 0xffff0000, v118
    v_pk_add_f32 v[198:199], v[198:199], v[30:31]
    v_cvt_pk_bf16_f32 v118, v198, v199
    v_lshlrev_b32 v198, 16, v118
    v_and_b32 v199, 0xffff0000, v118
    v_pk_lshlrev_b16 v119, 1, v118 op_sel_hi:[0,1]
    v_pk_lshrrev_b16 v118, 15, v118 op_sel_hi:[0,1]
    v_or_b32 v118, v118, v119
    v_pk_sub_u16 v118, v118, s37 clamp
    v_pk_max_u16 v75, v75, v118
    v_lshlrev_b32_sdwa v119, 2, v118 dst_sel:DWORD dst_unused:UNUSED_PAD src0_sel:DWORD src1_sel:WORD_1
    v_lshlrev_b32_sdwa v118, 2, v118 dst_sel:DWORD dst_unused:UNUSED_PAD src0_sel:DWORD src1_sel:WORD_0
    ds_read_b32 v102, v118 offset:0
    ds_read_b32 v103, v119 offset:0
    v_cvt_pk_bf16_f32 v112, v200, v201
    v_lshlrev_b32 v200, 16, v112
    v_and_b32 v201, 0xffff0000, v112
    v_pk_add_f32 v[200:201], v[200:201], v[32:33]
    v_cvt_pk_bf16_f32 v112, v200, v201
    v_lshlrev_b32 v200, 16, v112
    v_and_b32 v201, 0xffff0000, v112
    v_pk_lshlrev_b16 v113, 1, v112 op_sel_hi:[0,1]
    v_pk_lshrrev_b16 v112, 15, v112 op_sel_hi:[0,1]
    v_or_b32 v112, v112, v113
    v_pk_sub_u16 v112, v112, s37 clamp
    v_pk_max_u16 v75, v75, v112
    v_lshlrev_b32_sdwa v113, 2, v112 dst_sel:DWORD dst_unused:UNUSED_PAD src0_sel:DWORD src1_sel:WORD_1
    v_lshlrev_b32_sdwa v112, 2, v112 dst_sel:DWORD dst_unused:UNUSED_PAD src0_sel:DWORD src1_sel:WORD_0
    ds_read_b32 v104, v112 offset:0
    ds_read_b32 v105, v113 offset:0
    v_cvt_pk_bf16_f32 v114, v202, v203
    v_lshlrev_b32 v202, 16, v114
    v_and_b32 v203, 0xffff0000, v114
    v_pk_add_f32 v[202:203], v[202:203], v[34:35]
    v_cvt_pk_bf16_f32 v114, v202, v203
    v_lshlrev_b32 v202, 16, v114
    v_and_b32 v203, 0xffff0000, v114
    v_pk_lshlrev_b16 v115, 1, v114 op_sel_hi:[0,1]
    v_pk_lshrrev_b16 v114, 15, v114 op_sel_hi:[0,1]
    v_or_b32 v114, v114, v115
    v_pk_sub_u16 v114, v114, s37 clamp
    v_pk_max_u16 v75, v75, v114
    v_lshlrev_b32_sdwa v115, 2, v114 dst_sel:DWORD dst_unused:UNUSED_PAD src0_sel:DWORD src1_sel:WORD_1
    v_lshlrev_b32_sdwa v114, 2, v114 dst_sel:DWORD dst_unused:UNUSED_PAD src0_sel:DWORD src1_sel:WORD_0
    ds_read_b32 v106, v114 offset:0
    ds_read_b32 v107, v115 offset:0
    v_cvt_pk_bf16_f32 v116, v204, v205
    v_lshlrev_b32 v204, 16, v116
    v_and_b32 v205, 0xffff0000, v116
    v_pk_add_f32 v[204:205], v[204:205], v[36:37]
    v_cvt_pk_bf16_f32 v116, v204, v205
    v_lshlrev_b32 v204, 16, v116
    v_and_b32 v205, 0xffff0000, v116
    v_pk_lshlrev_b16 v117, 1, v116 op_sel_hi:[0,1]
    v_pk_lshrrev_b16 v116, 15, v116 op_sel_hi:[0,1]
    v_or_b32 v116, v116, v117
    v_pk_sub_u16 v116, v116, s37 clamp
    v_pk_max_u16 v75, v75, v116
    v_lshlrev_b32_sdwa v117, 2, v116 dst_sel:DWORD dst_unused:UNUSED_PAD src0_sel:DWORD src1_sel:WORD_1
    v_lshlrev_b32_sdwa v116, 2, v116 dst_sel:DWORD dst_unused:UNUSED_PAD src0_sel:DWORD src1_sel:WORD_0
    ds_read_b32 v108, v116 offset:0
    ds_read_b32 v109, v117 offset:0
    v_cvt_pk_bf16_f32 v118, v206, v207
    v_lshlrev_b32 v206, 16, v118
    v_and_b32 v207, 0xffff0000, v118
    v_pk_add_f32 v[206:207], v[206:207], v[38:39]
    v_cvt_pk_bf16_f32 v118, v206, v207
    v_lshlrev_b32 v206, 16, v118
    v_and_b32 v207, 0xffff0000, v118
    v_pk_lshlrev_b16 v119, 1, v118 op_sel_hi:[0,1]
    v_pk_lshrrev_b16 v118, 15, v118 op_sel_hi:[0,1]
    v_or_b32 v118, v118, v119
    v_pk_sub_u16 v118, v118, s37 clamp
    v_pk_max_u16 v75, v75, v118
    v_lshlrev_b32_sdwa v119, 2, v118 dst_sel:DWORD dst_unused:UNUSED_PAD src0_sel:DWORD src1_sel:WORD_1
    v_lshlrev_b32_sdwa v118, 2, v118 dst_sel:DWORD dst_unused:UNUSED_PAD src0_sel:DWORD src1_sel:WORD_0
    ds_read_b32 v110, v118 offset:0
    ds_read_b32 v111, v119 offset:0
    s_waitcnt lgkmcnt(8)
    v_pk_mul_f32 v[96:97], v[96:97], v[192:193]
    v_cvt_pk_bf16_f32 v64, v96, v97
    v_pk_mul_f32 v[98:99], v[98:99], v[194:195]
    v_cvt_pk_bf16_f32 v65, v98, v99
    v_pk_mul_f32 v[100:101], v[100:101], v[196:197]
    v_cvt_pk_bf16_f32 v66, v100, v101
    v_pk_mul_f32 v[102:103], v[102:103], v[198:199]
    v_cvt_pk_bf16_f32 v67, v102, v103
    s_add_u32 s30, s31, 196608
    buffer_store_dwordx4 v[64:67], v74, s[20:23], s30 offen sc1
    v_cvt_pk_bf16_f32 v112, v208, v209
    v_lshlrev_b32 v208, 16, v112
    v_and_b32 v209, 0xffff0000, v112
    v_pk_add_f32 v[208:209], v[208:209], v[40:41]
    v_cvt_pk_bf16_f32 v112, v208, v209
    v_lshlrev_b32 v208, 16, v112
    v_and_b32 v209, 0xffff0000, v112
    v_pk_lshlrev_b16 v113, 1, v112 op_sel_hi:[0,1]
    v_pk_lshrrev_b16 v112, 15, v112 op_sel_hi:[0,1]
    v_or_b32 v112, v112, v113
    v_pk_sub_u16 v112, v112, s37 clamp
    v_pk_max_u16 v75, v75, v112
    v_lshlrev_b32_sdwa v113, 2, v112 dst_sel:DWORD dst_unused:UNUSED_PAD src0_sel:DWORD src1_sel:WORD_1
    v_lshlrev_b32_sdwa v112, 2, v112 dst_sel:DWORD dst_unused:UNUSED_PAD src0_sel:DWORD src1_sel:WORD_0
    ds_read_b32 v96, v112 offset:0
    ds_read_b32 v97, v113 offset:0
    v_cvt_pk_bf16_f32 v114, v210, v211
    v_lshlrev_b32 v210, 16, v114
    v_and_b32 v211, 0xffff0000, v114
    v_pk_add_f32 v[210:211], v[210:211], v[42:43]
    v_cvt_pk_bf16_f32 v114, v210, v211
    v_lshlrev_b32 v210, 16, v114
    v_and_b32 v211, 0xffff0000, v114
    v_pk_lshlrev_b16 v115, 1, v114 op_sel_hi:[0,1]
    v_pk_lshrrev_b16 v114, 15, v114 op_sel_hi:[0,1]
    v_or_b32 v114, v114, v115
    v_pk_sub_u16 v114, v114, s37 clamp
    v_pk_max_u16 v75, v75, v114
    v_lshlrev_b32_sdwa v115, 2, v114 dst_sel:DWORD dst_unused:UNUSED_PAD src0_sel:DWORD src1_sel:WORD_1
    v_lshlrev_b32_sdwa v114, 2, v114 dst_sel:DWORD dst_unused:UNUSED_PAD src0_sel:DWORD src1_sel:WORD_0
    ds_read_b32 v98, v114 offset:0
    ds_read_b32 v99, v115 offset:0
    v_cvt_pk_bf16_f32 v116, v212, v213
    v_lshlrev_b32 v212, 16, v116
    v_and_b32 v213, 0xffff0000, v116
    v_pk_add_f32 v[212:213], v[212:213], v[44:45]
    v_cvt_pk_bf16_f32 v116, v212, v213
    v_lshlrev_b32 v212, 16, v116
    v_and_b32 v213, 0xffff0000, v116
    v_pk_lshlrev_b16 v117, 1, v116 op_sel_hi:[0,1]
    v_pk_lshrrev_b16 v116, 15, v116 op_sel_hi:[0,1]
    v_or_b32 v116, v116, v117
    v_pk_sub_u16 v116, v116, s37 clamp
    v_pk_max_u16 v75, v75, v116
    v_lshlrev_b32_sdwa v117, 2, v116 dst_sel:DWORD dst_unused:UNUSED_PAD src0_sel:DWORD src1_sel:WORD_1
    v_lshlrev_b32_sdwa v116, 2, v116 dst_sel:DWORD dst_unused:UNUSED_PAD src0_sel:DWORD src1_sel:WORD_0
    ds_read_b32 v100, v116 offset:0
    ds_read_b32 v101, v117 offset:0
    v_cvt_pk_bf16_f32 v118, v214, v215
    v_lshlrev_b32 v214, 16, v118
    v_and_b32 v215, 0xffff0000, v118
    v_pk_add_f32 v[214:215], v[214:215], v[46:47]
    v_cvt_pk_bf16_f32 v118, v214, v215
    v_lshlrev_b32 v214, 16, v118
    v_and_b32 v215, 0xffff0000, v118
    v_pk_lshlrev_b16 v119, 1, v118 op_sel_hi:[0,1]
    v_pk_lshrrev_b16 v118, 15, v118 op_sel_hi:[0,1]
    v_or_b32 v118, v118, v119
    v_pk_sub_u16 v118, v118, s37 clamp
    v_pk_max_u16 v75, v75, v118
    v_lshlrev_b32_sdwa v119, 2, v118 dst_sel:DWORD dst_unused:UNUSED_PAD src0_sel:DWORD src1_sel:WORD_1
    v_lshlrev_b32_sdwa v118, 2, v118 dst_sel:DWORD dst_unused:UNUSED_PAD src0_sel:DWORD src1_sel:WORD_0
    ds_read_b32 v102, v118 offset:0
    ds_read_b32 v103, v119 offset:0
    s_waitcnt lgkmcnt(8)
    v_pk_mul_f32 v[104:105], v[104:105], v[200:201]
    v_cvt_pk_bf16_f32 v68, v104, v105
    v_pk_mul_f32 v[106:107], v[106:107], v[202:203]
    v_cvt_pk_bf16_f32 v69, v106, v107
    v_pk_mul_f32 v[108:109], v[108:109], v[204:205]
    v_cvt_pk_bf16_f32 v70, v108, v109
    v_pk_mul_f32 v[110:111], v[110:111], v[206:207]
    v_cvt_pk_bf16_f32 v71, v110, v111
    s_add_u32 s30, s31, 197120
    buffer_store_dwordx4 v[68:71], v74, s[20:23], s30 offen sc1
    v_cvt_pk_bf16_f32 v112, v216, v217
    v_lshlrev_b32 v216, 16, v112
    v_and_b32 v217, 0xffff0000, v112
    v_pk_add_f32 v[216:217], v[216:217], v[48:49]
    v_cvt_pk_bf16_f32 v112, v216, v217
    v_lshlrev_b32 v216, 16, v112
    v_and_b32 v217, 0xffff0000, v112
    v_pk_lshlrev_b16 v113, 1, v112 op_sel_hi:[0,1]
    v_pk_lshrrev_b16 v112, 15, v112 op_sel_hi:[0,1]
    v_or_b32 v112, v112, v113
    v_pk_sub_u16 v112, v112, s37 clamp
    v_pk_max_u16 v75, v75, v112
    v_lshlrev_b32_sdwa v113, 2, v112 dst_sel:DWORD dst_unused:UNUSED_PAD src0_sel:DWORD src1_sel:WORD_1
    v_lshlrev_b32_sdwa v112, 2, v112 dst_sel:DWORD dst_unused:UNUSED_PAD src0_sel:DWORD src1_sel:WORD_0
    ds_read_b32 v104, v112 offset:0
    ds_read_b32 v105, v113 offset:0
    v_cvt_pk_bf16_f32 v114, v218, v219
    v_lshlrev_b32 v218, 16, v114
    v_and_b32 v219, 0xffff0000, v114
    v_pk_add_f32 v[218:219], v[218:219], v[50:51]
    v_cvt_pk_bf16_f32 v114, v218, v219
    v_lshlrev_b32 v218, 16, v114
    v_and_b32 v219, 0xffff0000, v114
    v_pk_lshlrev_b16 v115, 1, v114 op_sel_hi:[0,1]
    v_pk_lshrrev_b16 v114, 15, v114 op_sel_hi:[0,1]
    v_or_b32 v114, v114, v115
    v_pk_sub_u16 v114, v114, s37 clamp
    v_pk_max_u16 v75, v75, v114
    v_lshlrev_b32_sdwa v115, 2, v114 dst_sel:DWORD dst_unused:UNUSED_PAD src0_sel:DWORD src1_sel:WORD_1
    v_lshlrev_b32_sdwa v114, 2, v114 dst_sel:DWORD dst_unused:UNUSED_PAD src0_sel:DWORD src1_sel:WORD_0
    ds_read_b32 v106, v114 offset:0
    ds_read_b32 v107, v115 offset:0
    v_cvt_pk_bf16_f32 v116, v220, v221
    v_lshlrev_b32 v220, 16, v116
    v_and_b32 v221, 0xffff0000, v116
    v_pk_add_f32 v[220:221], v[220:221], v[52:53]
    v_cvt_pk_bf16_f32 v116, v220, v221
    v_lshlrev_b32 v220, 16, v116
    v_and_b32 v221, 0xffff0000, v116
    v_pk_lshlrev_b16 v117, 1, v116 op_sel_hi:[0,1]
    v_pk_lshrrev_b16 v116, 15, v116 op_sel_hi:[0,1]
    v_or_b32 v116, v116, v117
    v_pk_sub_u16 v116, v116, s37 clamp
    v_pk_max_u16 v75, v75, v116
    v_lshlrev_b32_sdwa v117, 2, v116 dst_sel:DWORD dst_unused:UNUSED_PAD src0_sel:DWORD src1_sel:WORD_1
    v_lshlrev_b32_sdwa v116, 2, v116 dst_sel:DWORD dst_unused:UNUSED_PAD src0_sel:DWORD src1_sel:WORD_0
    ds_read_b32 v108, v116 offset:0
    ds_read_b32 v109, v117 offset:0
    v_cvt_pk_bf16_f32 v118, v222, v223
    v_lshlrev_b32 v222, 16, v118
    v_and_b32 v223, 0xffff0000, v118
    v_pk_add_f32 v[222:223], v[222:223], v[54:55]
    v_cvt_pk_bf16_f32 v118, v222, v223
    v_lshlrev_b32 v222, 16, v118
    v_and_b32 v223, 0xffff0000, v118
    v_pk_lshlrev_b16 v119, 1, v118 op_sel_hi:[0,1]
    v_pk_lshrrev_b16 v118, 15, v118 op_sel_hi:[0,1]
    v_or_b32 v118, v118, v119
    v_pk_sub_u16 v118, v118, s37 clamp
    v_pk_max_u16 v75, v75, v118
    v_lshlrev_b32_sdwa v119, 2, v118 dst_sel:DWORD dst_unused:UNUSED_PAD src0_sel:DWORD src1_sel:WORD_1
    v_lshlrev_b32_sdwa v118, 2, v118 dst_sel:DWORD dst_unused:UNUSED_PAD src0_sel:DWORD src1_sel:WORD_0
    ds_read_b32 v110, v118 offset:0
    ds_read_b32 v111, v119 offset:0
    s_waitcnt lgkmcnt(8)
    v_pk_mul_f32 v[96:97], v[96:97], v[208:209]
    v_cvt_pk_bf16_f32 v64, v96, v97
    v_pk_mul_f32 v[98:99], v[98:99], v[210:211]
    v_cvt_pk_bf16_f32 v65, v98, v99
    v_pk_mul_f32 v[100:101], v[100:101], v[212:213]
    v_cvt_pk_bf16_f32 v66, v100, v101
    v_pk_mul_f32 v[102:103], v[102:103], v[214:215]
    v_cvt_pk_bf16_f32 v67, v102, v103
    s_add_u32 s30, s31, 200704
    buffer_store_dwordx4 v[64:67], v74, s[20:23], s30 offen sc1
    v_cvt_pk_bf16_f32 v112, v224, v225
    v_lshlrev_b32 v224, 16, v112
    v_and_b32 v225, 0xffff0000, v112
    v_pk_add_f32 v[224:225], v[224:225], v[24:25]
    v_cvt_pk_bf16_f32 v112, v224, v225
    v_lshlrev_b32 v224, 16, v112
    v_and_b32 v225, 0xffff0000, v112
    v_pk_lshlrev_b16 v113, 1, v112 op_sel_hi:[0,1]
    v_pk_lshrrev_b16 v112, 15, v112 op_sel_hi:[0,1]
    v_or_b32 v112, v112, v113
    v_pk_sub_u16 v112, v112, s37 clamp
    v_pk_max_u16 v75, v75, v112
    v_lshlrev_b32_sdwa v113, 2, v112 dst_sel:DWORD dst_unused:UNUSED_PAD src0_sel:DWORD src1_sel:WORD_1
    v_lshlrev_b32_sdwa v112, 2, v112 dst_sel:DWORD dst_unused:UNUSED_PAD src0_sel:DWORD src1_sel:WORD_0
    ds_read_b32 v96, v112 offset:0
    ds_read_b32 v97, v113 offset:0
    v_cvt_pk_bf16_f32 v114, v226, v227
    v_lshlrev_b32 v226, 16, v114
    v_and_b32 v227, 0xffff0000, v114
    v_pk_add_f32 v[226:227], v[226:227], v[26:27]
    v_cvt_pk_bf16_f32 v114, v226, v227
    v_lshlrev_b32 v226, 16, v114
    v_and_b32 v227, 0xffff0000, v114
    v_pk_lshlrev_b16 v115, 1, v114 op_sel_hi:[0,1]
    v_pk_lshrrev_b16 v114, 15, v114 op_sel_hi:[0,1]
    v_or_b32 v114, v114, v115
    v_pk_sub_u16 v114, v114, s37 clamp
    v_pk_max_u16 v75, v75, v114
    v_lshlrev_b32_sdwa v115, 2, v114 dst_sel:DWORD dst_unused:UNUSED_PAD src0_sel:DWORD src1_sel:WORD_1
    v_lshlrev_b32_sdwa v114, 2, v114 dst_sel:DWORD dst_unused:UNUSED_PAD src0_sel:DWORD src1_sel:WORD_0
    ds_read_b32 v98, v114 offset:0
    ds_read_b32 v99, v115 offset:0
    v_cvt_pk_bf16_f32 v116, v228, v229
    v_lshlrev_b32 v228, 16, v116
    v_and_b32 v229, 0xffff0000, v116
    v_pk_add_f32 v[228:229], v[228:229], v[28:29]
    v_cvt_pk_bf16_f32 v116, v228, v229
    v_lshlrev_b32 v228, 16, v116
    v_and_b32 v229, 0xffff0000, v116
    v_pk_lshlrev_b16 v117, 1, v116 op_sel_hi:[0,1]
    v_pk_lshrrev_b16 v116, 15, v116 op_sel_hi:[0,1]
    v_or_b32 v116, v116, v117
    v_pk_sub_u16 v116, v116, s37 clamp
    v_pk_max_u16 v75, v75, v116
    v_lshlrev_b32_sdwa v117, 2, v116 dst_sel:DWORD dst_unused:UNUSED_PAD src0_sel:DWORD src1_sel:WORD_1
    v_lshlrev_b32_sdwa v116, 2, v116 dst_sel:DWORD dst_unused:UNUSED_PAD src0_sel:DWORD src1_sel:WORD_0
    ds_read_b32 v100, v116 offset:0
    ds_read_b32 v101, v117 offset:0
    v_cvt_pk_bf16_f32 v118, v230, v231
    v_lshlrev_b32 v230, 16, v118
    v_and_b32 v231, 0xffff0000, v118
    v_pk_add_f32 v[230:231], v[230:231], v[30:31]
    v_cvt_pk_bf16_f32 v118, v230, v231
    v_lshlrev_b32 v230, 16, v118
    v_and_b32 v231, 0xffff0000, v118
    v_pk_lshlrev_b16 v119, 1, v118 op_sel_hi:[0,1]
    v_pk_lshrrev_b16 v118, 15, v118 op_sel_hi:[0,1]
    v_or_b32 v118, v118, v119
    v_pk_sub_u16 v118, v118, s37 clamp
    v_pk_max_u16 v75, v75, v118
    v_lshlrev_b32_sdwa v119, 2, v118 dst_sel:DWORD dst_unused:UNUSED_PAD src0_sel:DWORD src1_sel:WORD_1
    v_lshlrev_b32_sdwa v118, 2, v118 dst_sel:DWORD dst_unused:UNUSED_PAD src0_sel:DWORD src1_sel:WORD_0
    ds_read_b32 v102, v118 offset:0
    ds_read_b32 v103, v119 offset:0
    s_waitcnt lgkmcnt(8)
    v_pk_mul_f32 v[104:105], v[104:105], v[216:217]
    v_cvt_pk_bf16_f32 v68, v104, v105
    v_pk_mul_f32 v[106:107], v[106:107], v[218:219]
    v_cvt_pk_bf16_f32 v69, v106, v107
    v_pk_mul_f32 v[108:109], v[108:109], v[220:221]
    v_cvt_pk_bf16_f32 v70, v108, v109
    v_pk_mul_f32 v[110:111], v[110:111], v[222:223]
    v_cvt_pk_bf16_f32 v71, v110, v111
    s_add_u32 s30, s31, 201216
    buffer_store_dwordx4 v[68:71], v74, s[20:23], s30 offen sc1
    v_cvt_pk_bf16_f32 v112, v232, v233
    v_lshlrev_b32 v232, 16, v112
    v_and_b32 v233, 0xffff0000, v112
    v_pk_add_f32 v[232:233], v[232:233], v[32:33]
    v_cvt_pk_bf16_f32 v112, v232, v233
    v_lshlrev_b32 v232, 16, v112
    v_and_b32 v233, 0xffff0000, v112
    v_pk_lshlrev_b16 v113, 1, v112 op_sel_hi:[0,1]
    v_pk_lshrrev_b16 v112, 15, v112 op_sel_hi:[0,1]
    v_or_b32 v112, v112, v113
    v_pk_sub_u16 v112, v112, s37 clamp
    v_pk_max_u16 v75, v75, v112
    v_lshlrev_b32_sdwa v113, 2, v112 dst_sel:DWORD dst_unused:UNUSED_PAD src0_sel:DWORD src1_sel:WORD_1
    v_lshlrev_b32_sdwa v112, 2, v112 dst_sel:DWORD dst_unused:UNUSED_PAD src0_sel:DWORD src1_sel:WORD_0
    ds_read_b32 v104, v112 offset:0
    ds_read_b32 v105, v113 offset:0
    v_cvt_pk_bf16_f32 v114, v234, v235
    v_lshlrev_b32 v234, 16, v114
    v_and_b32 v235, 0xffff0000, v114
    v_pk_add_f32 v[234:235], v[234:235], v[34:35]
    v_cvt_pk_bf16_f32 v114, v234, v235
    v_lshlrev_b32 v234, 16, v114
    v_and_b32 v235, 0xffff0000, v114
    v_pk_lshlrev_b16 v115, 1, v114 op_sel_hi:[0,1]
    v_pk_lshrrev_b16 v114, 15, v114 op_sel_hi:[0,1]
    v_or_b32 v114, v114, v115
    v_pk_sub_u16 v114, v114, s37 clamp
    v_pk_max_u16 v75, v75, v114
    v_lshlrev_b32_sdwa v115, 2, v114 dst_sel:DWORD dst_unused:UNUSED_PAD src0_sel:DWORD src1_sel:WORD_1
    v_lshlrev_b32_sdwa v114, 2, v114 dst_sel:DWORD dst_unused:UNUSED_PAD src0_sel:DWORD src1_sel:WORD_0
    ds_read_b32 v106, v114 offset:0
    ds_read_b32 v107, v115 offset:0
    v_cvt_pk_bf16_f32 v116, v236, v237
    v_lshlrev_b32 v236, 16, v116
    v_and_b32 v237, 0xffff0000, v116
    v_pk_add_f32 v[236:237], v[236:237], v[36:37]
    v_cvt_pk_bf16_f32 v116, v236, v237
    v_lshlrev_b32 v236, 16, v116
    v_and_b32 v237, 0xffff0000, v116
    v_pk_lshlrev_b16 v117, 1, v116 op_sel_hi:[0,1]
    v_pk_lshrrev_b16 v116, 15, v116 op_sel_hi:[0,1]
    v_or_b32 v116, v116, v117
    v_pk_sub_u16 v116, v116, s37 clamp
    v_pk_max_u16 v75, v75, v116
    v_lshlrev_b32_sdwa v117, 2, v116 dst_sel:DWORD dst_unused:UNUSED_PAD src0_sel:DWORD src1_sel:WORD_1
    v_lshlrev_b32_sdwa v116, 2, v116 dst_sel:DWORD dst_unused:UNUSED_PAD src0_sel:DWORD src1_sel:WORD_0
    ds_read_b32 v108, v116 offset:0
    ds_read_b32 v109, v117 offset:0
    v_cvt_pk_bf16_f32 v118, v238, v239
    v_lshlrev_b32 v238, 16, v118
    v_and_b32 v239, 0xffff0000, v118
    v_pk_add_f32 v[238:239], v[238:239], v[38:39]
    v_cvt_pk_bf16_f32 v118, v238, v239
    v_lshlrev_b32 v238, 16, v118
    v_and_b32 v239, 0xffff0000, v118
    v_pk_lshlrev_b16 v119, 1, v118 op_sel_hi:[0,1]
    v_pk_lshrrev_b16 v118, 15, v118 op_sel_hi:[0,1]
    v_or_b32 v118, v118, v119
    v_pk_sub_u16 v118, v118, s37 clamp
    v_pk_max_u16 v75, v75, v118
    v_lshlrev_b32_sdwa v119, 2, v118 dst_sel:DWORD dst_unused:UNUSED_PAD src0_sel:DWORD src1_sel:WORD_1
    v_lshlrev_b32_sdwa v118, 2, v118 dst_sel:DWORD dst_unused:UNUSED_PAD src0_sel:DWORD src1_sel:WORD_0
    ds_read_b32 v110, v118 offset:0
    ds_read_b32 v111, v119 offset:0
    s_waitcnt lgkmcnt(8)
    v_pk_mul_f32 v[96:97], v[96:97], v[224:225]
    v_cvt_pk_bf16_f32 v64, v96, v97
    v_pk_mul_f32 v[98:99], v[98:99], v[226:227]
    v_cvt_pk_bf16_f32 v65, v98, v99
    v_pk_mul_f32 v[100:101], v[100:101], v[228:229]
    v_cvt_pk_bf16_f32 v66, v100, v101
    v_pk_mul_f32 v[102:103], v[102:103], v[230:231]
    v_cvt_pk_bf16_f32 v67, v102, v103
    s_add_u32 s30, s31, 198656
    buffer_store_dwordx4 v[64:67], v74, s[20:23], s30 offen sc1
    v_cvt_pk_bf16_f32 v112, v240, v241
    v_lshlrev_b32 v240, 16, v112
    v_and_b32 v241, 0xffff0000, v112
    v_pk_add_f32 v[240:241], v[240:241], v[40:41]
    v_cvt_pk_bf16_f32 v112, v240, v241
    v_lshlrev_b32 v240, 16, v112
    v_and_b32 v241, 0xffff0000, v112
    v_pk_lshlrev_b16 v113, 1, v112 op_sel_hi:[0,1]
    v_pk_lshrrev_b16 v112, 15, v112 op_sel_hi:[0,1]
    v_or_b32 v112, v112, v113
    v_pk_sub_u16 v112, v112, s37 clamp
    v_pk_max_u16 v75, v75, v112
    v_lshlrev_b32_sdwa v113, 2, v112 dst_sel:DWORD dst_unused:UNUSED_PAD src0_sel:DWORD src1_sel:WORD_1
    v_lshlrev_b32_sdwa v112, 2, v112 dst_sel:DWORD dst_unused:UNUSED_PAD src0_sel:DWORD src1_sel:WORD_0
    ds_read_b32 v96, v112 offset:0
    ds_read_b32 v97, v113 offset:0
    v_cvt_pk_bf16_f32 v114, v242, v243
    v_lshlrev_b32 v242, 16, v114
    v_and_b32 v243, 0xffff0000, v114
    v_pk_add_f32 v[242:243], v[242:243], v[42:43]
    v_cvt_pk_bf16_f32 v114, v242, v243
    v_lshlrev_b32 v242, 16, v114
    v_and_b32 v243, 0xffff0000, v114
    v_pk_lshlrev_b16 v115, 1, v114 op_sel_hi:[0,1]
    v_pk_lshrrev_b16 v114, 15, v114 op_sel_hi:[0,1]
    v_or_b32 v114, v114, v115
    v_pk_sub_u16 v114, v114, s37 clamp
    v_pk_max_u16 v75, v75, v114
    v_lshlrev_b32_sdwa v115, 2, v114 dst_sel:DWORD dst_unused:UNUSED_PAD src0_sel:DWORD src1_sel:WORD_1
    v_lshlrev_b32_sdwa v114, 2, v114 dst_sel:DWORD dst_unused:UNUSED_PAD src0_sel:DWORD src1_sel:WORD_0
    ds_read_b32 v98, v114 offset:0
    ds_read_b32 v99, v115 offset:0
    v_cvt_pk_bf16_f32 v116, v244, v245
    v_lshlrev_b32 v244, 16, v116
    v_and_b32 v245, 0xffff0000, v116
    v_pk_add_f32 v[244:245], v[244:245], v[44:45]
    v_cvt_pk_bf16_f32 v116, v244, v245
    v_lshlrev_b32 v244, 16, v116
    v_and_b32 v245, 0xffff0000, v116
    v_pk_lshlrev_b16 v117, 1, v116 op_sel_hi:[0,1]
    v_pk_lshrrev_b16 v116, 15, v116 op_sel_hi:[0,1]
    v_or_b32 v116, v116, v117
    v_pk_sub_u16 v116, v116, s37 clamp
    v_pk_max_u16 v75, v75, v116
    v_lshlrev_b32_sdwa v117, 2, v116 dst_sel:DWORD dst_unused:UNUSED_PAD src0_sel:DWORD src1_sel:WORD_1
    v_lshlrev_b32_sdwa v116, 2, v116 dst_sel:DWORD dst_unused:UNUSED_PAD src0_sel:DWORD src1_sel:WORD_0
    ds_read_b32 v100, v116 offset:0
    ds_read_b32 v101, v117 offset:0
    v_cvt_pk_bf16_f32 v118, v246, v247
    v_lshlrev_b32 v246, 16, v118
    v_and_b32 v247, 0xffff0000, v118
    v_pk_add_f32 v[246:247], v[246:247], v[46:47]
    v_cvt_pk_bf16_f32 v118, v246, v247
    v_lshlrev_b32 v246, 16, v118
    v_and_b32 v247, 0xffff0000, v118
    v_pk_lshlrev_b16 v119, 1, v118 op_sel_hi:[0,1]
    v_pk_lshrrev_b16 v118, 15, v118 op_sel_hi:[0,1]
    v_or_b32 v118, v118, v119
    v_pk_sub_u16 v118, v118, s37 clamp
    v_pk_max_u16 v75, v75, v118
    v_lshlrev_b32_sdwa v119, 2, v118 dst_sel:DWORD dst_unused:UNUSED_PAD src0_sel:DWORD src1_sel:WORD_1
    v_lshlrev_b32_sdwa v118, 2, v118 dst_sel:DWORD dst_unused:UNUSED_PAD src0_sel:DWORD src1_sel:WORD_0
    ds_read_b32 v102, v118 offset:0
    ds_read_b32 v103, v119 offset:0
    s_waitcnt lgkmcnt(8)
    v_pk_mul_f32 v[104:105], v[104:105], v[232:233]
    v_cvt_pk_bf16_f32 v68, v104, v105
    v_pk_mul_f32 v[106:107], v[106:107], v[234:235]
    v_cvt_pk_bf16_f32 v69, v106, v107
    v_pk_mul_f32 v[108:109], v[108:109], v[236:237]
    v_cvt_pk_bf16_f32 v70, v108, v109
    v_pk_mul_f32 v[110:111], v[110:111], v[238:239]
    v_cvt_pk_bf16_f32 v71, v110, v111
    s_add_u32 s30, s31, 199168
    buffer_store_dwordx4 v[68:71], v74, s[20:23], s30 offen sc1
    v_cvt_pk_bf16_f32 v112, v248, v249
    v_lshlrev_b32 v248, 16, v112
    v_and_b32 v249, 0xffff0000, v112
    v_pk_add_f32 v[248:249], v[248:249], v[48:49]
    v_cvt_pk_bf16_f32 v112, v248, v249
    v_lshlrev_b32 v248, 16, v112
    v_and_b32 v249, 0xffff0000, v112
    v_pk_lshlrev_b16 v113, 1, v112 op_sel_hi:[0,1]
    v_pk_lshrrev_b16 v112, 15, v112 op_sel_hi:[0,1]
    v_or_b32 v112, v112, v113
    v_pk_sub_u16 v112, v112, s37 clamp
    v_pk_max_u16 v75, v75, v112
    v_lshlrev_b32_sdwa v113, 2, v112 dst_sel:DWORD dst_unused:UNUSED_PAD src0_sel:DWORD src1_sel:WORD_1
    v_lshlrev_b32_sdwa v112, 2, v112 dst_sel:DWORD dst_unused:UNUSED_PAD src0_sel:DWORD src1_sel:WORD_0
    ds_read_b32 v104, v112 offset:0
    ds_read_b32 v105, v113 offset:0
    v_cvt_pk_bf16_f32 v114, v250, v251
    v_lshlrev_b32 v250, 16, v114
    v_and_b32 v251, 0xffff0000, v114
    v_pk_add_f32 v[250:251], v[250:251], v[50:51]
    v_cvt_pk_bf16_f32 v114, v250, v251
    v_lshlrev_b32 v250, 16, v114
    v_and_b32 v251, 0xffff0000, v114
    v_pk_lshlrev_b16 v115, 1, v114 op_sel_hi:[0,1]
    v_pk_lshrrev_b16 v114, 15, v114 op_sel_hi:[0,1]
    v_or_b32 v114, v114, v115
    v_pk_sub_u16 v114, v114, s37 clamp
    v_pk_max_u16 v75, v75, v114
    v_lshlrev_b32_sdwa v115, 2, v114 dst_sel:DWORD dst_unused:UNUSED_PAD src0_sel:DWORD src1_sel:WORD_1
    v_lshlrev_b32_sdwa v114, 2, v114 dst_sel:DWORD dst_unused:UNUSED_PAD src0_sel:DWORD src1_sel:WORD_0
    ds_read_b32 v106, v114 offset:0
    ds_read_b32 v107, v115 offset:0
    v_cvt_pk_bf16_f32 v116, v252, v253
    v_lshlrev_b32 v252, 16, v116
    v_and_b32 v253, 0xffff0000, v116
    v_pk_add_f32 v[252:253], v[252:253], v[52:53]
    v_cvt_pk_bf16_f32 v116, v252, v253
    v_lshlrev_b32 v252, 16, v116
    v_and_b32 v253, 0xffff0000, v116
    v_pk_lshlrev_b16 v117, 1, v116 op_sel_hi:[0,1]
    v_pk_lshrrev_b16 v116, 15, v116 op_sel_hi:[0,1]
    v_or_b32 v116, v116, v117
    v_pk_sub_u16 v116, v116, s37 clamp
    v_pk_max_u16 v75, v75, v116
    v_lshlrev_b32_sdwa v117, 2, v116 dst_sel:DWORD dst_unused:UNUSED_PAD src0_sel:DWORD src1_sel:WORD_1
    v_lshlrev_b32_sdwa v116, 2, v116 dst_sel:DWORD dst_unused:UNUSED_PAD src0_sel:DWORD src1_sel:WORD_0
    ds_read_b32 v108, v116 offset:0
    ds_read_b32 v109, v117 offset:0
    v_cvt_pk_bf16_f32 v118, v254, v255
    v_lshlrev_b32 v254, 16, v118
    v_and_b32 v255, 0xffff0000, v118
    v_pk_add_f32 v[254:255], v[254:255], v[54:55]
    v_cvt_pk_bf16_f32 v118, v254, v255
    v_lshlrev_b32 v254, 16, v118
    v_and_b32 v255, 0xffff0000, v118
    v_pk_lshlrev_b16 v119, 1, v118 op_sel_hi:[0,1]
    v_pk_lshrrev_b16 v118, 15, v118 op_sel_hi:[0,1]
    v_or_b32 v118, v118, v119
    v_pk_sub_u16 v118, v118, s37 clamp
    v_pk_max_u16 v75, v75, v118
    v_lshlrev_b32_sdwa v119, 2, v118 dst_sel:DWORD dst_unused:UNUSED_PAD src0_sel:DWORD src1_sel:WORD_1
    v_lshlrev_b32_sdwa v118, 2, v118 dst_sel:DWORD dst_unused:UNUSED_PAD src0_sel:DWORD src1_sel:WORD_0
    ds_read_b32 v110, v118 offset:0
    ds_read_b32 v111, v119 offset:0
    s_waitcnt lgkmcnt(8)
    v_pk_mul_f32 v[96:97], v[96:97], v[240:241]
    v_cvt_pk_bf16_f32 v64, v96, v97
    v_pk_mul_f32 v[98:99], v[98:99], v[242:243]
    v_cvt_pk_bf16_f32 v65, v98, v99
    v_pk_mul_f32 v[100:101], v[100:101], v[244:245]
    v_cvt_pk_bf16_f32 v66, v100, v101
    v_pk_mul_f32 v[102:103], v[102:103], v[246:247]
    v_cvt_pk_bf16_f32 v67, v102, v103
    s_add_u32 s30, s31, 202752
    buffer_store_dwordx4 v[64:67], v74, s[20:23], s30 offen sc1
    s_waitcnt lgkmcnt(0)
    v_pk_mul_f32 v[104:105], v[104:105], v[248:249]
    v_cvt_pk_bf16_f32 v68, v104, v105
    v_pk_mul_f32 v[106:107], v[106:107], v[250:251]
    v_cvt_pk_bf16_f32 v69, v106, v107
    v_pk_mul_f32 v[108:109], v[108:109], v[252:253]
    v_cvt_pk_bf16_f32 v70, v108, v109
    v_pk_mul_f32 v[110:111], v[110:111], v[254:255]
    v_cvt_pk_bf16_f32 v71, v110, v111
    s_add_u32 s30, s31, 203264
    buffer_store_dwordx4 v[68:71], v74, s[20:23], s30 offen sc1
    s_mov_b32 s30, 234819071
    v_pk_sub_u16 v76, v75, s30 clamp
    v_cmp_ne_u32 vcc, 0, v76
    s_cbranch_vccz K1_MLP_DONEL
    s_waitcnt vmcnt(0)
    v_mul_f32 v56, -abs(v192), s32
    v_mul_f32 v57, -abs(v193), s32
    v_exp_f32 v56, v56
    v_exp_f32 v57, v57
    v_max_f32 v60, 0, v192
    v_max_f32 v61, 0, v193
    v_cvt_pk_bf16_f32 v62, v56, v57
    v_lshlrev_b32 v56, 16, v62
    v_and_b32 v57, 0xffff0000, v62
    v_add_f32 v58, 1.0, v56
    v_add_f32 v59, 1.0, v57
    v_log_f32 v58, v58
    v_log_f32 v59, v59
    v_cmp_gt_f32 s[38:39], s35, v56
    v_cmp_gt_f32 s[40:41], s35, v57
    v_mul_f32 v58, s33, v58
    v_mul_f32 v59, s33, v59
    v_cndmask_b32 v58, v58, v56, s[38:39]
    v_cndmask_b32 v59, v59, v57, s[40:41]
    v_cvt_pk_bf16_f32 v62, v58, v59
    v_lshlrev_b32 v58, 16, v62
    v_and_b32 v59, 0xffff0000, v62
    v_add_f32 v60, v60, v58
    v_add_f32 v61, v61, v59
    v_cvt_pk_bf16_f32 v62, v60, v61
    v_lshlrev_b32 v60, 16, v62
    v_and_b32 v61, 0xffff0000, v62
    v_mul_f32 v56, s34, v60
    v_mul_f32 v57, s34, v61
    v_exp_f32 v56, v56
    v_exp_f32 v57, v57
    v_cmp_gt_f32 s[38:39], s36, v60
    v_cmp_gt_f32 s[40:41], s36, v61
    v_add_f32 v62, 1.0, v56
    v_add_f32 v63, 1.0, v57
    v_rcp_f32 v62, v62
    v_rcp_f32 v63, v63
    v_sub_f32 v56, 1.0, v56
    v_sub_f32 v57, 1.0, v57
    v_mul_f32 v56, v56, v62
    v_mul_f32 v57, v57, v63
    v_cndmask_b32 v56, v56, v60, s[38:39]
    v_cndmask_b32 v57, v57, v61, s[40:41]
    v_cvt_pk_bf16_f32 v62, v56, v57
    v_lshlrev_b32 v56, 16, v62
    v_and_b32 v57, 0xffff0000, v62
    v_mul_f32 v56, v192, v56
    v_mul_f32 v57, v193, v57
    v_cvt_pk_bf16_f32 v64, v56, v57
    v_mul_f32 v56, -abs(v194), s32
    v_mul_f32 v57, -abs(v195), s32
    v_exp_f32 v56, v56
    v_exp_f32 v57, v57
    v_max_f32 v60, 0, v194
    v_max_f32 v61, 0, v195
    v_cvt_pk_bf16_f32 v62, v56, v57
    v_lshlrev_b32 v56, 16, v62
    v_and_b32 v57, 0xffff0000, v62
    v_add_f32 v58, 1.0, v56
    v_add_f32 v59, 1.0, v57
    v_log_f32 v58, v58
    v_log_f32 v59, v59
    v_cmp_gt_f32 s[38:39], s35, v56
    v_cmp_gt_f32 s[40:41], s35, v57
    v_mul_f32 v58, s33, v58
    v_mul_f32 v59, s33, v59
    v_cndmask_b32 v58, v58, v56, s[38:39]
    v_cndmask_b32 v59, v59, v57, s[40:41]
    v_cvt_pk_bf16_f32 v62, v58, v59
    v_lshlrev_b32 v58, 16, v62
    v_and_b32 v59, 0xffff0000, v62
    v_add_f32 v60, v60, v58
    v_add_f32 v61, v61, v59
    v_cvt_pk_bf16_f32 v62, v60, v61
    v_lshlrev_b32 v60, 16, v62
    v_and_b32 v61, 0xffff0000, v62
    v_mul_f32 v56, s34, v60
    v_mul_f32 v57, s34, v61
    v_exp_f32 v56, v56
    v_exp_f32 v57, v57
    v_cmp_gt_f32 s[38:39], s36, v60
    v_cmp_gt_f32 s[40:41], s36, v61
    v_add_f32 v62, 1.0, v56
    v_add_f32 v63, 1.0, v57
    v_rcp_f32 v62, v62
    v_rcp_f32 v63, v63
    v_sub_f32 v56, 1.0, v56
    v_sub_f32 v57, 1.0, v57
    v_mul_f32 v56, v56, v62
    v_mul_f32 v57, v57, v63
    v_cndmask_b32 v56, v56, v60, s[38:39]
    v_cndmask_b32 v57, v57, v61, s[40:41]
    v_cvt_pk_bf16_f32 v62, v56, v57
    v_lshlrev_b32 v56, 16, v62
    v_and_b32 v57, 0xffff0000, v62
    v_mul_f32 v56, v194, v56
    v_mul_f32 v57, v195, v57
    v_cvt_pk_bf16_f32 v65, v56, v57
    v_mul_f32 v56, -abs(v196), s32
    v_mul_f32 v57, -abs(v197), s32
    v_exp_f32 v56, v56
    v_exp_f32 v57, v57
    v_max_f32 v60, 0, v196
    v_max_f32 v61, 0, v197
    v_cvt_pk_bf16_f32 v62, v56, v57
    v_lshlrev_b32 v56, 16, v62
    v_and_b32 v57, 0xffff0000, v62
    v_add_f32 v58, 1.0, v56
    v_add_f32 v59, 1.0, v57
    v_log_f32 v58, v58
    v_log_f32 v59, v59
    v_cmp_gt_f32 s[38:39], s35, v56
    v_cmp_gt_f32 s[40:41], s35, v57
    v_mul_f32 v58, s33, v58
    v_mul_f32 v59, s33, v59
    v_cndmask_b32 v58, v58, v56, s[38:39]
    v_cndmask_b32 v59, v59, v57, s[40:41]
    v_cvt_pk_bf16_f32 v62, v58, v59
    v_lshlrev_b32 v58, 16, v62
    v_and_b32 v59, 0xffff0000, v62
    v_add_f32 v60, v60, v58
    v_add_f32 v61, v61, v59
    v_cvt_pk_bf16_f32 v62, v60, v61
    v_lshlrev_b32 v60, 16, v62
    v_and_b32 v61, 0xffff0000, v62
    v_mul_f32 v56, s34, v60
    v_mul_f32 v57, s34, v61
    v_exp_f32 v56, v56
    v_exp_f32 v57, v57
    v_cmp_gt_f32 s[38:39], s36, v60
    v_cmp_gt_f32 s[40:41], s36, v61
    v_add_f32 v62, 1.0, v56
    v_add_f32 v63, 1.0, v57
    v_rcp_f32 v62, v62
    v_rcp_f32 v63, v63
    v_sub_f32 v56, 1.0, v56
    v_sub_f32 v57, 1.0, v57
    v_mul_f32 v56, v56, v62
    v_mul_f32 v57, v57, v63
    v_cndmask_b32 v56, v56, v60, s[38:39]
    v_cndmask_b32 v57, v57, v61, s[40:41]
    v_cvt_pk_bf16_f32 v62, v56, v57
    v_lshlrev_b32 v56, 16, v62
    v_and_b32 v57, 0xffff0000, v62
    v_mul_f32 v56, v196, v56
    v_mul_f32 v57, v197, v57
    v_cvt_pk_bf16_f32 v66, v56, v57
    v_mul_f32 v56, -abs(v198), s32
    v_mul_f32 v57, -abs(v199), s32
    v_exp_f32 v56, v56
    v_exp_f32 v57, v57
    v_max_f32 v60, 0, v198
    v_max_f32 v61, 0, v199
    v_cvt_pk_bf16_f32 v62, v56, v57
    v_lshlrev_b32 v56, 16, v62
    v_and_b32 v57, 0xffff0000, v62
    v_add_f32 v58, 1.0, v56
    v_add_f32 v59, 1.0, v57
    v_log_f32 v58, v58
    v_log_f32 v59, v59
    v_cmp_gt_f32 s[38:39], s35, v56
    v_cmp_gt_f32 s[40:41], s35, v57
    v_mul_f32 v58, s33, v58
    v_mul_f32 v59, s33, v59
    v_cndmask_b32 v58, v58, v56, s[38:39]
    v_cndmask_b32 v59, v59, v57, s[40:41]
    v_cvt_pk_bf16_f32 v62, v58, v59
    v_lshlrev_b32 v58, 16, v62
    v_and_b32 v59, 0xffff0000, v62
    v_add_f32 v60, v60, v58
    v_add_f32 v61, v61, v59
    v_cvt_pk_bf16_f32 v62, v60, v61
    v_lshlrev_b32 v60, 16, v62
    v_and_b32 v61, 0xffff0000, v62
    v_mul_f32 v56, s34, v60
    v_mul_f32 v57, s34, v61
    v_exp_f32 v56, v56
    v_exp_f32 v57, v57
    v_cmp_gt_f32 s[38:39], s36, v60
    v_cmp_gt_f32 s[40:41], s36, v61
    v_add_f32 v62, 1.0, v56
    v_add_f32 v63, 1.0, v57
    v_rcp_f32 v62, v62
    v_rcp_f32 v63, v63
    v_sub_f32 v56, 1.0, v56
    v_sub_f32 v57, 1.0, v57
    v_mul_f32 v56, v56, v62
    v_mul_f32 v57, v57, v63
    v_cndmask_b32 v56, v56, v60, s[38:39]
    v_cndmask_b32 v57, v57, v61, s[40:41]
    v_cvt_pk_bf16_f32 v62, v56, v57
    v_lshlrev_b32 v56, 16, v62
    v_and_b32 v57, 0xffff0000, v62
    v_mul_f32 v56, v198, v56
    v_mul_f32 v57, v199, v57
    v_cvt_pk_bf16_f32 v67, v56, v57
    s_add_u32 s30, s31, 196608
    buffer_store_dwordx4 v[64:67], v74, s[20:23], s30 offen sc1
    v_mul_f32 v56, -abs(v200), s32
    v_mul_f32 v57, -abs(v201), s32
    v_exp_f32 v56, v56
    v_exp_f32 v57, v57
    v_max_f32 v60, 0, v200
    v_max_f32 v61, 0, v201
    v_cvt_pk_bf16_f32 v62, v56, v57
    v_lshlrev_b32 v56, 16, v62
    v_and_b32 v57, 0xffff0000, v62
    v_add_f32 v58, 1.0, v56
    v_add_f32 v59, 1.0, v57
    v_log_f32 v58, v58
    v_log_f32 v59, v59
    v_cmp_gt_f32 s[38:39], s35, v56
    v_cmp_gt_f32 s[40:41], s35, v57
    v_mul_f32 v58, s33, v58
    v_mul_f32 v59, s33, v59
    v_cndmask_b32 v58, v58, v56, s[38:39]
    v_cndmask_b32 v59, v59, v57, s[40:41]
    v_cvt_pk_bf16_f32 v62, v58, v59
    v_lshlrev_b32 v58, 16, v62
    v_and_b32 v59, 0xffff0000, v62
    v_add_f32 v60, v60, v58
    v_add_f32 v61, v61, v59
    v_cvt_pk_bf16_f32 v62, v60, v61
    v_lshlrev_b32 v60, 16, v62
    v_and_b32 v61, 0xffff0000, v62
    v_mul_f32 v56, s34, v60
    v_mul_f32 v57, s34, v61
    v_exp_f32 v56, v56
    v_exp_f32 v57, v57
    v_cmp_gt_f32 s[38:39], s36, v60
    v_cmp_gt_f32 s[40:41], s36, v61
    v_add_f32 v62, 1.0, v56
    v_add_f32 v63, 1.0, v57
    v_rcp_f32 v62, v62
    v_rcp_f32 v63, v63
    v_sub_f32 v56, 1.0, v56
    v_sub_f32 v57, 1.0, v57
    v_mul_f32 v56, v56, v62
    v_mul_f32 v57, v57, v63
    v_cndmask_b32 v56, v56, v60, s[38:39]
    v_cndmask_b32 v57, v57, v61, s[40:41]
    v_cvt_pk_bf16_f32 v62, v56, v57
    v_lshlrev_b32 v56, 16, v62
    v_and_b32 v57, 0xffff0000, v62
    v_mul_f32 v56, v200, v56
    v_mul_f32 v57, v201, v57
    v_cvt_pk_bf16_f32 v68, v56, v57
    v_mul_f32 v56, -abs(v202), s32
    v_mul_f32 v57, -abs(v203), s32
    v_exp_f32 v56, v56
    v_exp_f32 v57, v57
    v_max_f32 v60, 0, v202
    v_max_f32 v61, 0, v203
    v_cvt_pk_bf16_f32 v62, v56, v57
    v_lshlrev_b32 v56, 16, v62
    v_and_b32 v57, 0xffff0000, v62
    v_add_f32 v58, 1.0, v56
    v_add_f32 v59, 1.0, v57
    v_log_f32 v58, v58
    v_log_f32 v59, v59
    v_cmp_gt_f32 s[38:39], s35, v56
    v_cmp_gt_f32 s[40:41], s35, v57
    v_mul_f32 v58, s33, v58
    v_mul_f32 v59, s33, v59
    v_cndmask_b32 v58, v58, v56, s[38:39]
    v_cndmask_b32 v59, v59, v57, s[40:41]
    v_cvt_pk_bf16_f32 v62, v58, v59
    v_lshlrev_b32 v58, 16, v62
    v_and_b32 v59, 0xffff0000, v62
    v_add_f32 v60, v60, v58
    v_add_f32 v61, v61, v59
    v_cvt_pk_bf16_f32 v62, v60, v61
    v_lshlrev_b32 v60, 16, v62
    v_and_b32 v61, 0xffff0000, v62
    v_mul_f32 v56, s34, v60
    v_mul_f32 v57, s34, v61
    v_exp_f32 v56, v56
    v_exp_f32 v57, v57
    v_cmp_gt_f32 s[38:39], s36, v60
    v_cmp_gt_f32 s[40:41], s36, v61
    v_add_f32 v62, 1.0, v56
    v_add_f32 v63, 1.0, v57
    v_rcp_f32 v62, v62
    v_rcp_f32 v63, v63
    v_sub_f32 v56, 1.0, v56
    v_sub_f32 v57, 1.0, v57
    v_mul_f32 v56, v56, v62
    v_mul_f32 v57, v57, v63
    v_cndmask_b32 v56, v56, v60, s[38:39]
    v_cndmask_b32 v57, v57, v61, s[40:41]
    v_cvt_pk_bf16_f32 v62, v56, v57
    v_lshlrev_b32 v56, 16, v62
    v_and_b32 v57, 0xffff0000, v62
    v_mul_f32 v56, v202, v56
    v_mul_f32 v57, v203, v57
    v_cvt_pk_bf16_f32 v69, v56, v57
    v_mul_f32 v56, -abs(v204), s32
    v_mul_f32 v57, -abs(v205), s32
    v_exp_f32 v56, v56
    v_exp_f32 v57, v57
    v_max_f32 v60, 0, v204
    v_max_f32 v61, 0, v205
    v_cvt_pk_bf16_f32 v62, v56, v57
    v_lshlrev_b32 v56, 16, v62
    v_and_b32 v57, 0xffff0000, v62
    v_add_f32 v58, 1.0, v56
    v_add_f32 v59, 1.0, v57
    v_log_f32 v58, v58
    v_log_f32 v59, v59
    v_cmp_gt_f32 s[38:39], s35, v56
    v_cmp_gt_f32 s[40:41], s35, v57
    v_mul_f32 v58, s33, v58
    v_mul_f32 v59, s33, v59
    v_cndmask_b32 v58, v58, v56, s[38:39]
    v_cndmask_b32 v59, v59, v57, s[40:41]
    v_cvt_pk_bf16_f32 v62, v58, v59
    v_lshlrev_b32 v58, 16, v62
    v_and_b32 v59, 0xffff0000, v62
    v_add_f32 v60, v60, v58
    v_add_f32 v61, v61, v59
    v_cvt_pk_bf16_f32 v62, v60, v61
    v_lshlrev_b32 v60, 16, v62
    v_and_b32 v61, 0xffff0000, v62
    v_mul_f32 v56, s34, v60
    v_mul_f32 v57, s34, v61
    v_exp_f32 v56, v56
    v_exp_f32 v57, v57
    v_cmp_gt_f32 s[38:39], s36, v60
    v_cmp_gt_f32 s[40:41], s36, v61
    v_add_f32 v62, 1.0, v56
    v_add_f32 v63, 1.0, v57
    v_rcp_f32 v62, v62
    v_rcp_f32 v63, v63
    v_sub_f32 v56, 1.0, v56
    v_sub_f32 v57, 1.0, v57
    v_mul_f32 v56, v56, v62
    v_mul_f32 v57, v57, v63
    v_cndmask_b32 v56, v56, v60, s[38:39]
    v_cndmask_b32 v57, v57, v61, s[40:41]
    v_cvt_pk_bf16_f32 v62, v56, v57
    v_lshlrev_b32 v56, 16, v62
    v_and_b32 v57, 0xffff0000, v62
    v_mul_f32 v56, v204, v56
    v_mul_f32 v57, v205, v57
    v_cvt_pk_bf16_f32 v70, v56, v57
    v_mul_f32 v56, -abs(v206), s32
    v_mul_f32 v57, -abs(v207), s32
    v_exp_f32 v56, v56
    v_exp_f32 v57, v57
    v_max_f32 v60, 0, v206
    v_max_f32 v61, 0, v207
    v_cvt_pk_bf16_f32 v62, v56, v57
    v_lshlrev_b32 v56, 16, v62
    v_and_b32 v57, 0xffff0000, v62
    v_add_f32 v58, 1.0, v56
    v_add_f32 v59, 1.0, v57
    v_log_f32 v58, v58
    v_log_f32 v59, v59
    v_cmp_gt_f32 s[38:39], s35, v56
    v_cmp_gt_f32 s[40:41], s35, v57
    v_mul_f32 v58, s33, v58
    v_mul_f32 v59, s33, v59
    v_cndmask_b32 v58, v58, v56, s[38:39]
    v_cndmask_b32 v59, v59, v57, s[40:41]
    v_cvt_pk_bf16_f32 v62, v58, v59
    v_lshlrev_b32 v58, 16, v62
    v_and_b32 v59, 0xffff0000, v62
    v_add_f32 v60, v60, v58
    v_add_f32 v61, v61, v59
    v_cvt_pk_bf16_f32 v62, v60, v61
    v_lshlrev_b32 v60, 16, v62
    v_and_b32 v61, 0xffff0000, v62
    v_mul_f32 v56, s34, v60
    v_mul_f32 v57, s34, v61
    v_exp_f32 v56, v56
    v_exp_f32 v57, v57
    v_cmp_gt_f32 s[38:39], s36, v60
    v_cmp_gt_f32 s[40:41], s36, v61
    v_add_f32 v62, 1.0, v56
    v_add_f32 v63, 1.0, v57
    v_rcp_f32 v62, v62
    v_rcp_f32 v63, v63
    v_sub_f32 v56, 1.0, v56
    v_sub_f32 v57, 1.0, v57
    v_mul_f32 v56, v56, v62
    v_mul_f32 v57, v57, v63
    v_cndmask_b32 v56, v56, v60, s[38:39]
    v_cndmask_b32 v57, v57, v61, s[40:41]
    v_cvt_pk_bf16_f32 v62, v56, v57
    v_lshlrev_b32 v56, 16, v62
    v_and_b32 v57, 0xffff0000, v62
    v_mul_f32 v56, v206, v56
    v_mul_f32 v57, v207, v57
    v_cvt_pk_bf16_f32 v71, v56, v57
    s_add_u32 s30, s31, 197120
    buffer_store_dwordx4 v[68:71], v74, s[20:23], s30 offen sc1
    v_mul_f32 v56, -abs(v208), s32
    v_mul_f32 v57, -abs(v209), s32
    v_exp_f32 v56, v56
    v_exp_f32 v57, v57
    v_max_f32 v60, 0, v208
    v_max_f32 v61, 0, v209
    v_cvt_pk_bf16_f32 v62, v56, v57
    v_lshlrev_b32 v56, 16, v62
    v_and_b32 v57, 0xffff0000, v62
    v_add_f32 v58, 1.0, v56
    v_add_f32 v59, 1.0, v57
    v_log_f32 v58, v58
    v_log_f32 v59, v59
    v_cmp_gt_f32 s[38:39], s35, v56
    v_cmp_gt_f32 s[40:41], s35, v57
    v_mul_f32 v58, s33, v58
    v_mul_f32 v59, s33, v59
    v_cndmask_b32 v58, v58, v56, s[38:39]
    v_cndmask_b32 v59, v59, v57, s[40:41]
    v_cvt_pk_bf16_f32 v62, v58, v59
    v_lshlrev_b32 v58, 16, v62
    v_and_b32 v59, 0xffff0000, v62
    v_add_f32 v60, v60, v58
    v_add_f32 v61, v61, v59
    v_cvt_pk_bf16_f32 v62, v60, v61
    v_lshlrev_b32 v60, 16, v62
    v_and_b32 v61, 0xffff0000, v62
    v_mul_f32 v56, s34, v60
    v_mul_f32 v57, s34, v61
    v_exp_f32 v56, v56
    v_exp_f32 v57, v57
    v_cmp_gt_f32 s[38:39], s36, v60
    v_cmp_gt_f32 s[40:41], s36, v61
    v_add_f32 v62, 1.0, v56
    v_add_f32 v63, 1.0, v57
    v_rcp_f32 v62, v62
    v_rcp_f32 v63, v63
    v_sub_f32 v56, 1.0, v56
    v_sub_f32 v57, 1.0, v57
    v_mul_f32 v56, v56, v62
    v_mul_f32 v57, v57, v63
    v_cndmask_b32 v56, v56, v60, s[38:39]
    v_cndmask_b32 v57, v57, v61, s[40:41]
    v_cvt_pk_bf16_f32 v62, v56, v57
    v_lshlrev_b32 v56, 16, v62
    v_and_b32 v57, 0xffff0000, v62
    v_mul_f32 v56, v208, v56
    v_mul_f32 v57, v209, v57
    v_cvt_pk_bf16_f32 v64, v56, v57
    v_mul_f32 v56, -abs(v210), s32
    v_mul_f32 v57, -abs(v211), s32
    v_exp_f32 v56, v56
    v_exp_f32 v57, v57
    v_max_f32 v60, 0, v210
    v_max_f32 v61, 0, v211
    v_cvt_pk_bf16_f32 v62, v56, v57
    v_lshlrev_b32 v56, 16, v62
    v_and_b32 v57, 0xffff0000, v62
    v_add_f32 v58, 1.0, v56
    v_add_f32 v59, 1.0, v57
    v_log_f32 v58, v58
    v_log_f32 v59, v59
    v_cmp_gt_f32 s[38:39], s35, v56
    v_cmp_gt_f32 s[40:41], s35, v57
    v_mul_f32 v58, s33, v58
    v_mul_f32 v59, s33, v59
    v_cndmask_b32 v58, v58, v56, s[38:39]
    v_cndmask_b32 v59, v59, v57, s[40:41]
    v_cvt_pk_bf16_f32 v62, v58, v59
    v_lshlrev_b32 v58, 16, v62
    v_and_b32 v59, 0xffff0000, v62
    v_add_f32 v60, v60, v58
    v_add_f32 v61, v61, v59
    v_cvt_pk_bf16_f32 v62, v60, v61
    v_lshlrev_b32 v60, 16, v62
    v_and_b32 v61, 0xffff0000, v62
    v_mul_f32 v56, s34, v60
    v_mul_f32 v57, s34, v61
    v_exp_f32 v56, v56
    v_exp_f32 v57, v57
    v_cmp_gt_f32 s[38:39], s36, v60
    v_cmp_gt_f32 s[40:41], s36, v61
    v_add_f32 v62, 1.0, v56
    v_add_f32 v63, 1.0, v57
    v_rcp_f32 v62, v62
    v_rcp_f32 v63, v63
    v_sub_f32 v56, 1.0, v56
    v_sub_f32 v57, 1.0, v57
    v_mul_f32 v56, v56, v62
    v_mul_f32 v57, v57, v63
    v_cndmask_b32 v56, v56, v60, s[38:39]
    v_cndmask_b32 v57, v57, v61, s[40:41]
    v_cvt_pk_bf16_f32 v62, v56, v57
    v_lshlrev_b32 v56, 16, v62
    v_and_b32 v57, 0xffff0000, v62
    v_mul_f32 v56, v210, v56
    v_mul_f32 v57, v211, v57
    v_cvt_pk_bf16_f32 v65, v56, v57
    v_mul_f32 v56, -abs(v212), s32
    v_mul_f32 v57, -abs(v213), s32
    v_exp_f32 v56, v56
    v_exp_f32 v57, v57
    v_max_f32 v60, 0, v212
    v_max_f32 v61, 0, v213
    v_cvt_pk_bf16_f32 v62, v56, v57
    v_lshlrev_b32 v56, 16, v62
    v_and_b32 v57, 0xffff0000, v62
    v_add_f32 v58, 1.0, v56
    v_add_f32 v59, 1.0, v57
    v_log_f32 v58, v58
    v_log_f32 v59, v59
    v_cmp_gt_f32 s[38:39], s35, v56
    v_cmp_gt_f32 s[40:41], s35, v57
    v_mul_f32 v58, s33, v58
    v_mul_f32 v59, s33, v59
    v_cndmask_b32 v58, v58, v56, s[38:39]
    v_cndmask_b32 v59, v59, v57, s[40:41]
    v_cvt_pk_bf16_f32 v62, v58, v59
    v_lshlrev_b32 v58, 16, v62
    v_and_b32 v59, 0xffff0000, v62
    v_add_f32 v60, v60, v58
    v_add_f32 v61, v61, v59
    v_cvt_pk_bf16_f32 v62, v60, v61
    v_lshlrev_b32 v60, 16, v62
    v_and_b32 v61, 0xffff0000, v62
    v_mul_f32 v56, s34, v60
    v_mul_f32 v57, s34, v61
    v_exp_f32 v56, v56
    v_exp_f32 v57, v57
    v_cmp_gt_f32 s[38:39], s36, v60
    v_cmp_gt_f32 s[40:41], s36, v61
    v_add_f32 v62, 1.0, v56
    v_add_f32 v63, 1.0, v57
    v_rcp_f32 v62, v62
    v_rcp_f32 v63, v63
    v_sub_f32 v56, 1.0, v56
    v_sub_f32 v57, 1.0, v57
    v_mul_f32 v56, v56, v62
    v_mul_f32 v57, v57, v63
    v_cndmask_b32 v56, v56, v60, s[38:39]
    v_cndmask_b32 v57, v57, v61, s[40:41]
    v_cvt_pk_bf16_f32 v62, v56, v57
    v_lshlrev_b32 v56, 16, v62
    v_and_b32 v57, 0xffff0000, v62
    v_mul_f32 v56, v212, v56
    v_mul_f32 v57, v213, v57
    v_cvt_pk_bf16_f32 v66, v56, v57
    v_mul_f32 v56, -abs(v214), s32
    v_mul_f32 v57, -abs(v215), s32
    v_exp_f32 v56, v56
    v_exp_f32 v57, v57
    v_max_f32 v60, 0, v214
    v_max_f32 v61, 0, v215
    v_cvt_pk_bf16_f32 v62, v56, v57
    v_lshlrev_b32 v56, 16, v62
    v_and_b32 v57, 0xffff0000, v62
    v_add_f32 v58, 1.0, v56
    v_add_f32 v59, 1.0, v57
    v_log_f32 v58, v58
    v_log_f32 v59, v59
    v_cmp_gt_f32 s[38:39], s35, v56
    v_cmp_gt_f32 s[40:41], s35, v57
    v_mul_f32 v58, s33, v58
    v_mul_f32 v59, s33, v59
    v_cndmask_b32 v58, v58, v56, s[38:39]
    v_cndmask_b32 v59, v59, v57, s[40:41]
    v_cvt_pk_bf16_f32 v62, v58, v59
    v_lshlrev_b32 v58, 16, v62
    v_and_b32 v59, 0xffff0000, v62
    v_add_f32 v60, v60, v58
    v_add_f32 v61, v61, v59
    v_cvt_pk_bf16_f32 v62, v60, v61
    v_lshlrev_b32 v60, 16, v62
    v_and_b32 v61, 0xffff0000, v62
    v_mul_f32 v56, s34, v60
    v_mul_f32 v57, s34, v61
    v_exp_f32 v56, v56
    v_exp_f32 v57, v57
    v_cmp_gt_f32 s[38:39], s36, v60
    v_cmp_gt_f32 s[40:41], s36, v61
    v_add_f32 v62, 1.0, v56
    v_add_f32 v63, 1.0, v57
    v_rcp_f32 v62, v62
    v_rcp_f32 v63, v63
    v_sub_f32 v56, 1.0, v56
    v_sub_f32 v57, 1.0, v57
    v_mul_f32 v56, v56, v62
    v_mul_f32 v57, v57, v63
    v_cndmask_b32 v56, v56, v60, s[38:39]
    v_cndmask_b32 v57, v57, v61, s[40:41]
    v_cvt_pk_bf16_f32 v62, v56, v57
    v_lshlrev_b32 v56, 16, v62
    v_and_b32 v57, 0xffff0000, v62
    v_mul_f32 v56, v214, v56
    v_mul_f32 v57, v215, v57
    v_cvt_pk_bf16_f32 v67, v56, v57
    s_add_u32 s30, s31, 200704
    buffer_store_dwordx4 v[64:67], v74, s[20:23], s30 offen sc1
    v_mul_f32 v56, -abs(v216), s32
    v_mul_f32 v57, -abs(v217), s32
    v_exp_f32 v56, v56
    v_exp_f32 v57, v57
    v_max_f32 v60, 0, v216
    v_max_f32 v61, 0, v217
    v_cvt_pk_bf16_f32 v62, v56, v57
    v_lshlrev_b32 v56, 16, v62
    v_and_b32 v57, 0xffff0000, v62
    v_add_f32 v58, 1.0, v56
    v_add_f32 v59, 1.0, v57
    v_log_f32 v58, v58
    v_log_f32 v59, v59
    v_cmp_gt_f32 s[38:39], s35, v56
    v_cmp_gt_f32 s[40:41], s35, v57
    v_mul_f32 v58, s33, v58
    v_mul_f32 v59, s33, v59
    v_cndmask_b32 v58, v58, v56, s[38:39]
    v_cndmask_b32 v59, v59, v57, s[40:41]
    v_cvt_pk_bf16_f32 v62, v58, v59
    v_lshlrev_b32 v58, 16, v62
    v_and_b32 v59, 0xffff0000, v62
    v_add_f32 v60, v60, v58
    v_add_f32 v61, v61, v59
    v_cvt_pk_bf16_f32 v62, v60, v61
    v_lshlrev_b32 v60, 16, v62
    v_and_b32 v61, 0xffff0000, v62
    v_mul_f32 v56, s34, v60
    v_mul_f32 v57, s34, v61
    v_exp_f32 v56, v56
    v_exp_f32 v57, v57
    v_cmp_gt_f32 s[38:39], s36, v60
    v_cmp_gt_f32 s[40:41], s36, v61
    v_add_f32 v62, 1.0, v56
    v_add_f32 v63, 1.0, v57
    v_rcp_f32 v62, v62
    v_rcp_f32 v63, v63
    v_sub_f32 v56, 1.0, v56
    v_sub_f32 v57, 1.0, v57
    v_mul_f32 v56, v56, v62
    v_mul_f32 v57, v57, v63
    v_cndmask_b32 v56, v56, v60, s[38:39]
    v_cndmask_b32 v57, v57, v61, s[40:41]
    v_cvt_pk_bf16_f32 v62, v56, v57
    v_lshlrev_b32 v56, 16, v62
    v_and_b32 v57, 0xffff0000, v62
    v_mul_f32 v56, v216, v56
    v_mul_f32 v57, v217, v57
    v_cvt_pk_bf16_f32 v68, v56, v57
    v_mul_f32 v56, -abs(v218), s32
    v_mul_f32 v57, -abs(v219), s32
    v_exp_f32 v56, v56
    v_exp_f32 v57, v57
    v_max_f32 v60, 0, v218
    v_max_f32 v61, 0, v219
    v_cvt_pk_bf16_f32 v62, v56, v57
    v_lshlrev_b32 v56, 16, v62
    v_and_b32 v57, 0xffff0000, v62
    v_add_f32 v58, 1.0, v56
    v_add_f32 v59, 1.0, v57
    v_log_f32 v58, v58
    v_log_f32 v59, v59
    v_cmp_gt_f32 s[38:39], s35, v56
    v_cmp_gt_f32 s[40:41], s35, v57
    v_mul_f32 v58, s33, v58
    v_mul_f32 v59, s33, v59
    v_cndmask_b32 v58, v58, v56, s[38:39]
    v_cndmask_b32 v59, v59, v57, s[40:41]
    v_cvt_pk_bf16_f32 v62, v58, v59
    v_lshlrev_b32 v58, 16, v62
    v_and_b32 v59, 0xffff0000, v62
    v_add_f32 v60, v60, v58
    v_add_f32 v61, v61, v59
    v_cvt_pk_bf16_f32 v62, v60, v61
    v_lshlrev_b32 v60, 16, v62
    v_and_b32 v61, 0xffff0000, v62
    v_mul_f32 v56, s34, v60
    v_mul_f32 v57, s34, v61
    v_exp_f32 v56, v56
    v_exp_f32 v57, v57
    v_cmp_gt_f32 s[38:39], s36, v60
    v_cmp_gt_f32 s[40:41], s36, v61
    v_add_f32 v62, 1.0, v56
    v_add_f32 v63, 1.0, v57
    v_rcp_f32 v62, v62
    v_rcp_f32 v63, v63
    v_sub_f32 v56, 1.0, v56
    v_sub_f32 v57, 1.0, v57
    v_mul_f32 v56, v56, v62
    v_mul_f32 v57, v57, v63
    v_cndmask_b32 v56, v56, v60, s[38:39]
    v_cndmask_b32 v57, v57, v61, s[40:41]
    v_cvt_pk_bf16_f32 v62, v56, v57
    v_lshlrev_b32 v56, 16, v62
    v_and_b32 v57, 0xffff0000, v62
    v_mul_f32 v56, v218, v56
    v_mul_f32 v57, v219, v57
    v_cvt_pk_bf16_f32 v69, v56, v57
    v_mul_f32 v56, -abs(v220), s32
    v_mul_f32 v57, -abs(v221), s32
    v_exp_f32 v56, v56
    v_exp_f32 v57, v57
    v_max_f32 v60, 0, v220
    v_max_f32 v61, 0, v221
    v_cvt_pk_bf16_f32 v62, v56, v57
    v_lshlrev_b32 v56, 16, v62
    v_and_b32 v57, 0xffff0000, v62
    v_add_f32 v58, 1.0, v56
    v_add_f32 v59, 1.0, v57
    v_log_f32 v58, v58
    v_log_f32 v59, v59
    v_cmp_gt_f32 s[38:39], s35, v56
    v_cmp_gt_f32 s[40:41], s35, v57
    v_mul_f32 v58, s33, v58
    v_mul_f32 v59, s33, v59
    v_cndmask_b32 v58, v58, v56, s[38:39]
    v_cndmask_b32 v59, v59, v57, s[40:41]
    v_cvt_pk_bf16_f32 v62, v58, v59
    v_lshlrev_b32 v58, 16, v62
    v_and_b32 v59, 0xffff0000, v62
    v_add_f32 v60, v60, v58
    v_add_f32 v61, v61, v59
    v_cvt_pk_bf16_f32 v62, v60, v61
    v_lshlrev_b32 v60, 16, v62
    v_and_b32 v61, 0xffff0000, v62
    v_mul_f32 v56, s34, v60
    v_mul_f32 v57, s34, v61
    v_exp_f32 v56, v56
    v_exp_f32 v57, v57
    v_cmp_gt_f32 s[38:39], s36, v60
    v_cmp_gt_f32 s[40:41], s36, v61
    v_add_f32 v62, 1.0, v56
    v_add_f32 v63, 1.0, v57
    v_rcp_f32 v62, v62
    v_rcp_f32 v63, v63
    v_sub_f32 v56, 1.0, v56
    v_sub_f32 v57, 1.0, v57
    v_mul_f32 v56, v56, v62
    v_mul_f32 v57, v57, v63
    v_cndmask_b32 v56, v56, v60, s[38:39]
    v_cndmask_b32 v57, v57, v61, s[40:41]
    v_cvt_pk_bf16_f32 v62, v56, v57
    v_lshlrev_b32 v56, 16, v62
    v_and_b32 v57, 0xffff0000, v62
    v_mul_f32 v56, v220, v56
    v_mul_f32 v57, v221, v57
    v_cvt_pk_bf16_f32 v70, v56, v57
    v_mul_f32 v56, -abs(v222), s32
    v_mul_f32 v57, -abs(v223), s32
    v_exp_f32 v56, v56
    v_exp_f32 v57, v57
    v_max_f32 v60, 0, v222
    v_max_f32 v61, 0, v223
    v_cvt_pk_bf16_f32 v62, v56, v57
    v_lshlrev_b32 v56, 16, v62
    v_and_b32 v57, 0xffff0000, v62
    v_add_f32 v58, 1.0, v56
    v_add_f32 v59, 1.0, v57
    v_log_f32 v58, v58
    v_log_f32 v59, v59
    v_cmp_gt_f32 s[38:39], s35, v56
    v_cmp_gt_f32 s[40:41], s35, v57
    v_mul_f32 v58, s33, v58
    v_mul_f32 v59, s33, v59
    v_cndmask_b32 v58, v58, v56, s[38:39]
    v_cndmask_b32 v59, v59, v57, s[40:41]
    v_cvt_pk_bf16_f32 v62, v58, v59
    v_lshlrev_b32 v58, 16, v62
    v_and_b32 v59, 0xffff0000, v62
    v_add_f32 v60, v60, v58
    v_add_f32 v61, v61, v59
    v_cvt_pk_bf16_f32 v62, v60, v61
    v_lshlrev_b32 v60, 16, v62
    v_and_b32 v61, 0xffff0000, v62
    v_mul_f32 v56, s34, v60
    v_mul_f32 v57, s34, v61
    v_exp_f32 v56, v56
    v_exp_f32 v57, v57
    v_cmp_gt_f32 s[38:39], s36, v60
    v_cmp_gt_f32 s[40:41], s36, v61
    v_add_f32 v62, 1.0, v56
    v_add_f32 v63, 1.0, v57
    v_rcp_f32 v62, v62
    v_rcp_f32 v63, v63
    v_sub_f32 v56, 1.0, v56
    v_sub_f32 v57, 1.0, v57
    v_mul_f32 v56, v56, v62
    v_mul_f32 v57, v57, v63
    v_cndmask_b32 v56, v56, v60, s[38:39]
    v_cndmask_b32 v57, v57, v61, s[40:41]
    v_cvt_pk_bf16_f32 v62, v56, v57
    v_lshlrev_b32 v56, 16, v62
    v_and_b32 v57, 0xffff0000, v62
    v_mul_f32 v56, v222, v56
    v_mul_f32 v57, v223, v57
    v_cvt_pk_bf16_f32 v71, v56, v57
    s_add_u32 s30, s31, 201216
    buffer_store_dwordx4 v[68:71], v74, s[20:23], s30 offen sc1
    v_mul_f32 v56, -abs(v224), s32
    v_mul_f32 v57, -abs(v225), s32
    v_exp_f32 v56, v56
    v_exp_f32 v57, v57
    v_max_f32 v60, 0, v224
    v_max_f32 v61, 0, v225
    v_cvt_pk_bf16_f32 v62, v56, v57
    v_lshlrev_b32 v56, 16, v62
    v_and_b32 v57, 0xffff0000, v62
    v_add_f32 v58, 1.0, v56
    v_add_f32 v59, 1.0, v57
    v_log_f32 v58, v58
    v_log_f32 v59, v59
    v_cmp_gt_f32 s[38:39], s35, v56
    v_cmp_gt_f32 s[40:41], s35, v57
    v_mul_f32 v58, s33, v58
    v_mul_f32 v59, s33, v59
    v_cndmask_b32 v58, v58, v56, s[38:39]
    v_cndmask_b32 v59, v59, v57, s[40:41]
    v_cvt_pk_bf16_f32 v62, v58, v59
    v_lshlrev_b32 v58, 16, v62
    v_and_b32 v59, 0xffff0000, v62
    v_add_f32 v60, v60, v58
    v_add_f32 v61, v61, v59
    v_cvt_pk_bf16_f32 v62, v60, v61
    v_lshlrev_b32 v60, 16, v62
    v_and_b32 v61, 0xffff0000, v62
    v_mul_f32 v56, s34, v60
    v_mul_f32 v57, s34, v61
    v_exp_f32 v56, v56
    v_exp_f32 v57, v57
    v_cmp_gt_f32 s[38:39], s36, v60
    v_cmp_gt_f32 s[40:41], s36, v61
    v_add_f32 v62, 1.0, v56
    v_add_f32 v63, 1.0, v57
    v_rcp_f32 v62, v62
    v_rcp_f32 v63, v63
    v_sub_f32 v56, 1.0, v56
    v_sub_f32 v57, 1.0, v57
    v_mul_f32 v56, v56, v62
    v_mul_f32 v57, v57, v63
    v_cndmask_b32 v56, v56, v60, s[38:39]
    v_cndmask_b32 v57, v57, v61, s[40:41]
    v_cvt_pk_bf16_f32 v62, v56, v57
    v_lshlrev_b32 v56, 16, v62
    v_and_b32 v57, 0xffff0000, v62
    v_mul_f32 v56, v224, v56
    v_mul_f32 v57, v225, v57
    v_cvt_pk_bf16_f32 v64, v56, v57
    v_mul_f32 v56, -abs(v226), s32
    v_mul_f32 v57, -abs(v227), s32
    v_exp_f32 v56, v56
    v_exp_f32 v57, v57
    v_max_f32 v60, 0, v226
    v_max_f32 v61, 0, v227
    v_cvt_pk_bf16_f32 v62, v56, v57
    v_lshlrev_b32 v56, 16, v62
    v_and_b32 v57, 0xffff0000, v62
    v_add_f32 v58, 1.0, v56
    v_add_f32 v59, 1.0, v57
    v_log_f32 v58, v58
    v_log_f32 v59, v59
    v_cmp_gt_f32 s[38:39], s35, v56
    v_cmp_gt_f32 s[40:41], s35, v57
    v_mul_f32 v58, s33, v58
    v_mul_f32 v59, s33, v59
    v_cndmask_b32 v58, v58, v56, s[38:39]
    v_cndmask_b32 v59, v59, v57, s[40:41]
    v_cvt_pk_bf16_f32 v62, v58, v59
    v_lshlrev_b32 v58, 16, v62
    v_and_b32 v59, 0xffff0000, v62
    v_add_f32 v60, v60, v58
    v_add_f32 v61, v61, v59
    v_cvt_pk_bf16_f32 v62, v60, v61
    v_lshlrev_b32 v60, 16, v62
    v_and_b32 v61, 0xffff0000, v62
    v_mul_f32 v56, s34, v60
    v_mul_f32 v57, s34, v61
    v_exp_f32 v56, v56
    v_exp_f32 v57, v57
    v_cmp_gt_f32 s[38:39], s36, v60
    v_cmp_gt_f32 s[40:41], s36, v61
    v_add_f32 v62, 1.0, v56
    v_add_f32 v63, 1.0, v57
    v_rcp_f32 v62, v62
    v_rcp_f32 v63, v63
    v_sub_f32 v56, 1.0, v56
    v_sub_f32 v57, 1.0, v57
    v_mul_f32 v56, v56, v62
    v_mul_f32 v57, v57, v63
    v_cndmask_b32 v56, v56, v60, s[38:39]
    v_cndmask_b32 v57, v57, v61, s[40:41]
    v_cvt_pk_bf16_f32 v62, v56, v57
    v_lshlrev_b32 v56, 16, v62
    v_and_b32 v57, 0xffff0000, v62
    v_mul_f32 v56, v226, v56
    v_mul_f32 v57, v227, v57
    v_cvt_pk_bf16_f32 v65, v56, v57
    v_mul_f32 v56, -abs(v228), s32
    v_mul_f32 v57, -abs(v229), s32
    v_exp_f32 v56, v56
    v_exp_f32 v57, v57
    v_max_f32 v60, 0, v228
    v_max_f32 v61, 0, v229
    v_cvt_pk_bf16_f32 v62, v56, v57
    v_lshlrev_b32 v56, 16, v62
    v_and_b32 v57, 0xffff0000, v62
    v_add_f32 v58, 1.0, v56
    v_add_f32 v59, 1.0, v57
    v_log_f32 v58, v58
    v_log_f32 v59, v59
    v_cmp_gt_f32 s[38:39], s35, v56
    v_cmp_gt_f32 s[40:41], s35, v57
    v_mul_f32 v58, s33, v58
    v_mul_f32 v59, s33, v59
    v_cndmask_b32 v58, v58, v56, s[38:39]
    v_cndmask_b32 v59, v59, v57, s[40:41]
    v_cvt_pk_bf16_f32 v62, v58, v59
    v_lshlrev_b32 v58, 16, v62
    v_and_b32 v59, 0xffff0000, v62
    v_add_f32 v60, v60, v58
    v_add_f32 v61, v61, v59
    v_cvt_pk_bf16_f32 v62, v60, v61
    v_lshlrev_b32 v60, 16, v62
    v_and_b32 v61, 0xffff0000, v62
    v_mul_f32 v56, s34, v60
    v_mul_f32 v57, s34, v61
    v_exp_f32 v56, v56
    v_exp_f32 v57, v57
    v_cmp_gt_f32 s[38:39], s36, v60
    v_cmp_gt_f32 s[40:41], s36, v61
    v_add_f32 v62, 1.0, v56
    v_add_f32 v63, 1.0, v57
    v_rcp_f32 v62, v62
    v_rcp_f32 v63, v63
    v_sub_f32 v56, 1.0, v56
    v_sub_f32 v57, 1.0, v57
    v_mul_f32 v56, v56, v62
    v_mul_f32 v57, v57, v63
    v_cndmask_b32 v56, v56, v60, s[38:39]
    v_cndmask_b32 v57, v57, v61, s[40:41]
    v_cvt_pk_bf16_f32 v62, v56, v57
    v_lshlrev_b32 v56, 16, v62
    v_and_b32 v57, 0xffff0000, v62
    v_mul_f32 v56, v228, v56
    v_mul_f32 v57, v229, v57
    v_cvt_pk_bf16_f32 v66, v56, v57
    v_mul_f32 v56, -abs(v230), s32
    v_mul_f32 v57, -abs(v231), s32
    v_exp_f32 v56, v56
    v_exp_f32 v57, v57
    v_max_f32 v60, 0, v230
    v_max_f32 v61, 0, v231
    v_cvt_pk_bf16_f32 v62, v56, v57
    v_lshlrev_b32 v56, 16, v62
    v_and_b32 v57, 0xffff0000, v62
    v_add_f32 v58, 1.0, v56
    v_add_f32 v59, 1.0, v57
    v_log_f32 v58, v58
    v_log_f32 v59, v59
    v_cmp_gt_f32 s[38:39], s35, v56
    v_cmp_gt_f32 s[40:41], s35, v57
    v_mul_f32 v58, s33, v58
    v_mul_f32 v59, s33, v59
    v_cndmask_b32 v58, v58, v56, s[38:39]
    v_cndmask_b32 v59, v59, v57, s[40:41]
    v_cvt_pk_bf16_f32 v62, v58, v59
    v_lshlrev_b32 v58, 16, v62
    v_and_b32 v59, 0xffff0000, v62
    v_add_f32 v60, v60, v58
    v_add_f32 v61, v61, v59
    v_cvt_pk_bf16_f32 v62, v60, v61
    v_lshlrev_b32 v60, 16, v62
    v_and_b32 v61, 0xffff0000, v62
    v_mul_f32 v56, s34, v60
    v_mul_f32 v57, s34, v61
    v_exp_f32 v56, v56
    v_exp_f32 v57, v57
    v_cmp_gt_f32 s[38:39], s36, v60
    v_cmp_gt_f32 s[40:41], s36, v61
    v_add_f32 v62, 1.0, v56
    v_add_f32 v63, 1.0, v57
    v_rcp_f32 v62, v62
    v_rcp_f32 v63, v63
    v_sub_f32 v56, 1.0, v56
    v_sub_f32 v57, 1.0, v57
    v_mul_f32 v56, v56, v62
    v_mul_f32 v57, v57, v63
    v_cndmask_b32 v56, v56, v60, s[38:39]
    v_cndmask_b32 v57, v57, v61, s[40:41]
    v_cvt_pk_bf16_f32 v62, v56, v57
    v_lshlrev_b32 v56, 16, v62
    v_and_b32 v57, 0xffff0000, v62
    v_mul_f32 v56, v230, v56
    v_mul_f32 v57, v231, v57
    v_cvt_pk_bf16_f32 v67, v56, v57
    s_add_u32 s30, s31, 198656
    buffer_store_dwordx4 v[64:67], v74, s[20:23], s30 offen sc1
    v_mul_f32 v56, -abs(v232), s32
    v_mul_f32 v57, -abs(v233), s32
    v_exp_f32 v56, v56
    v_exp_f32 v57, v57
    v_max_f32 v60, 0, v232
    v_max_f32 v61, 0, v233
    v_cvt_pk_bf16_f32 v62, v56, v57
    v_lshlrev_b32 v56, 16, v62
    v_and_b32 v57, 0xffff0000, v62
    v_add_f32 v58, 1.0, v56
    v_add_f32 v59, 1.0, v57
    v_log_f32 v58, v58
    v_log_f32 v59, v59
    v_cmp_gt_f32 s[38:39], s35, v56
    v_cmp_gt_f32 s[40:41], s35, v57
    v_mul_f32 v58, s33, v58
    v_mul_f32 v59, s33, v59
    v_cndmask_b32 v58, v58, v56, s[38:39]
    v_cndmask_b32 v59, v59, v57, s[40:41]
    v_cvt_pk_bf16_f32 v62, v58, v59
    v_lshlrev_b32 v58, 16, v62
    v_and_b32 v59, 0xffff0000, v62
    v_add_f32 v60, v60, v58
    v_add_f32 v61, v61, v59
    v_cvt_pk_bf16_f32 v62, v60, v61
    v_lshlrev_b32 v60, 16, v62
    v_and_b32 v61, 0xffff0000, v62
    v_mul_f32 v56, s34, v60
    v_mul_f32 v57, s34, v61
    v_exp_f32 v56, v56
    v_exp_f32 v57, v57
    v_cmp_gt_f32 s[38:39], s36, v60
    v_cmp_gt_f32 s[40:41], s36, v61
    v_add_f32 v62, 1.0, v56
    v_add_f32 v63, 1.0, v57
    v_rcp_f32 v62, v62
    v_rcp_f32 v63, v63
    v_sub_f32 v56, 1.0, v56
    v_sub_f32 v57, 1.0, v57
    v_mul_f32 v56, v56, v62
    v_mul_f32 v57, v57, v63
    v_cndmask_b32 v56, v56, v60, s[38:39]
    v_cndmask_b32 v57, v57, v61, s[40:41]
    v_cvt_pk_bf16_f32 v62, v56, v57
    v_lshlrev_b32 v56, 16, v62
    v_and_b32 v57, 0xffff0000, v62
    v_mul_f32 v56, v232, v56
    v_mul_f32 v57, v233, v57
    v_cvt_pk_bf16_f32 v68, v56, v57
    v_mul_f32 v56, -abs(v234), s32
    v_mul_f32 v57, -abs(v235), s32
    v_exp_f32 v56, v56
    v_exp_f32 v57, v57
    v_max_f32 v60, 0, v234
    v_max_f32 v61, 0, v235
    v_cvt_pk_bf16_f32 v62, v56, v57
    v_lshlrev_b32 v56, 16, v62
    v_and_b32 v57, 0xffff0000, v62
    v_add_f32 v58, 1.0, v56
    v_add_f32 v59, 1.0, v57
    v_log_f32 v58, v58
    v_log_f32 v59, v59
    v_cmp_gt_f32 s[38:39], s35, v56
    v_cmp_gt_f32 s[40:41], s35, v57
    v_mul_f32 v58, s33, v58
    v_mul_f32 v59, s33, v59
    v_cndmask_b32 v58, v58, v56, s[38:39]
    v_cndmask_b32 v59, v59, v57, s[40:41]
    v_cvt_pk_bf16_f32 v62, v58, v59
    v_lshlrev_b32 v58, 16, v62
    v_and_b32 v59, 0xffff0000, v62
    v_add_f32 v60, v60, v58
    v_add_f32 v61, v61, v59
    v_cvt_pk_bf16_f32 v62, v60, v61
    v_lshlrev_b32 v60, 16, v62
    v_and_b32 v61, 0xffff0000, v62
    v_mul_f32 v56, s34, v60
    v_mul_f32 v57, s34, v61
    v_exp_f32 v56, v56
    v_exp_f32 v57, v57
    v_cmp_gt_f32 s[38:39], s36, v60
    v_cmp_gt_f32 s[40:41], s36, v61
    v_add_f32 v62, 1.0, v56
    v_add_f32 v63, 1.0, v57
    v_rcp_f32 v62, v62
    v_rcp_f32 v63, v63
    v_sub_f32 v56, 1.0, v56
    v_sub_f32 v57, 1.0, v57
    v_mul_f32 v56, v56, v62
    v_mul_f32 v57, v57, v63
    v_cndmask_b32 v56, v56, v60, s[38:39]
    v_cndmask_b32 v57, v57, v61, s[40:41]
    v_cvt_pk_bf16_f32 v62, v56, v57
    v_lshlrev_b32 v56, 16, v62
    v_and_b32 v57, 0xffff0000, v62
    v_mul_f32 v56, v234, v56
    v_mul_f32 v57, v235, v57
    v_cvt_pk_bf16_f32 v69, v56, v57
    v_mul_f32 v56, -abs(v236), s32
    v_mul_f32 v57, -abs(v237), s32
    v_exp_f32 v56, v56
    v_exp_f32 v57, v57
    v_max_f32 v60, 0, v236
    v_max_f32 v61, 0, v237
    v_cvt_pk_bf16_f32 v62, v56, v57
    v_lshlrev_b32 v56, 16, v62
    v_and_b32 v57, 0xffff0000, v62
    v_add_f32 v58, 1.0, v56
    v_add_f32 v59, 1.0, v57
    v_log_f32 v58, v58
    v_log_f32 v59, v59
    v_cmp_gt_f32 s[38:39], s35, v56
    v_cmp_gt_f32 s[40:41], s35, v57
    v_mul_f32 v58, s33, v58
    v_mul_f32 v59, s33, v59
    v_cndmask_b32 v58, v58, v56, s[38:39]
    v_cndmask_b32 v59, v59, v57, s[40:41]
    v_cvt_pk_bf16_f32 v62, v58, v59
    v_lshlrev_b32 v58, 16, v62
    v_and_b32 v59, 0xffff0000, v62
    v_add_f32 v60, v60, v58
    v_add_f32 v61, v61, v59
    v_cvt_pk_bf16_f32 v62, v60, v61
    v_lshlrev_b32 v60, 16, v62
    v_and_b32 v61, 0xffff0000, v62
    v_mul_f32 v56, s34, v60
    v_mul_f32 v57, s34, v61
    v_exp_f32 v56, v56
    v_exp_f32 v57, v57
    v_cmp_gt_f32 s[38:39], s36, v60
    v_cmp_gt_f32 s[40:41], s36, v61
    v_add_f32 v62, 1.0, v56
    v_add_f32 v63, 1.0, v57
    v_rcp_f32 v62, v62
    v_rcp_f32 v63, v63
    v_sub_f32 v56, 1.0, v56
    v_sub_f32 v57, 1.0, v57
    v_mul_f32 v56, v56, v62
    v_mul_f32 v57, v57, v63
    v_cndmask_b32 v56, v56, v60, s[38:39]
    v_cndmask_b32 v57, v57, v61, s[40:41]
    v_cvt_pk_bf16_f32 v62, v56, v57
    v_lshlrev_b32 v56, 16, v62
    v_and_b32 v57, 0xffff0000, v62
    v_mul_f32 v56, v236, v56
    v_mul_f32 v57, v237, v57
    v_cvt_pk_bf16_f32 v70, v56, v57
    v_mul_f32 v56, -abs(v238), s32
    v_mul_f32 v57, -abs(v239), s32
    v_exp_f32 v56, v56
    v_exp_f32 v57, v57
    v_max_f32 v60, 0, v238
    v_max_f32 v61, 0, v239
    v_cvt_pk_bf16_f32 v62, v56, v57
    v_lshlrev_b32 v56, 16, v62
    v_and_b32 v57, 0xffff0000, v62
    v_add_f32 v58, 1.0, v56
    v_add_f32 v59, 1.0, v57
    v_log_f32 v58, v58
    v_log_f32 v59, v59
    v_cmp_gt_f32 s[38:39], s35, v56
    v_cmp_gt_f32 s[40:41], s35, v57
    v_mul_f32 v58, s33, v58
    v_mul_f32 v59, s33, v59
    v_cndmask_b32 v58, v58, v56, s[38:39]
    v_cndmask_b32 v59, v59, v57, s[40:41]
    v_cvt_pk_bf16_f32 v62, v58, v59
    v_lshlrev_b32 v58, 16, v62
    v_and_b32 v59, 0xffff0000, v62
    v_add_f32 v60, v60, v58
    v_add_f32 v61, v61, v59
    v_cvt_pk_bf16_f32 v62, v60, v61
    v_lshlrev_b32 v60, 16, v62
    v_and_b32 v61, 0xffff0000, v62
    v_mul_f32 v56, s34, v60
    v_mul_f32 v57, s34, v61
    v_exp_f32 v56, v56
    v_exp_f32 v57, v57
    v_cmp_gt_f32 s[38:39], s36, v60
    v_cmp_gt_f32 s[40:41], s36, v61
    v_add_f32 v62, 1.0, v56
    v_add_f32 v63, 1.0, v57
    v_rcp_f32 v62, v62
    v_rcp_f32 v63, v63
    v_sub_f32 v56, 1.0, v56
    v_sub_f32 v57, 1.0, v57
    v_mul_f32 v56, v56, v62
    v_mul_f32 v57, v57, v63
    v_cndmask_b32 v56, v56, v60, s[38:39]
    v_cndmask_b32 v57, v57, v61, s[40:41]
    v_cvt_pk_bf16_f32 v62, v56, v57
    v_lshlrev_b32 v56, 16, v62
    v_and_b32 v57, 0xffff0000, v62
    v_mul_f32 v56, v238, v56
    v_mul_f32 v57, v239, v57
    v_cvt_pk_bf16_f32 v71, v56, v57
    s_add_u32 s30, s31, 199168
    buffer_store_dwordx4 v[68:71], v74, s[20:23], s30 offen sc1
    v_mul_f32 v56, -abs(v240), s32
    v_mul_f32 v57, -abs(v241), s32
    v_exp_f32 v56, v56
    v_exp_f32 v57, v57
    v_max_f32 v60, 0, v240
    v_max_f32 v61, 0, v241
    v_cvt_pk_bf16_f32 v62, v56, v57
    v_lshlrev_b32 v56, 16, v62
    v_and_b32 v57, 0xffff0000, v62
    v_add_f32 v58, 1.0, v56
    v_add_f32 v59, 1.0, v57
    v_log_f32 v58, v58
    v_log_f32 v59, v59
    v_cmp_gt_f32 s[38:39], s35, v56
    v_cmp_gt_f32 s[40:41], s35, v57
    v_mul_f32 v58, s33, v58
    v_mul_f32 v59, s33, v59
    v_cndmask_b32 v58, v58, v56, s[38:39]
    v_cndmask_b32 v59, v59, v57, s[40:41]
    v_cvt_pk_bf16_f32 v62, v58, v59
    v_lshlrev_b32 v58, 16, v62
    v_and_b32 v59, 0xffff0000, v62
    v_add_f32 v60, v60, v58
    v_add_f32 v61, v61, v59
    v_cvt_pk_bf16_f32 v62, v60, v61
    v_lshlrev_b32 v60, 16, v62
    v_and_b32 v61, 0xffff0000, v62
    v_mul_f32 v56, s34, v60
    v_mul_f32 v57, s34, v61
    v_exp_f32 v56, v56
    v_exp_f32 v57, v57
    v_cmp_gt_f32 s[38:39], s36, v60
    v_cmp_gt_f32 s[40:41], s36, v61
    v_add_f32 v62, 1.0, v56
    v_add_f32 v63, 1.0, v57
    v_rcp_f32 v62, v62
    v_rcp_f32 v63, v63
    v_sub_f32 v56, 1.0, v56
    v_sub_f32 v57, 1.0, v57
    v_mul_f32 v56, v56, v62
    v_mul_f32 v57, v57, v63
    v_cndmask_b32 v56, v56, v60, s[38:39]
    v_cndmask_b32 v57, v57, v61, s[40:41]
    v_cvt_pk_bf16_f32 v62, v56, v57
    v_lshlrev_b32 v56, 16, v62
    v_and_b32 v57, 0xffff0000, v62
    v_mul_f32 v56, v240, v56
    v_mul_f32 v57, v241, v57
    v_cvt_pk_bf16_f32 v64, v56, v57
    v_mul_f32 v56, -abs(v242), s32
    v_mul_f32 v57, -abs(v243), s32
    v_exp_f32 v56, v56
    v_exp_f32 v57, v57
    v_max_f32 v60, 0, v242
    v_max_f32 v61, 0, v243
    v_cvt_pk_bf16_f32 v62, v56, v57
    v_lshlrev_b32 v56, 16, v62
    v_and_b32 v57, 0xffff0000, v62
    v_add_f32 v58, 1.0, v56
    v_add_f32 v59, 1.0, v57
    v_log_f32 v58, v58
    v_log_f32 v59, v59
    v_cmp_gt_f32 s[38:39], s35, v56
    v_cmp_gt_f32 s[40:41], s35, v57
    v_mul_f32 v58, s33, v58
    v_mul_f32 v59, s33, v59
    v_cndmask_b32 v58, v58, v56, s[38:39]
    v_cndmask_b32 v59, v59, v57, s[40:41]
    v_cvt_pk_bf16_f32 v62, v58, v59
    v_lshlrev_b32 v58, 16, v62
    v_and_b32 v59, 0xffff0000, v62
    v_add_f32 v60, v60, v58
    v_add_f32 v61, v61, v59
    v_cvt_pk_bf16_f32 v62, v60, v61
    v_lshlrev_b32 v60, 16, v62
    v_and_b32 v61, 0xffff0000, v62
    v_mul_f32 v56, s34, v60
    v_mul_f32 v57, s34, v61
    v_exp_f32 v56, v56
    v_exp_f32 v57, v57
    v_cmp_gt_f32 s[38:39], s36, v60
    v_cmp_gt_f32 s[40:41], s36, v61
    v_add_f32 v62, 1.0, v56
    v_add_f32 v63, 1.0, v57
    v_rcp_f32 v62, v62
    v_rcp_f32 v63, v63
    v_sub_f32 v56, 1.0, v56
    v_sub_f32 v57, 1.0, v57
    v_mul_f32 v56, v56, v62
    v_mul_f32 v57, v57, v63
    v_cndmask_b32 v56, v56, v60, s[38:39]
    v_cndmask_b32 v57, v57, v61, s[40:41]
    v_cvt_pk_bf16_f32 v62, v56, v57
    v_lshlrev_b32 v56, 16, v62
    v_and_b32 v57, 0xffff0000, v62
    v_mul_f32 v56, v242, v56
    v_mul_f32 v57, v243, v57
    v_cvt_pk_bf16_f32 v65, v56, v57
    v_mul_f32 v56, -abs(v244), s32
    v_mul_f32 v57, -abs(v245), s32
    v_exp_f32 v56, v56
    v_exp_f32 v57, v57
    v_max_f32 v60, 0, v244
    v_max_f32 v61, 0, v245
    v_cvt_pk_bf16_f32 v62, v56, v57
    v_lshlrev_b32 v56, 16, v62
    v_and_b32 v57, 0xffff0000, v62
    v_add_f32 v58, 1.0, v56
    v_add_f32 v59, 1.0, v57
    v_log_f32 v58, v58
    v_log_f32 v59, v59
    v_cmp_gt_f32 s[38:39], s35, v56
    v_cmp_gt_f32 s[40:41], s35, v57
    v_mul_f32 v58, s33, v58
    v_mul_f32 v59, s33, v59
    v_cndmask_b32 v58, v58, v56, s[38:39]
    v_cndmask_b32 v59, v59, v57, s[40:41]
    v_cvt_pk_bf16_f32 v62, v58, v59
    v_lshlrev_b32 v58, 16, v62
    v_and_b32 v59, 0xffff0000, v62
    v_add_f32 v60, v60, v58
    v_add_f32 v61, v61, v59
    v_cvt_pk_bf16_f32 v62, v60, v61
    v_lshlrev_b32 v60, 16, v62
    v_and_b32 v61, 0xffff0000, v62
    v_mul_f32 v56, s34, v60
    v_mul_f32 v57, s34, v61
    v_exp_f32 v56, v56
    v_exp_f32 v57, v57
    v_cmp_gt_f32 s[38:39], s36, v60
    v_cmp_gt_f32 s[40:41], s36, v61
    v_add_f32 v62, 1.0, v56
    v_add_f32 v63, 1.0, v57
    v_rcp_f32 v62, v62
    v_rcp_f32 v63, v63
    v_sub_f32 v56, 1.0, v56
    v_sub_f32 v57, 1.0, v57
    v_mul_f32 v56, v56, v62
    v_mul_f32 v57, v57, v63
    v_cndmask_b32 v56, v56, v60, s[38:39]
    v_cndmask_b32 v57, v57, v61, s[40:41]
    v_cvt_pk_bf16_f32 v62, v56, v57
    v_lshlrev_b32 v56, 16, v62
    v_and_b32 v57, 0xffff0000, v62
    v_mul_f32 v56, v244, v56
    v_mul_f32 v57, v245, v57
    v_cvt_pk_bf16_f32 v66, v56, v57
    v_mul_f32 v56, -abs(v246), s32
    v_mul_f32 v57, -abs(v247), s32
    v_exp_f32 v56, v56
    v_exp_f32 v57, v57
    v_max_f32 v60, 0, v246
    v_max_f32 v61, 0, v247
    v_cvt_pk_bf16_f32 v62, v56, v57
    v_lshlrev_b32 v56, 16, v62
    v_and_b32 v57, 0xffff0000, v62
    v_add_f32 v58, 1.0, v56
    v_add_f32 v59, 1.0, v57
    v_log_f32 v58, v58
    v_log_f32 v59, v59
    v_cmp_gt_f32 s[38:39], s35, v56
    v_cmp_gt_f32 s[40:41], s35, v57
    v_mul_f32 v58, s33, v58
    v_mul_f32 v59, s33, v59
    v_cndmask_b32 v58, v58, v56, s[38:39]
    v_cndmask_b32 v59, v59, v57, s[40:41]
    v_cvt_pk_bf16_f32 v62, v58, v59
    v_lshlrev_b32 v58, 16, v62
    v_and_b32 v59, 0xffff0000, v62
    v_add_f32 v60, v60, v58
    v_add_f32 v61, v61, v59
    v_cvt_pk_bf16_f32 v62, v60, v61
    v_lshlrev_b32 v60, 16, v62
    v_and_b32 v61, 0xffff0000, v62
    v_mul_f32 v56, s34, v60
    v_mul_f32 v57, s34, v61
    v_exp_f32 v56, v56
    v_exp_f32 v57, v57
    v_cmp_gt_f32 s[38:39], s36, v60
    v_cmp_gt_f32 s[40:41], s36, v61
    v_add_f32 v62, 1.0, v56
    v_add_f32 v63, 1.0, v57
    v_rcp_f32 v62, v62
    v_rcp_f32 v63, v63
    v_sub_f32 v56, 1.0, v56
    v_sub_f32 v57, 1.0, v57
    v_mul_f32 v56, v56, v62
    v_mul_f32 v57, v57, v63
    v_cndmask_b32 v56, v56, v60, s[38:39]
    v_cndmask_b32 v57, v57, v61, s[40:41]
    v_cvt_pk_bf16_f32 v62, v56, v57
    v_lshlrev_b32 v56, 16, v62
    v_and_b32 v57, 0xffff0000, v62
    v_mul_f32 v56, v246, v56
    v_mul_f32 v57, v247, v57
    v_cvt_pk_bf16_f32 v67, v56, v57
    s_add_u32 s30, s31, 202752
    buffer_store_dwordx4 v[64:67], v74, s[20:23], s30 offen sc1
    v_mul_f32 v56, -abs(v248), s32
    v_mul_f32 v57, -abs(v249), s32
    v_exp_f32 v56, v56
    v_exp_f32 v57, v57
    v_max_f32 v60, 0, v248
    v_max_f32 v61, 0, v249
    v_cvt_pk_bf16_f32 v62, v56, v57
    v_lshlrev_b32 v56, 16, v62
    v_and_b32 v57, 0xffff0000, v62
    v_add_f32 v58, 1.0, v56
    v_add_f32 v59, 1.0, v57
    v_log_f32 v58, v58
    v_log_f32 v59, v59
    v_cmp_gt_f32 s[38:39], s35, v56
    v_cmp_gt_f32 s[40:41], s35, v57
    v_mul_f32 v58, s33, v58
    v_mul_f32 v59, s33, v59
    v_cndmask_b32 v58, v58, v56, s[38:39]
    v_cndmask_b32 v59, v59, v57, s[40:41]
    v_cvt_pk_bf16_f32 v62, v58, v59
    v_lshlrev_b32 v58, 16, v62
    v_and_b32 v59, 0xffff0000, v62
    v_add_f32 v60, v60, v58
    v_add_f32 v61, v61, v59
    v_cvt_pk_bf16_f32 v62, v60, v61
    v_lshlrev_b32 v60, 16, v62
    v_and_b32 v61, 0xffff0000, v62
    v_mul_f32 v56, s34, v60
    v_mul_f32 v57, s34, v61
    v_exp_f32 v56, v56
    v_exp_f32 v57, v57
    v_cmp_gt_f32 s[38:39], s36, v60
    v_cmp_gt_f32 s[40:41], s36, v61
    v_add_f32 v62, 1.0, v56
    v_add_f32 v63, 1.0, v57
    v_rcp_f32 v62, v62
    v_rcp_f32 v63, v63
    v_sub_f32 v56, 1.0, v56
    v_sub_f32 v57, 1.0, v57
    v_mul_f32 v56, v56, v62
    v_mul_f32 v57, v57, v63
    v_cndmask_b32 v56, v56, v60, s[38:39]
    v_cndmask_b32 v57, v57, v61, s[40:41]
    v_cvt_pk_bf16_f32 v62, v56, v57
    v_lshlrev_b32 v56, 16, v62
    v_and_b32 v57, 0xffff0000, v62
    v_mul_f32 v56, v248, v56
    v_mul_f32 v57, v249, v57
    v_cvt_pk_bf16_f32 v68, v56, v57
    v_mul_f32 v56, -abs(v250), s32
    v_mul_f32 v57, -abs(v251), s32
    v_exp_f32 v56, v56
    v_exp_f32 v57, v57
    v_max_f32 v60, 0, v250
    v_max_f32 v61, 0, v251
    v_cvt_pk_bf16_f32 v62, v56, v57
    v_lshlrev_b32 v56, 16, v62
    v_and_b32 v57, 0xffff0000, v62
    v_add_f32 v58, 1.0, v56
    v_add_f32 v59, 1.0, v57
    v_log_f32 v58, v58
    v_log_f32 v59, v59
    v_cmp_gt_f32 s[38:39], s35, v56
    v_cmp_gt_f32 s[40:41], s35, v57
    v_mul_f32 v58, s33, v58
    v_mul_f32 v59, s33, v59
    v_cndmask_b32 v58, v58, v56, s[38:39]
    v_cndmask_b32 v59, v59, v57, s[40:41]
    v_cvt_pk_bf16_f32 v62, v58, v59
    v_lshlrev_b32 v58, 16, v62
    v_and_b32 v59, 0xffff0000, v62
    v_add_f32 v60, v60, v58
    v_add_f32 v61, v61, v59
    v_cvt_pk_bf16_f32 v62, v60, v61
    v_lshlrev_b32 v60, 16, v62
    v_and_b32 v61, 0xffff0000, v62
    v_mul_f32 v56, s34, v60
    v_mul_f32 v57, s34, v61
    v_exp_f32 v56, v56
    v_exp_f32 v57, v57
    v_cmp_gt_f32 s[38:39], s36, v60
    v_cmp_gt_f32 s[40:41], s36, v61
    v_add_f32 v62, 1.0, v56
    v_add_f32 v63, 1.0, v57
    v_rcp_f32 v62, v62
    v_rcp_f32 v63, v63
    v_sub_f32 v56, 1.0, v56
    v_sub_f32 v57, 1.0, v57
    v_mul_f32 v56, v56, v62
    v_mul_f32 v57, v57, v63
    v_cndmask_b32 v56, v56, v60, s[38:39]
    v_cndmask_b32 v57, v57, v61, s[40:41]
    v_cvt_pk_bf16_f32 v62, v56, v57
    v_lshlrev_b32 v56, 16, v62
    v_and_b32 v57, 0xffff0000, v62
    v_mul_f32 v56, v250, v56
    v_mul_f32 v57, v251, v57
    v_cvt_pk_bf16_f32 v69, v56, v57
    v_mul_f32 v56, -abs(v252), s32
    v_mul_f32 v57, -abs(v253), s32
    v_exp_f32 v56, v56
    v_exp_f32 v57, v57
    v_max_f32 v60, 0, v252
    v_max_f32 v61, 0, v253
    v_cvt_pk_bf16_f32 v62, v56, v57
    v_lshlrev_b32 v56, 16, v62
    v_and_b32 v57, 0xffff0000, v62
    v_add_f32 v58, 1.0, v56
    v_add_f32 v59, 1.0, v57
    v_log_f32 v58, v58
    v_log_f32 v59, v59
    v_cmp_gt_f32 s[38:39], s35, v56
    v_cmp_gt_f32 s[40:41], s35, v57
    v_mul_f32 v58, s33, v58
    v_mul_f32 v59, s33, v59
    v_cndmask_b32 v58, v58, v56, s[38:39]
    v_cndmask_b32 v59, v59, v57, s[40:41]
    v_cvt_pk_bf16_f32 v62, v58, v59
    v_lshlrev_b32 v58, 16, v62
    v_and_b32 v59, 0xffff0000, v62
    v_add_f32 v60, v60, v58
    v_add_f32 v61, v61, v59
    v_cvt_pk_bf16_f32 v62, v60, v61
    v_lshlrev_b32 v60, 16, v62
    v_and_b32 v61, 0xffff0000, v62
    v_mul_f32 v56, s34, v60
    v_mul_f32 v57, s34, v61
    v_exp_f32 v56, v56
    v_exp_f32 v57, v57
    v_cmp_gt_f32 s[38:39], s36, v60
    v_cmp_gt_f32 s[40:41], s36, v61
    v_add_f32 v62, 1.0, v56
    v_add_f32 v63, 1.0, v57
    v_rcp_f32 v62, v62
    v_rcp_f32 v63, v63
    v_sub_f32 v56, 1.0, v56
    v_sub_f32 v57, 1.0, v57
    v_mul_f32 v56, v56, v62
    v_mul_f32 v57, v57, v63
    v_cndmask_b32 v56, v56, v60, s[38:39]
    v_cndmask_b32 v57, v57, v61, s[40:41]
    v_cvt_pk_bf16_f32 v62, v56, v57
    v_lshlrev_b32 v56, 16, v62
    v_and_b32 v57, 0xffff0000, v62
    v_mul_f32 v56, v252, v56
    v_mul_f32 v57, v253, v57
    v_cvt_pk_bf16_f32 v70, v56, v57
    v_mul_f32 v56, -abs(v254), s32
    v_mul_f32 v57, -abs(v255), s32
    v_exp_f32 v56, v56
    v_exp_f32 v57, v57
    v_max_f32 v60, 0, v254
    v_max_f32 v61, 0, v255
    v_cvt_pk_bf16_f32 v62, v56, v57
    v_lshlrev_b32 v56, 16, v62
    v_and_b32 v57, 0xffff0000, v62
    v_add_f32 v58, 1.0, v56
    v_add_f32 v59, 1.0, v57
    v_log_f32 v58, v58
    v_log_f32 v59, v59
    v_cmp_gt_f32 s[38:39], s35, v56
    v_cmp_gt_f32 s[40:41], s35, v57
    v_mul_f32 v58, s33, v58
    v_mul_f32 v59, s33, v59
    v_cndmask_b32 v58, v58, v56, s[38:39]
    v_cndmask_b32 v59, v59, v57, s[40:41]
    v_cvt_pk_bf16_f32 v62, v58, v59
    v_lshlrev_b32 v58, 16, v62
    v_and_b32 v59, 0xffff0000, v62
    v_add_f32 v60, v60, v58
    v_add_f32 v61, v61, v59
    v_cvt_pk_bf16_f32 v62, v60, v61
    v_lshlrev_b32 v60, 16, v62
    v_and_b32 v61, 0xffff0000, v62
    v_mul_f32 v56, s34, v60
    v_mul_f32 v57, s34, v61
    v_exp_f32 v56, v56
    v_exp_f32 v57, v57
    v_cmp_gt_f32 s[38:39], s36, v60
    v_cmp_gt_f32 s[40:41], s36, v61
    v_add_f32 v62, 1.0, v56
    v_add_f32 v63, 1.0, v57
    v_rcp_f32 v62, v62
    v_rcp_f32 v63, v63
    v_sub_f32 v56, 1.0, v56
    v_sub_f32 v57, 1.0, v57
    v_mul_f32 v56, v56, v62
    v_mul_f32 v57, v57, v63
    v_cndmask_b32 v56, v56, v60, s[38:39]
    v_cndmask_b32 v57, v57, v61, s[40:41]
    v_cvt_pk_bf16_f32 v62, v56, v57
    v_lshlrev_b32 v56, 16, v62
    v_and_b32 v57, 0xffff0000, v62
    v_mul_f32 v56, v254, v56
    v_mul_f32 v57, v255, v57
    v_cvt_pk_bf16_f32 v71, v56, v57
    s_add_u32 s30, s31, 203264
    buffer_store_dwordx4 v[68:71], v74, s[20:23], s30 offen sc1
K1_MLP_DONEL:
    s_endpgm
K1_MLP:
    v_lshrrev_b32 v3, 4, v1
    v_and_b32 v23, 31, v1
    v_lshlrev_b32 v23, 7, v23
    v_bfe_u32 v73, v1, 1, 3
    v_add_u32 v74, 0, v72
    v_xor_b32 v74, v74, v73
    v_lshl_add_u32 v8, v74, 4, v23
    v_add_u32 v74, 2, v72
    v_xor_b32 v74, v74, v73
    v_lshl_add_u32 v9, v74, 4, v23
    v_add_u32 v74, 4, v72
    v_xor_b32 v74, v74, v73
    v_lshl_add_u32 v10, v74, 4, v23
    v_add_u32 v74, 6, v72
    v_xor_b32 v74, v74, v73
    v_lshl_add_u32 v11, v74, 4, v23
    v_bfe_u32 v74, v1, 2, 2
    v_lshl_add_u32 v75, v72, 3, v74
    v_lshlrev_b32 v75, 9, v75
    v_bfe_u32 v76, v1, 1, 1
    v_lshl_add_u32 v75, v76, 3, v75
    v_and_b32 v76, 1, v3
    v_and_b32 v77, 1, v1
    v_lshl_add_u32 v76, v76, 1, v77
    s_lshl_b32 s30, s3, 3
    v_add_u32 v76, s30, v76
    v_lshlrev_b32 v74, 2, v74
    v_add_u32 v77, 0, v76
    v_xor_b32 v77, v77, v74
    v_lshl_add_u32 v12, v77, 4, v75
    v_add_u32 v12, 65536, v12
    v_add_u32 v16, 0x10000, v12
    v_add_u32 v77, 4, v76
    v_xor_b32 v77, v77, v74
    v_lshl_add_u32 v13, v77, 4, v75
    v_add_u32 v13, 65536, v13
    v_add_u32 v17, 0x10000, v13
    s_lshl_b32 s42, s25, 8
    s_lshl_b32 s30, s3, 6
    s_add_u32 s42, s42, s30
    v_lshlrev_b32 v74, 4, v72
    s_lshl_b32 s30, s42, 1
    v_add_u32 v74, s30, v74
    global_load_dwordx4 v[96:99], v74, s[86:87] offset:0
    global_load_dwordx4 v[100:103], v74, s[86:87] offset:32
    global_load_dwordx4 v[104:107], v74, s[86:87] offset:64
    global_load_dwordx4 v[108:111], v74, s[86:87] offset:96
    s_mov_b32 s32, 0x3fb8aa3b
    s_mov_b32 s33, 0x3f317218
    s_mov_b32 s34, 0xc038aa3b
    s_mov_b32 s35, 0x39800000
    s_mov_b32 s36, 0x3c800000
    v_and_b32 v24, 1, v0
    v_lshlrev_b32 v24, 31, v24
    v_add_u32 v25, 29952, v0
    v_lshrrev_b32 v25, 1, v25
    v_lshl_or_b32 v25, v25, 16, v24
    v_lshlrev_b32 v26, 2, v0
    v_add_u32 v27, 0, v25
    v_add_u32 v28, 8388608, v25
    v_mul_f32 v56, -abs(v27), s32
    v_mul_f32 v57, -abs(v28), s32
    v_exp_f32 v56, v56
    v_exp_f32 v57, v57
    v_max_f32 v60, 0, v27
    v_max_f32 v61, 0, v28
    v_cvt_pk_bf16_f32 v62, v56, v57
    v_lshlrev_b32 v56, 16, v62
    v_and_b32 v57, 0xffff0000, v62
    v_add_f32 v58, 1.0, v56
    v_add_f32 v59, 1.0, v57
    v_log_f32 v58, v58
    v_log_f32 v59, v59
    v_cmp_gt_f32 s[38:39], s35, v56
    v_cmp_gt_f32 s[40:41], s35, v57
    v_mul_f32 v58, s33, v58
    v_mul_f32 v59, s33, v59
    v_cndmask_b32 v58, v58, v56, s[38:39]
    v_cndmask_b32 v59, v59, v57, s[40:41]
    v_cvt_pk_bf16_f32 v62, v58, v59
    v_lshlrev_b32 v58, 16, v62
    v_and_b32 v59, 0xffff0000, v62
    v_add_f32 v60, v60, v58
    v_add_f32 v61, v61, v59
    v_cvt_pk_bf16_f32 v62, v60, v61
    v_lshlrev_b32 v60, 16, v62
    v_and_b32 v61, 0xffff0000, v62
    v_mul_f32 v56, s34, v60
    v_mul_f32 v57, s34, v61
    v_exp_f32 v56, v56
    v_exp_f32 v57, v57
    v_cmp_gt_f32 s[38:39], s36, v60
    v_cmp_gt_f32 s[40:41], s36, v61
    v_add_f32 v62, 1.0, v56
    v_add_f32 v63, 1.0, v57
    v_rcp_f32 v62, v62
    v_rcp_f32 v63, v63
    v_sub_f32 v56, 1.0, v56
    v_sub_f32 v57, 1.0, v57
    v_mul_f32 v56, v56, v62
    v_mul_f32 v57, v57, v63
    v_cndmask_b32 v56, v56, v60, s[38:39]
    v_cndmask_b32 v57, v57, v61, s[40:41]
    v_cvt_pk_bf16_f32 v62, v56, v57
    v_lshlrev_b32 v56, 16, v62
    v_and_b32 v57, 0xffff0000, v62
    ds_write_b32 v26, v56 offset:0
    ds_write_b32 v26, v57 offset:1024
    v_add_u32 v27, 16777216, v25
    v_add_u32 v28, 25165824, v25
    v_mul_f32 v56, -abs(v27), s32
    v_mul_f32 v57, -abs(v28), s32
    v_exp_f32 v56, v56
    v_exp_f32 v57, v57
    v_max_f32 v60, 0, v27
    v_max_f32 v61, 0, v28
    v_cvt_pk_bf16_f32 v62, v56, v57
    v_lshlrev_b32 v56, 16, v62
    v_and_b32 v57, 0xffff0000, v62
    v_add_f32 v58, 1.0, v56
    v_add_f32 v59, 1.0, v57
    v_log_f32 v58, v58
    v_log_f32 v59, v59
    v_cmp_gt_f32 s[38:39], s35, v56
    v_cmp_gt_f32 s[40:41], s35, v57
    v_mul_f32 v58, s33, v58
    v_mul_f32 v59, s33, v59
    v_cndmask_b32 v58, v58, v56, s[38:39]
    v_cndmask_b32 v59, v59, v57, s[40:41]
    v_cvt_pk_bf16_f32 v62, v58, v59
    v_lshlrev_b32 v58, 16, v62
    v_and_b32 v59, 0xffff0000, v62
    v_add_f32 v60, v60, v58
    v_add_f32 v61, v61, v59
    v_cvt_pk_bf16_f32 v62, v60, v61
    v_lshlrev_b32 v60, 16, v62
    v_and_b32 v61, 0xffff0000, v62
    v_mul_f32 v56, s34, v60
    v_mul_f32 v57, s34, v61
    v_exp_f32 v56, v56
    v_exp_f32 v57, v57
    v_cmp_gt_f32 s[38:39], s36, v60
    v_cmp_gt_f32 s[40:41], s36, v61
    v_add_f32 v62, 1.0, v56
    v_add_f32 v63, 1.0, v57
    v_rcp_f32 v62, v62
    v_rcp_f32 v63, v63
    v_sub_f32 v56, 1.0, v56
    v_sub_f32 v57, 1.0, v57
    v_mul_f32 v56, v56, v62
    v_mul_f32 v57, v57, v63
    v_cndmask_b32 v56, v56, v60, s[38:39]
    v_cndmask_b32 v57, v57, v61, s[40:41]
    v_cvt_pk_bf16_f32 v62, v56, v57
    v_lshlrev_b32 v56, 16, v62
    v_and_b32 v57, 0xffff0000, v62
    ds_write_b32 v26, v56 offset:2048
    ds_write_b32 v26, v57 offset:3072
    v_add_u32 v27, 33554432, v25
    v_add_u32 v28, 41943040, v25
    v_mul_f32 v56, -abs(v27), s32
    v_mul_f32 v57, -abs(v28), s32
    v_exp_f32 v56, v56
    v_exp_f32 v57, v57
    v_max_f32 v60, 0, v27
    v_max_f32 v61, 0, v28
    v_cvt_pk_bf16_f32 v62, v56, v57
    v_lshlrev_b32 v56, 16, v62
    v_and_b32 v57, 0xffff0000, v62
    v_add_f32 v58, 1.0, v56
    v_add_f32 v59, 1.0, v57
    v_log_f32 v58, v58
    v_log_f32 v59, v59
    v_cmp_gt_f32 s[38:39], s35, v56
    v_cmp_gt_f32 s[40:41], s35, v57
    v_mul_f32 v58, s33, v58
    v_mul_f32 v59, s33, v59
    v_cndmask_b32 v58, v58, v56, s[38:39]
    v_cndmask_b32 v59, v59, v57, s[40:41]
    v_cvt_pk_bf16_f32 v62, v58, v59
    v_lshlrev_b32 v58, 16, v62
    v_and_b32 v59, 0xffff0000, v62
    v_add_f32 v60, v60, v58
    v_add_f32 v61, v61, v59
    v_cvt_pk_bf16_f32 v62, v60, v61
    v_lshlrev_b32 v60, 16, v62
    v_and_b32 v61, 0xffff0000, v62
    v_mul_f32 v56, s34, v60
    v_mul_f32 v57, s34, v61
    v_exp_f32 v56, v56
    v_exp_f32 v57, v57
    v_cmp_gt_f32 s[38:39], s36, v60
    v_cmp_gt_f32 s[40:41], s36, v61
    v_add_f32 v62, 1.0, v56
    v_add_f32 v63, 1.0, v57
    v_rcp_f32 v62, v62
    v_rcp_f32 v63, v63
    v_sub_f32 v56, 1.0, v56
    v_sub_f32 v57, 1.0, v57
    v_mul_f32 v56, v56, v62
    v_mul_f32 v57, v57, v63
    v_cndmask_b32 v56, v56, v60, s[38:39]
    v_cndmask_b32 v57, v57, v61, s[40:41]
    v_cvt_pk_bf16_f32 v62, v56, v57
    v_lshlrev_b32 v56, 16, v62
    v_and_b32 v57, 0xffff0000, v62
    ds_write_b32 v26, v56 offset:4096
    ds_write_b32 v26, v57 offset:5120
    v_add_u32 v27, 50331648, v25
    v_add_u32 v28, 58720256, v25
    v_mul_f32 v56, -abs(v27), s32
    v_mul_f32 v57, -abs(v28), s32
    v_exp_f32 v56, v56
    v_exp_f32 v57, v57
    v_max_f32 v60, 0, v27
    v_max_f32 v61, 0, v28
    v_cvt_pk_bf16_f32 v62, v56, v57
    v_lshlrev_b32 v56, 16, v62
    v_and_b32 v57, 0xffff0000, v62
    v_add_f32 v58, 1.0, v56
    v_add_f32 v59, 1.0, v57
    v_log_f32 v58, v58
    v_log_f32 v59, v59
    v_cmp_gt_f32 s[38:39], s35, v56
    v_cmp_gt_f32 s[40:41], s35, v57
    v_mul_f32 v58, s33, v58
    v_mul_f32 v59, s33, v59
    v_cndmask_b32 v58, v58, v56, s[38:39]
    v_cndmask_b32 v59, v59, v57, s[40:41]
    v_cvt_pk_bf16_f32 v62, v58, v59
    v_lshlrev_b32 v58, 16, v62
    v_and_b32 v59, 0xffff0000, v62
    v_add_f32 v60, v60, v58
    v_add_f32 v61, v61, v59
    v_cvt_pk_bf16_f32 v62, v60, v61
    v_lshlrev_b32 v60, 16, v62
    v_and_b32 v61, 0xffff0000, v62
    v_mul_f32 v56, s34, v60
    v_mul_f32 v57, s34, v61
    v_exp_f32 v56, v56
    v_exp_f32 v57, v57
    v_cmp_gt_f32 s[38:39], s36, v60
    v_cmp_gt_f32 s[40:41], s36, v61
    v_add_f32 v62, 1.0, v56
    v_add_f32 v63, 1.0, v57
    v_rcp_f32 v62, v62
    v_rcp_f32 v63, v63
    v_sub_f32 v56, 1.0, v56
    v_sub_f32 v57, 1.0, v57
    v_mul_f32 v56, v56, v62
    v_mul_f32 v57, v57, v63
    v_cndmask_b32 v56, v56, v60, s[38:39]
    v_cndmask_b32 v57, v57, v61, s[40:41]
    v_cvt_pk_bf16_f32 v62, v56, v57
    v_lshlrev_b32 v56, 16, v62
    v_and_b32 v57, 0xffff0000, v62
    ds_write_b32 v26, v56 offset:6144
    ds_write_b32 v26, v57 offset:7168
    v_add_u32 v27, 67108864, v25
    v_add_u32 v28, 75497472, v25
    v_mul_f32 v56, -abs(v27), s32
    v_mul_f32 v57, -abs(v28), s32
    v_exp_f32 v56, v56
    v_exp_f32 v57, v57
    v_max_f32 v60, 0, v27
    v_max_f32 v61, 0, v28
    v_cvt_pk_bf16_f32 v62, v56, v57
    v_lshlrev_b32 v56, 16, v62
    v_and_b32 v57, 0xffff0000, v62
    v_add_f32 v58, 1.0, v56
    v_add_f32 v59, 1.0, v57
    v_log_f32 v58, v58
    v_log_f32 v59, v59
    v_cmp_gt_f32 s[38:39], s35, v56
    v_cmp_gt_f32 s[40:41], s35, v57
    v_mul_f32 v58, s33, v58
    v_mul_f32 v59, s33, v59
    v_cndmask_b32 v58, v58, v56, s[38:39]
    v_cndmask_b32 v59, v59, v57, s[40:41]
    v_cvt_pk_bf16_f32 v62, v58, v59
    v_lshlrev_b32 v58, 16, v62
    v_and_b32 v59, 0xffff0000, v62
    v_add_f32 v60, v60, v58
    v_add_f32 v61, v61, v59
    v_cvt_pk_bf16_f32 v62, v60, v61
    v_lshlrev_b32 v60, 16, v62
    v_and_b32 v61, 0xffff0000, v62
    v_mul_f32 v56, s34, v60
    v_mul_f32 v57, s34, v61
    v_exp_f32 v56, v56
    v_exp_f32 v57, v57
    v_cmp_gt_f32 s[38:39], s36, v60
    v_cmp_gt_f32 s[40:41], s36, v61
    v_add_f32 v62, 1.0, v56
    v_add_f32 v63, 1.0, v57
    v_rcp_f32 v62, v62
    v_rcp_f32 v63, v63
    v_sub_f32 v56, 1.0, v56
    v_sub_f32 v57, 1.0, v57
    v_mul_f32 v56, v56, v62
    v_mul_f32 v57, v57, v63
    v_cndmask_b32 v56, v56, v60, s[38:39]
    v_cndmask_b32 v57, v57, v61, s[40:41]
    v_cvt_pk_bf16_f32 v62, v56, v57
    v_lshlrev_b32 v56, 16, v62
    v_and_b32 v57, 0xffff0000, v62
    ds_write_b32 v26, v56 offset:8192
    ds_write_b32 v26, v57 offset:9216
    v_add_u32 v27, 83886080, v25
    v_add_u32 v28, 92274688, v25
    v_mul_f32 v56, -abs(v27), s32
    v_mul_f32 v57, -abs(v28), s32
    v_exp_f32 v56, v56
    v_exp_f32 v57, v57
    v_max_f32 v60, 0, v27
    v_max_f32 v61, 0, v28
    v_cvt_pk_bf16_f32 v62, v56, v57
    v_lshlrev_b32 v56, 16, v62
    v_and_b32 v57, 0xffff0000, v62
    v_add_f32 v58, 1.0, v56
    v_add_f32 v59, 1.0, v57
    v_log_f32 v58, v58
    v_log_f32 v59, v59
    v_cmp_gt_f32 s[38:39], s35, v56
    v_cmp_gt_f32 s[40:41], s35, v57
    v_mul_f32 v58, s33, v58
    v_mul_f32 v59, s33, v59
    v_cndmask_b32 v58, v58, v56, s[38:39]
    v_cndmask_b32 v59, v59, v57, s[40:41]
    v_cvt_pk_bf16_f32 v62, v58, v59
    v_lshlrev_b32 v58, 16, v62
    v_and_b32 v59, 0xffff0000, v62
    v_add_f32 v60, v60, v58
    v_add_f32 v61, v61, v59
    v_cvt_pk_bf16_f32 v62, v60, v61
    v_lshlrev_b32 v60, 16, v62
    v_and_b32 v61, 0xffff0000, v62
    v_mul_f32 v56, s34, v60
    v_mul_f32 v57, s34, v61
    v_exp_f32 v56, v56
    v_exp_f32 v57, v57
    v_cmp_gt_f32 s[38:39], s36, v60
    v_cmp_gt_f32 s[40:41], s36, v61
    v_add_f32 v62, 1.0, v56
    v_add_f32 v63, 1.0, v57
    v_rcp_f32 v62, v62
    v_rcp_f32 v63, v63
    v_sub_f32 v56, 1.0, v56
    v_sub_f32 v57, 1.0, v57
    v_mul_f32 v56, v56, v62
    v_mul_f32 v57, v57, v63
    v_cndmask_b32 v56, v56, v60, s[38:39]
    v_cndmask_b32 v57, v57, v61, s[40:41]
    v_cvt_pk_bf16_f32 v62, v56, v57
    v_lshlrev_b32 v56, 16, v62
    v_and_b32 v57, 0xffff0000, v62
    ds_write_b32 v26, v56 offset:10240
    ds_write_b32 v26, v57 offset:11264
    v_add_u32 v27, 100663296, v25
    v_add_u32 v28, 109051904, v25
    v_mul_f32 v56, -abs(v27), s32
    v_mul_f32 v57, -abs(v28), s32
    v_exp_f32 v56, v56
    v_exp_f32 v57, v57
    v_max_f32 v60, 0, v27
    v_max_f32 v61, 0, v28
    v_cvt_pk_bf16_f32 v62, v56, v57
    v_lshlrev_b32 v56, 16, v62
    v_and_b32 v57, 0xffff0000, v62
    v_add_f32 v58, 1.0, v56
    v_add_f32 v59, 1.0, v57
    v_log_f32 v58, v58
    v_log_f32 v59, v59
    v_cmp_gt_f32 s[38:39], s35, v56
    v_cmp_gt_f32 s[40:41], s35, v57
    v_mul_f32 v58, s33, v58
    v_mul_f32 v59, s33, v59
    v_cndmask_b32 v58, v58, v56, s[38:39]
    v_cndmask_b32 v59, v59, v57, s[40:41]
    v_cvt_pk_bf16_f32 v62, v58, v59
    v_lshlrev_b32 v58, 16, v62
    v_and_b32 v59, 0xffff0000, v62
    v_add_f32 v60, v60, v58
    v_add_f32 v61, v61, v59
    v_cvt_pk_bf16_f32 v62, v60, v61
    v_lshlrev_b32 v60, 16, v62
    v_and_b32 v61, 0xffff0000, v62
    v_mul_f32 v56, s34, v60
    v_mul_f32 v57, s34, v61
    v_exp_f32 v56, v56
    v_exp_f32 v57, v57
    v_cmp_gt_f32 s[38:39], s36, v60
    v_cmp_gt_f32 s[40:41], s36, v61
    v_add_f32 v62, 1.0, v56
    v_add_f32 v63, 1.0, v57
    v_rcp_f32 v62, v62
    v_rcp_f32 v63, v63
    v_sub_f32 v56, 1.0, v56
    v_sub_f32 v57, 1.0, v57
    v_mul_f32 v56, v56, v62
    v_mul_f32 v57, v57, v63
    v_cndmask_b32 v56, v56, v60, s[38:39]
    v_cndmask_b32 v57, v57, v61, s[40:41]
    v_cvt_pk_bf16_f32 v62, v56, v57
    v_lshlrev_b32 v56, 16, v62
    v_and_b32 v57, 0xffff0000, v62
    ds_write_b32 v26, v56 offset:12288
    ds_write_b32 v26, v57 offset:13312
    v_mov_b32 v128, 0
    v_mov_b32 v129, 0
    v_mov_b32 v130, 0
    v_mov_b32 v131, 0
    v_mov_b32 v132, 0
    v_mov_b32 v133, 0
    v_mov_b32 v134, 0
    v_mov_b32 v135, 0
    v_mov_b32 v136, 0
    v_mov_b32 v137, 0
    v_mov_b32 v138, 0
    v_mov_b32 v139, 0
    v_mov_b32 v140, 0
    v_mov_b32 v141, 0
    v_mov_b32 v142, 0
    v_mov_b32 v143, 0
    v_mov_b32 v144, 0
    v_mov_b32 v145, 0
    v_mov_b32 v146, 0
    v_mov_b32 v147, 0
    v_mov_b32 v148, 0
    v_mov_b32 v149, 0
    v_mov_b32 v150, 0
    v_mov_b32 v151, 0
    v_mov_b32 v152, 0
    v_mov_b32 v153, 0
    v_mov_b32 v154, 0
    v_mov_b32 v155, 0
    v_mov_b32 v156, 0
    v_mov_b32 v157, 0
    v_mov_b32 v158, 0
    v_mov_b32 v159, 0
    v_mov_b32 v160, 0
    v_mov_b32 v161, 0
    v_mov_b32 v162, 0
    v_mov_b32 v163, 0
    v_mov_b32 v164, 0
    v_mov_b32 v165, 0
    v_mov_b32 v166, 0
    v_mov_b32 v167, 0
    v_mov_b32 v168, 0
    v_mov_b32 v169, 0
    v_mov_b32 v170, 0
    v_mov_b32 v171, 0
    v_mov_b32 v172, 0
    v_mov_b32 v173, 0
    v_mov_b32 v174, 0
    v_mov_b32 v175, 0
    v_mov_b32 v176, 0
    v_mov_b32 v177, 0
    v_mov_b32 v178, 0
    v_mov_b32 v179, 0
    v_mov_b32 v180, 0
    v_mov_b32 v181, 0
    v_mov_b32 v182, 0
    v_mov_b32 v183, 0
    v_mov_b32 v184, 0
    v_mov_b32 v185, 0
    v_mov_b32 v186, 0
    v_mov_b32 v187, 0
    v_mov_b32 v188, 0
    v_mov_b32 v189, 0
    v_mov_b32 v190, 0
    v_mov_b32 v191, 0
    v_mov_b32 v192, 0
    v_mov_b32 v193, 0
    v_mov_b32 v194, 0
    v_mov_b32 v195, 0
    v_mov_b32 v196, 0
    v_mov_b32 v197, 0
    v_mov_b32 v198, 0
    v_mov_b32 v199, 0
    v_mov_b32 v200, 0
    v_mov_b32 v201, 0
    v_mov_b32 v202, 0
    v_mov_b32 v203, 0
    v_mov_b32 v204, 0
    v_mov_b32 v205, 0
    v_mov_b32 v206, 0
    v_mov_b32 v207, 0
    v_mov_b32 v208, 0
    v_mov_b32 v209, 0
    v_mov_b32 v210, 0
    v_mov_b32 v211, 0
    v_mov_b32 v212, 0
    v_mov_b32 v213, 0
    v_mov_b32 v214, 0
    v_mov_b32 v215, 0
    v_mov_b32 v216, 0
    v_mov_b32 v217, 0
    v_mov_b32 v218, 0
    v_mov_b32 v219, 0
    v_mov_b32 v220, 0
    v_mov_b32 v221, 0
    v_mov_b32 v222, 0
    v_mov_b32 v223, 0
    v_mov_b32 v224, 0
    v_mov_b32 v225, 0
    v_mov_b32 v226, 0
    v_mov_b32 v227, 0
    v_mov_b32 v228, 0
    v_mov_b32 v229, 0
    v_mov_b32 v230, 0
    v_mov_b32 v231, 0
    v_mov_b32 v232, 0
    v_mov_b32 v233, 0
    v_mov_b32 v234, 0
    v_mov_b32 v235, 0
    v_mov_b32 v236, 0
    v_mov_b32 v237, 0
    v_mov_b32 v238, 0
    v_mov_b32 v239, 0
    v_mov_b32 v240, 0
    v_mov_b32 v241, 0
    v_mov_b32 v242, 0
    v_mov_b32 v243, 0
    v_mov_b32 v244, 0
    v_mov_b32 v245, 0
    v_mov_b32 v246, 0
    v_mov_b32 v247, 0
    v_mov_b32 v248, 0
    v_mov_b32 v249, 0
    v_mov_b32 v250, 0
    v_mov_b32 v251, 0
    v_mov_b32 v252, 0
    v_mov_b32 v253, 0
    v_mov_b32 v254, 0
    v_mov_b32 v255, 0
    s_waitcnt lgkmcnt(0)
    s_barrier
    ds_read_b128 v[24:27], v8 offset:16384
    ds_read_b128 v[28:31], v8 offset:20480
    ds_read_b128 v[32:35], v8 offset:24576
    ds_read_b128 v[36:39], v8 offset:28672
    ds_read_b64_tr_b16 v[40:41], v12 offset:0
    ds_read_b64_tr_b16 v[42:43], v12 offset:2048
    ds_read_b64_tr_b16 v[44:45], v13 offset:0
    ds_read_b64_tr_b16 v[46:47], v13 offset:2048
    ds_read_b128 v[48:51], v9 offset:16384
    ds_read_b128 v[52:55], v9 offset:20480
    ds_read_b128 v[56:59], v9 offset:24576
    ds_read_b128 v[60:63], v9 offset:28672
    ds_read_b64_tr_b16 v[64:65], v12 offset:8192
    ds_read_b64_tr_b16 v[66:67], v12 offset:10240
    ds_read_b64_tr_b16 v[68:69], v13 offset:8192
    ds_read_b64_tr_b16 v[70:71], v13 offset:10240
    s_waitcnt lgkmcnt(8)
    v_mfma_f32_32x32x16_bf16 v[128:143], v[40:43], v[24:27], v[128:143]
    v_mfma_f32_32x32x16_bf16 v[144:159], v[44:47], v[24:27], v[144:159]
    v_mfma_f32_32x32x16_bf16 v[160:175], v[40:43], v[28:31], v[160:175]
    v_mfma_f32_32x32x16_bf16 v[176:191], v[44:47], v[28:31], v[176:191]
    v_mfma_f32_32x32x16_bf16 v[192:207], v[40:43], v[32:35], v[192:207]
    v_mfma_f32_32x32x16_bf16 v[208:223], v[44:47], v[32:35], v[208:223]
    v_mfma_f32_32x32x16_bf16 v[224:239], v[40:43], v[36:39], v[224:239]
    v_mfma_f32_32x32x16_bf16 v[240:255], v[44:47], v[36:39], v[240:255]
    ds_read_b128 v[24:27], v10 offset:16384
    ds_read_b128 v[28:31], v10 offset:20480
    ds_read_b128 v[32:35], v10 offset:24576
    ds_read_b128 v[36:39], v10 offset:28672
    ds_read_b64_tr_b16 v[40:41], v12 offset:16384
    ds_read_b64_tr_b16 v[42:43], v12 offset:18432
    ds_read_b64_tr_b16 v[44:45], v13 offset:16384
    ds_read_b64_tr_b16 v[46:47], v13 offset:18432
    s_waitcnt lgkmcnt(8)
    v_mfma_f32_32x32x16_bf16 v[128:143], v[64:67], v[48:51], v[128:143]
    v_mfma_f32_32x32x16_bf16 v[144:159], v[68:71], v[48:51], v[144:159]
    v_mfma_f32_32x32x16_bf16 v[160:175], v[64:67], v[52:55], v[160:175]
    v_mfma_f32_32x32x16_bf16 v[176:191], v[68:71], v[52:55], v[176:191]
    v_mfma_f32_32x32x16_bf16 v[192:207], v[64:67], v[56:59], v[192:207]
    v_mfma_f32_32x32x16_bf16 v[208:223], v[68:71], v[56:59], v[208:223]
    v_mfma_f32_32x32x16_bf16 v[224:239], v[64:67], v[60:63], v[224:239]
    v_mfma_f32_32x32x16_bf16 v[240:255], v[68:71], v[60:63], v[240:255]
    ds_read_b128 v[48:51], v11 offset:16384
    ds_read_b128 v[52:55], v11 offset:20480
    ds_read_b128 v[56:59], v11 offset:24576
    ds_read_b128 v[60:63], v11 offset:28672
    ds_read_b64_tr_b16 v[64:65], v12 offset:24576
    ds_read_b64_tr_b16 v[66:67], v12 offset:26624
    ds_read_b64_tr_b16 v[68:69], v13 offset:24576
    ds_read_b64_tr_b16 v[70:71], v13 offset:26624
    s_waitcnt lgkmcnt(8)
    v_mfma_f32_32x32x16_bf16 v[128:143], v[40:43], v[24:27], v[128:143]
    v_mfma_f32_32x32x16_bf16 v[144:159], v[44:47], v[24:27], v[144:159]
    v_mfma_f32_32x32x16_bf16 v[160:175], v[40:43], v[28:31], v[160:175]
    v_mfma_f32_32x32x16_bf16 v[176:191], v[44:47], v[28:31], v[176:191]
    v_mfma_f32_32x32x16_bf16 v[192:207], v[40:43], v[32:35], v[192:207]
    v_mfma_f32_32x32x16_bf16 v[208:223], v[44:47], v[32:35], v[208:223]
    v_mfma_f32_32x32x16_bf16 v[224:239], v[40:43], v[36:39], v[224:239]
    v_mfma_f32_32x32x16_bf16 v[240:255], v[44:47], v[36:39], v[240:255]
    s_waitcnt lgkmcnt(0)
    v_mfma_f32_32x32x16_bf16 v[128:143], v[64:67], v[48:51], v[128:143]
    v_mfma_f32_32x32x16_bf16 v[144:159], v[68:71], v[48:51], v[144:159]
    v_mfma_f32_32x32x16_bf16 v[160:175], v[64:67], v[52:55], v[160:175]
    v_mfma_f32_32x32x16_bf16 v[176:191], v[68:71], v[52:55], v[176:191]
    v_mfma_f32_32x32x16_bf16 v[192:207], v[64:67], v[56:59], v[192:207]
    v_mfma_f32_32x32x16_bf16 v[208:223], v[68:71], v[56:59], v[208:223]
    v_mfma_f32_32x32x16_bf16 v[224:239], v[64:67], v[60:63], v[224:239]
    v_mfma_f32_32x32x16_bf16 v[240:255], v[68:71], v[60:63], v[240:255]
    s_barrier
    ds_read_b128 v[24:27], v8 offset:32768
    ds_read_b128 v[28:31], v8 offset:36864
    ds_read_b128 v[32:35], v8 offset:40960
    ds_read_b128 v[36:39], v8 offset:45056
    ds_read_b64_tr_b16 v[40:41], v12 offset:32768
    ds_read_b64_tr_b16 v[42:43], v12 offset:34816
    ds_read_b64_tr_b16 v[44:45], v13 offset:32768
    ds_read_b64_tr_b16 v[46:47], v13 offset:34816
    ds_read_b128 v[48:51], v9 offset:32768
    ds_read_b128 v[52:55], v9 offset:36864
    ds_read_b128 v[56:59], v9 offset:40960
    ds_read_b128 v[60:63], v9 offset:45056
    ds_read_b64_tr_b16 v[64:65], v12 offset:40960
    ds_read_b64_tr_b16 v[66:67], v12 offset:43008
    ds_read_b64_tr_b16 v[68:69], v13 offset:40960
    ds_read_b64_tr_b16 v[70:71], v13 offset:43008
    s_waitcnt lgkmcnt(8)
    v_mfma_f32_32x32x16_bf16 v[128:143], v[40:43], v[24:27], v[128:143]
    v_mfma_f32_32x32x16_bf16 v[144:159], v[44:47], v[24:27], v[144:159]
    v_mfma_f32_32x32x16_bf16 v[160:175], v[40:43], v[28:31], v[160:175]
    v_mfma_f32_32x32x16_bf16 v[176:191], v[44:47], v[28:31], v[176:191]
    v_mfma_f32_32x32x16_bf16 v[192:207], v[40:43], v[32:35], v[192:207]
    v_mfma_f32_32x32x16_bf16 v[208:223], v[44:47], v[32:35], v[208:223]
    v_mfma_f32_32x32x16_bf16 v[224:239], v[40:43], v[36:39], v[224:239]
    v_mfma_f32_32x32x16_bf16 v[240:255], v[44:47], v[36:39], v[240:255]
    ds_read_b128 v[24:27], v10 offset:32768
    ds_read_b128 v[28:31], v10 offset:36864
    ds_read_b128 v[32:35], v10 offset:40960
    ds_read_b128 v[36:39], v10 offset:45056
    ds_read_b64_tr_b16 v[40:41], v12 offset:49152
    ds_read_b64_tr_b16 v[42:43], v12 offset:51200
    ds_read_b64_tr_b16 v[44:45], v13 offset:49152
    ds_read_b64_tr_b16 v[46:47], v13 offset:51200
    s_waitcnt lgkmcnt(8)
    v_mfma_f32_32x32x16_bf16 v[128:143], v[64:67], v[48:51], v[128:143]
    v_mfma_f32_32x32x16_bf16 v[144:159], v[68:71], v[48:51], v[144:159]
    v_mfma_f32_32x32x16_bf16 v[160:175], v[64:67], v[52:55], v[160:175]
    v_mfma_f32_32x32x16_bf16 v[176:191], v[68:71], v[52:55], v[176:191]
    v_mfma_f32_32x32x16_bf16 v[192:207], v[64:67], v[56:59], v[192:207]
    v_mfma_f32_32x32x16_bf16 v[208:223], v[68:71], v[56:59], v[208:223]
    v_mfma_f32_32x32x16_bf16 v[224:239], v[64:67], v[60:63], v[224:239]
    v_mfma_f32_32x32x16_bf16 v[240:255], v[68:71], v[60:63], v[240:255]
    ds_read_b128 v[48:51], v11 offset:32768
    ds_read_b128 v[52:55], v11 offset:36864
    ds_read_b128 v[56:59], v11 offset:40960
    ds_read_b128 v[60:63], v11 offset:45056
    ds_read_b64_tr_b16 v[64:65], v12 offset:57344
    ds_read_b64_tr_b16 v[66:67], v12 offset:59392
    ds_read_b64_tr_b16 v[68:69], v13 offset:57344
    ds_read_b64_tr_b16 v[70:71], v13 offset:59392
    s_waitcnt lgkmcnt(8)
    v_mfma_f32_32x32x16_bf16 v[128:143], v[40:43], v[24:27], v[128:143]
    v_mfma_f32_32x32x16_bf16 v[144:159], v[44:47], v[24:27], v[144:159]
    v_mfma_f32_32x32x16_bf16 v[160:175], v[40:43], v[28:31], v[160:175]
    v_mfma_f32_32x32x16_bf16 v[176:191], v[44:47], v[28:31], v[176:191]
    v_mfma_f32_32x32x16_bf16 v[192:207], v[40:43], v[32:35], v[192:207]
    v_mfma_f32_32x32x16_bf16 v[208:223], v[44:47], v[32:35], v[208:223]
    v_mfma_f32_32x32x16_bf16 v[224:239], v[40:43], v[36:39], v[224:239]
    v_mfma_f32_32x32x16_bf16 v[240:255], v[44:47], v[36:39], v[240:255]
    s_waitcnt lgkmcnt(0)
    v_mfma_f32_32x32x16_bf16 v[128:143], v[64:67], v[48:51], v[128:143]
    v_mfma_f32_32x32x16_bf16 v[144:159], v[68:71], v[48:51], v[144:159]
    v_mfma_f32_32x32x16_bf16 v[160:175], v[64:67], v[52:55], v[160:175]
    v_mfma_f32_32x32x16_bf16 v[176:191], v[68:71], v[52:55], v[176:191]
    v_mfma_f32_32x32x16_bf16 v[192:207], v[64:67], v[56:59], v[192:207]
    v_mfma_f32_32x32x16_bf16 v[208:223], v[68:71], v[56:59], v[208:223]
    v_mfma_f32_32x32x16_bf16 v[224:239], v[64:67], v[60:63], v[224:239]
    v_mfma_f32_32x32x16_bf16 v[240:255], v[68:71], v[60:63], v[240:255]
    s_barrier
    ds_read_b128 v[24:27], v8 offset:49152
    ds_read_b128 v[28:31], v8 offset:53248
    ds_read_b128 v[32:35], v8 offset:57344
    ds_read_b128 v[36:39], v8 offset:61440
    ds_read_b64_tr_b16 v[40:41], v16 offset:0
    ds_read_b64_tr_b16 v[42:43], v16 offset:2048
    ds_read_b64_tr_b16 v[44:45], v17 offset:0
    ds_read_b64_tr_b16 v[46:47], v17 offset:2048
    ds_read_b128 v[48:51], v9 offset:49152
    ds_read_b128 v[52:55], v9 offset:53248
    ds_read_b128 v[56:59], v9 offset:57344
    ds_read_b128 v[60:63], v9 offset:61440
    ds_read_b64_tr_b16 v[64:65], v16 offset:8192
    ds_read_b64_tr_b16 v[66:67], v16 offset:10240
    ds_read_b64_tr_b16 v[68:69], v17 offset:8192
    ds_read_b64_tr_b16 v[70:71], v17 offset:10240
    s_waitcnt lgkmcnt(8)
    v_mfma_f32_32x32x16_bf16 v[128:143], v[40:43], v[24:27], v[128:143]
    v_mfma_f32_32x32x16_bf16 v[144:159], v[44:47], v[24:27], v[144:159]
    v_mfma_f32_32x32x16_bf16 v[160:175], v[40:43], v[28:31], v[160:175]
    v_mfma_f32_32x32x16_bf16 v[176:191], v[44:47], v[28:31], v[176:191]
    v_mfma_f32_32x32x16_bf16 v[192:207], v[40:43], v[32:35], v[192:207]
    v_mfma_f32_32x32x16_bf16 v[208:223], v[44:47], v[32:35], v[208:223]
    v_mfma_f32_32x32x16_bf16 v[224:239], v[40:43], v[36:39], v[224:239]
    v_mfma_f32_32x32x16_bf16 v[240:255], v[44:47], v[36:39], v[240:255]
    ds_read_b128 v[24:27], v10 offset:49152
    ds_read_b128 v[28:31], v10 offset:53248
    ds_read_b128 v[32:35], v10 offset:57344
    ds_read_b128 v[36:39], v10 offset:61440
    ds_read_b64_tr_b16 v[40:41], v16 offset:16384
    ds_read_b64_tr_b16 v[42:43], v16 offset:18432
    ds_read_b64_tr_b16 v[44:45], v17 offset:16384
    ds_read_b64_tr_b16 v[46:47], v17 offset:18432
    s_waitcnt lgkmcnt(8)
    v_mfma_f32_32x32x16_bf16 v[128:143], v[64:67], v[48:51], v[128:143]
    v_mfma_f32_32x32x16_bf16 v[144:159], v[68:71], v[48:51], v[144:159]
    v_mfma_f32_32x32x16_bf16 v[160:175], v[64:67], v[52:55], v[160:175]
    v_mfma_f32_32x32x16_bf16 v[176:191], v[68:71], v[52:55], v[176:191]
    v_mfma_f32_32x32x16_bf16 v[192:207], v[64:67], v[56:59], v[192:207]
    v_mfma_f32_32x32x16_bf16 v[208:223], v[68:71], v[56:59], v[208:223]
    v_mfma_f32_32x32x16_bf16 v[224:239], v[64:67], v[60:63], v[224:239]
    v_mfma_f32_32x32x16_bf16 v[240:255], v[68:71], v[60:63], v[240:255]
    ds_read_b128 v[48:51], v11 offset:49152
    ds_read_b128 v[52:55], v11 offset:53248
    ds_read_b128 v[56:59], v11 offset:57344
    ds_read_b128 v[60:63], v11 offset:61440
    ds_read_b64_tr_b16 v[64:65], v16 offset:24576
    ds_read_b64_tr_b16 v[66:67], v16 offset:26624
    ds_read_b64_tr_b16 v[68:69], v17 offset:24576
    ds_read_b64_tr_b16 v[70:71], v17 offset:26624
    s_waitcnt lgkmcnt(8)
    v_mfma_f32_32x32x16_bf16 v[128:143], v[40:43], v[24:27], v[128:143]
    v_mfma_f32_32x32x16_bf16 v[144:159], v[44:47], v[24:27], v[144:159]
    v_mfma_f32_32x32x16_bf16 v[160:175], v[40:43], v[28:31], v[160:175]
    v_mfma_f32_32x32x16_bf16 v[176:191], v[44:47], v[28:31], v[176:191]
    v_mfma_f32_32x32x16_bf16 v[192:207], v[40:43], v[32:35], v[192:207]
    v_mfma_f32_32x32x16_bf16 v[208:223], v[44:47], v[32:35], v[208:223]
    v_mfma_f32_32x32x16_bf16 v[224:239], v[40:43], v[36:39], v[224:239]
    v_mfma_f32_32x32x16_bf16 v[240:255], v[44:47], v[36:39], v[240:255]
    s_waitcnt lgkmcnt(0)
    v_mfma_f32_32x32x16_bf16 v[128:143], v[64:67], v[48:51], v[128:143]
    v_mfma_f32_32x32x16_bf16 v[144:159], v[68:71], v[48:51], v[144:159]
    v_mfma_f32_32x32x16_bf16 v[160:175], v[64:67], v[52:55], v[160:175]
    v_mfma_f32_32x32x16_bf16 v[176:191], v[68:71], v[52:55], v[176:191]
    v_mfma_f32_32x32x16_bf16 v[192:207], v[64:67], v[56:59], v[192:207]
    v_mfma_f32_32x32x16_bf16 v[208:223], v[68:71], v[56:59], v[208:223]
    v_mfma_f32_32x32x16_bf16 v[224:239], v[64:67], v[60:63], v[224:239]
    v_mfma_f32_32x32x16_bf16 v[240:255], v[68:71], v[60:63], v[240:255]
    s_barrier
    ds_read_b128 v[24:27], v8 offset:16384
    ds_read_b128 v[28:31], v8 offset:20480
    ds_read_b128 v[32:35], v8 offset:24576
    ds_read_b128 v[36:39], v8 offset:28672
    ds_read_b64_tr_b16 v[40:41], v12 offset:0
    ds_read_b64_tr_b16 v[42:43], v12 offset:2048
    ds_read_b64_tr_b16 v[44:45], v13 offset:0
    ds_read_b64_tr_b16 v[46:47], v13 offset:2048
    ds_read_b128 v[48:51], v9 offset:16384
    ds_read_b128 v[52:55], v9 offset:20480
    ds_read_b128 v[56:59], v9 offset:24576
    ds_read_b128 v[60:63], v9 offset:28672
    ds_read_b64_tr_b16 v[64:65], v12 offset:8192
    ds_read_b64_tr_b16 v[66:67], v12 offset:10240
    ds_read_b64_tr_b16 v[68:69], v13 offset:8192
    ds_read_b64_tr_b16 v[70:71], v13 offset:10240
    s_waitcnt lgkmcnt(8)
    v_mfma_f32_32x32x16_bf16 v[128:143], v[40:43], v[24:27], v[128:143]
    v_mfma_f32_32x32x16_bf16 v[144:159], v[44:47], v[24:27], v[144:159]
    v_mfma_f32_32x32x16_bf16 v[160:175], v[40:43], v[28:31], v[160:175]
    v_mfma_f32_32x32x16_bf16 v[176:191], v[44:47], v[28:31], v[176:191]
    v_mfma_f32_32x32x16_bf16 v[192:207], v[40:43], v[32:35], v[192:207]
    v_mfma_f32_32x32x16_bf16 v[208:223], v[44:47], v[32:35], v[208:223]
    v_mfma_f32_32x32x16_bf16 v[224:239], v[40:43], v[36:39], v[224:239]
    v_mfma_f32_32x32x16_bf16 v[240:255], v[44:47], v[36:39], v[240:255]
    ds_read_b128 v[24:27], v10 offset:16384
    ds_read_b128 v[28:31], v10 offset:20480
    ds_read_b128 v[32:35], v10 offset:24576
    ds_read_b128 v[36:39], v10 offset:28672
    ds_read_b64_tr_b16 v[40:41], v12 offset:16384
    ds_read_b64_tr_b16 v[42:43], v12 offset:18432
    ds_read_b64_tr_b16 v[44:45], v13 offset:16384
    ds_read_b64_tr_b16 v[46:47], v13 offset:18432
    s_waitcnt lgkmcnt(8)
    v_mfma_f32_32x32x16_bf16 v[128:143], v[64:67], v[48:51], v[128:143]
    v_mfma_f32_32x32x16_bf16 v[144:159], v[68:71], v[48:51], v[144:159]
    v_mfma_f32_32x32x16_bf16 v[160:175], v[64:67], v[52:55], v[160:175]
    v_mfma_f32_32x32x16_bf16 v[176:191], v[68:71], v[52:55], v[176:191]
    v_mfma_f32_32x32x16_bf16 v[192:207], v[64:67], v[56:59], v[192:207]
    v_mfma_f32_32x32x16_bf16 v[208:223], v[68:71], v[56:59], v[208:223]
    v_mfma_f32_32x32x16_bf16 v[224:239], v[64:67], v[60:63], v[224:239]
    v_mfma_f32_32x32x16_bf16 v[240:255], v[68:71], v[60:63], v[240:255]
    ds_read_b128 v[48:51], v11 offset:16384
    ds_read_b128 v[52:55], v11 offset:20480
    ds_read_b128 v[56:59], v11 offset:24576
    ds_read_b128 v[60:63], v11 offset:28672
    ds_read_b64_tr_b16 v[64:65], v12 offset:24576
    ds_read_b64_tr_b16 v[66:67], v12 offset:26624
    ds_read_b64_tr_b16 v[68:69], v13 offset:24576
    ds_read_b64_tr_b16 v[70:71], v13 offset:26624
    s_waitcnt lgkmcnt(8)
    v_mfma_f32_32x32x16_bf16 v[128:143], v[40:43], v[24:27], v[128:143]
    v_mfma_f32_32x32x16_bf16 v[144:159], v[44:47], v[24:27], v[144:159]
    v_mfma_f32_32x32x16_bf16 v[160:175], v[40:43], v[28:31], v[160:175]
    v_mfma_f32_32x32x16_bf16 v[176:191], v[44:47], v[28:31], v[176:191]
    v_mfma_f32_32x32x16_bf16 v[192:207], v[40:43], v[32:35], v[192:207]
    v_mfma_f32_32x32x16_bf16 v[208:223], v[44:47], v[32:35], v[208:223]
    v_mfma_f32_32x32x16_bf16 v[224:239], v[40:43], v[36:39], v[224:239]
    v_mfma_f32_32x32x16_bf16 v[240:255], v[44:47], v[36:39], v[240:255]
    s_waitcnt lgkmcnt(0)
    v_mfma_f32_32x32x16_bf16 v[128:143], v[64:67], v[48:51], v[128:143]
    v_mfma_f32_32x32x16_bf16 v[144:159], v[68:71], v[48:51], v[144:159]
    v_mfma_f32_32x32x16_bf16 v[160:175], v[64:67], v[52:55], v[160:175]
    v_mfma_f32_32x32x16_bf16 v[176:191], v[68:71], v[52:55], v[176:191]
    v_mfma_f32_32x32x16_bf16 v[192:207], v[64:67], v[56:59], v[192:207]
    v_mfma_f32_32x32x16_bf16 v[208:223], v[68:71], v[56:59], v[208:223]
    v_mfma_f32_32x32x16_bf16 v[224:239], v[64:67], v[60:63], v[224:239]
    v_mfma_f32_32x32x16_bf16 v[240:255], v[68:71], v[60:63], v[240:255]
    s_barrier
    ds_read_b128 v[24:27], v8 offset:32768
    ds_read_b128 v[28:31], v8 offset:36864
    ds_read_b128 v[32:35], v8 offset:40960
    ds_read_b128 v[36:39], v8 offset:45056
    ds_read_b64_tr_b16 v[40:41], v12 offset:32768
    ds_read_b64_tr_b16 v[42:43], v12 offset:34816
    ds_read_b64_tr_b16 v[44:45], v13 offset:32768
    ds_read_b64_tr_b16 v[46:47], v13 offset:34816
    ds_read_b128 v[48:51], v9 offset:32768
    ds_read_b128 v[52:55], v9 offset:36864
    ds_read_b128 v[56:59], v9 offset:40960
    ds_read_b128 v[60:63], v9 offset:45056
    ds_read_b64_tr_b16 v[64:65], v12 offset:40960
    ds_read_b64_tr_b16 v[66:67], v12 offset:43008
    ds_read_b64_tr_b16 v[68:69], v13 offset:40960
    ds_read_b64_tr_b16 v[70:71], v13 offset:43008
    s_waitcnt lgkmcnt(8)
    v_mfma_f32_32x32x16_bf16 v[128:143], v[40:43], v[24:27], v[128:143]
    v_mfma_f32_32x32x16_bf16 v[144:159], v[44:47], v[24:27], v[144:159]
    v_mfma_f32_32x32x16_bf16 v[160:175], v[40:43], v[28:31], v[160:175]
    v_mfma_f32_32x32x16_bf16 v[176:191], v[44:47], v[28:31], v[176:191]
    v_mfma_f32_32x32x16_bf16 v[192:207], v[40:43], v[32:35], v[192:207]
    v_mfma_f32_32x32x16_bf16 v[208:223], v[44:47], v[32:35], v[208:223]
    v_mfma_f32_32x32x16_bf16 v[224:239], v[40:43], v[36:39], v[224:239]
    v_mfma_f32_32x32x16_bf16 v[240:255], v[44:47], v[36:39], v[240:255]
    ds_read_b128 v[24:27], v10 offset:32768
    ds_read_b128 v[28:31], v10 offset:36864
    ds_read_b128 v[32:35], v10 offset:40960
    ds_read_b128 v[36:39], v10 offset:45056
    ds_read_b64_tr_b16 v[40:41], v12 offset:49152
    ds_read_b64_tr_b16 v[42:43], v12 offset:51200
    ds_read_b64_tr_b16 v[44:45], v13 offset:49152
    ds_read_b64_tr_b16 v[46:47], v13 offset:51200
    s_waitcnt lgkmcnt(8)
    v_mfma_f32_32x32x16_bf16 v[128:143], v[64:67], v[48:51], v[128:143]
    v_mfma_f32_32x32x16_bf16 v[144:159], v[68:71], v[48:51], v[144:159]
    v_mfma_f32_32x32x16_bf16 v[160:175], v[64:67], v[52:55], v[160:175]
    v_mfma_f32_32x32x16_bf16 v[176:191], v[68:71], v[52:55], v[176:191]
    v_mfma_f32_32x32x16_bf16 v[192:207], v[64:67], v[56:59], v[192:207]
    v_mfma_f32_32x32x16_bf16 v[208:223], v[68:71], v[56:59], v[208:223]
    v_mfma_f32_32x32x16_bf16 v[224:239], v[64:67], v[60:63], v[224:239]
    v_mfma_f32_32x32x16_bf16 v[240:255], v[68:71], v[60:63], v[240:255]
    ds_read_b128 v[48:51], v11 offset:32768
    ds_read_b128 v[52:55], v11 offset:36864
    ds_read_b128 v[56:59], v11 offset:40960
    ds_read_b128 v[60:63], v11 offset:45056
    ds_read_b64_tr_b16 v[64:65], v12 offset:57344
    ds_read_b64_tr_b16 v[66:67], v12 offset:59392
    ds_read_b64_tr_b16 v[68:69], v13 offset:57344
    ds_read_b64_tr_b16 v[70:71], v13 offset:59392
    s_waitcnt lgkmcnt(8)
    v_mfma_f32_32x32x16_bf16 v[128:143], v[40:43], v[24:27], v[128:143]
    v_mfma_f32_32x32x16_bf16 v[144:159], v[44:47], v[24:27], v[144:159]
    v_mfma_f32_32x32x16_bf16 v[160:175], v[40:43], v[28:31], v[160:175]
    v_mfma_f32_32x32x16_bf16 v[176:191], v[44:47], v[28:31], v[176:191]
    v_mfma_f32_32x32x16_bf16 v[192:207], v[40:43], v[32:35], v[192:207]
    v_mfma_f32_32x32x16_bf16 v[208:223], v[44:47], v[32:35], v[208:223]
    v_mfma_f32_32x32x16_bf16 v[224:239], v[40:43], v[36:39], v[224:239]
    v_mfma_f32_32x32x16_bf16 v[240:255], v[44:47], v[36:39], v[240:255]
    s_waitcnt lgkmcnt(0)
    v_mfma_f32_32x32x16_bf16 v[128:143], v[64:67], v[48:51], v[128:143]
    v_mfma_f32_32x32x16_bf16 v[144:159], v[68:71], v[48:51], v[144:159]
    v_mfma_f32_32x32x16_bf16 v[160:175], v[64:67], v[52:55], v[160:175]
    v_mfma_f32_32x32x16_bf16 v[176:191], v[68:71], v[52:55], v[176:191]
    v_mfma_f32_32x32x16_bf16 v[192:207], v[64:67], v[56:59], v[192:207]
    v_mfma_f32_32x32x16_bf16 v[208:223], v[68:71], v[56:59], v[208:223]
    v_mfma_f32_32x32x16_bf16 v[224:239], v[64:67], v[60:63], v[224:239]
    v_mfma_f32_32x32x16_bf16 v[240:255], v[68:71], v[60:63], v[240:255]
    s_barrier
    ds_read_b128 v[24:27], v8 offset:49152
    ds_read_b128 v[28:31], v8 offset:53248
    ds_read_b128 v[32:35], v8 offset:57344
    ds_read_b128 v[36:39], v8 offset:61440
    ds_read_b64_tr_b16 v[40:41], v16 offset:0
    ds_read_b64_tr_b16 v[42:43], v16 offset:2048
    ds_read_b64_tr_b16 v[44:45], v17 offset:0
    ds_read_b64_tr_b16 v[46:47], v17 offset:2048
    ds_read_b128 v[48:51], v9 offset:49152
    ds_read_b128 v[52:55], v9 offset:53248
    ds_read_b128 v[56:59], v9 offset:57344
    ds_read_b128 v[60:63], v9 offset:61440
    ds_read_b64_tr_b16 v[64:65], v16 offset:8192
    ds_read_b64_tr_b16 v[66:67], v16 offset:10240
    ds_read_b64_tr_b16 v[68:69], v17 offset:8192
    ds_read_b64_tr_b16 v[70:71], v17 offset:10240
    s_waitcnt lgkmcnt(8)
    v_mfma_f32_32x32x16_bf16 v[128:143], v[40:43], v[24:27], v[128:143]
    v_mfma_f32_32x32x16_bf16 v[144:159], v[44:47], v[24:27], v[144:159]
    v_mfma_f32_32x32x16_bf16 v[160:175], v[40:43], v[28:31], v[160:175]
    v_mfma_f32_32x32x16_bf16 v[176:191], v[44:47], v[28:31], v[176:191]
    v_mfma_f32_32x32x16_bf16 v[192:207], v[40:43], v[32:35], v[192:207]
    v_mfma_f32_32x32x16_bf16 v[208:223], v[44:47], v[32:35], v[208:223]
    v_mfma_f32_32x32x16_bf16 v[224:239], v[40:43], v[36:39], v[224:239]
    v_mfma_f32_32x32x16_bf16 v[240:255], v[44:47], v[36:39], v[240:255]
    ds_read_b128 v[24:27], v10 offset:49152
    ds_read_b128 v[28:31], v10 offset:53248
    ds_read_b128 v[32:35], v10 offset:57344
    ds_read_b128 v[36:39], v10 offset:61440
    ds_read_b64_tr_b16 v[40:41], v16 offset:16384
    ds_read_b64_tr_b16 v[42:43], v16 offset:18432
    ds_read_b64_tr_b16 v[44:45], v17 offset:16384
    ds_read_b64_tr_b16 v[46:47], v17 offset:18432
    s_waitcnt lgkmcnt(8)
    v_mfma_f32_32x32x16_bf16 v[128:143], v[64:67], v[48:51], v[128:143]
    v_mfma_f32_32x32x16_bf16 v[144:159], v[68:71], v[48:51], v[144:159]
    v_mfma_f32_32x32x16_bf16 v[160:175], v[64:67], v[52:55], v[160:175]
    v_mfma_f32_32x32x16_bf16 v[176:191], v[68:71], v[52:55], v[176:191]
    v_mfma_f32_32x32x16_bf16 v[192:207], v[64:67], v[56:59], v[192:207]
    v_mfma_f32_32x32x16_bf16 v[208:223], v[68:71], v[56:59], v[208:223]
    v_mfma_f32_32x32x16_bf16 v[224:239], v[64:67], v[60:63], v[224:239]
    v_mfma_f32_32x32x16_bf16 v[240:255], v[68:71], v[60:63], v[240:255]
    ds_read_b128 v[48:51], v11 offset:49152
    ds_read_b128 v[52:55], v11 offset:53248
    ds_read_b128 v[56:59], v11 offset:57344
    ds_read_b128 v[60:63], v11 offset:61440
    ds_read_b64_tr_b16 v[64:65], v16 offset:24576
    ds_read_b64_tr_b16 v[66:67], v16 offset:26624
    ds_read_b64_tr_b16 v[68:69], v17 offset:24576
    ds_read_b64_tr_b16 v[70:71], v17 offset:26624
    s_waitcnt lgkmcnt(8)
    v_mfma_f32_32x32x16_bf16 v[128:143], v[40:43], v[24:27], v[128:143]
    v_mfma_f32_32x32x16_bf16 v[144:159], v[44:47], v[24:27], v[144:159]
    v_mfma_f32_32x32x16_bf16 v[160:175], v[40:43], v[28:31], v[160:175]
    v_mfma_f32_32x32x16_bf16 v[176:191], v[44:47], v[28:31], v[176:191]
    v_mfma_f32_32x32x16_bf16 v[192:207], v[40:43], v[32:35], v[192:207]
    v_mfma_f32_32x32x16_bf16 v[208:223], v[44:47], v[32:35], v[208:223]
    v_mfma_f32_32x32x16_bf16 v[224:239], v[40:43], v[36:39], v[224:239]
    v_mfma_f32_32x32x16_bf16 v[240:255], v[44:47], v[36:39], v[240:255]
    s_waitcnt lgkmcnt(0)
    v_mfma_f32_32x32x16_bf16 v[128:143], v[64:67], v[48:51], v[128:143]
    v_mfma_f32_32x32x16_bf16 v[144:159], v[68:71], v[48:51], v[144:159]
    v_mfma_f32_32x32x16_bf16 v[160:175], v[64:67], v[52:55], v[160:175]
    v_mfma_f32_32x32x16_bf16 v[176:191], v[68:71], v[52:55], v[176:191]
    v_mfma_f32_32x32x16_bf16 v[192:207], v[64:67], v[56:59], v[192:207]
    v_mfma_f32_32x32x16_bf16 v[208:223], v[68:71], v[56:59], v[208:223]
    v_mfma_f32_32x32x16_bf16 v[224:239], v[64:67], v[60:63], v[224:239]
    v_mfma_f32_32x32x16_bf16 v[240:255], v[68:71], v[60:63], v[240:255]
    s_barrier
    ds_read_b128 v[24:27], v8 offset:16384
    ds_read_b128 v[28:31], v8 offset:20480
    ds_read_b128 v[32:35], v8 offset:24576
    ds_read_b128 v[36:39], v8 offset:28672
    ds_read_b64_tr_b16 v[40:41], v12 offset:0
    ds_read_b64_tr_b16 v[42:43], v12 offset:2048
    ds_read_b64_tr_b16 v[44:45], v13 offset:0
    ds_read_b64_tr_b16 v[46:47], v13 offset:2048
    ds_read_b128 v[48:51], v9 offset:16384
    ds_read_b128 v[52:55], v9 offset:20480
    ds_read_b128 v[56:59], v9 offset:24576
    ds_read_b128 v[60:63], v9 offset:28672
    ds_read_b64_tr_b16 v[64:65], v12 offset:8192
    ds_read_b64_tr_b16 v[66:67], v12 offset:10240
    ds_read_b64_tr_b16 v[68:69], v13 offset:8192
    ds_read_b64_tr_b16 v[70:71], v13 offset:10240
    s_waitcnt lgkmcnt(8)
    v_mfma_f32_32x32x16_bf16 v[128:143], v[40:43], v[24:27], v[128:143]
    v_mfma_f32_32x32x16_bf16 v[144:159], v[44:47], v[24:27], v[144:159]
    v_mfma_f32_32x32x16_bf16 v[160:175], v[40:43], v[28:31], v[160:175]
    v_mfma_f32_32x32x16_bf16 v[176:191], v[44:47], v[28:31], v[176:191]
    v_mfma_f32_32x32x16_bf16 v[192:207], v[40:43], v[32:35], v[192:207]
    v_mfma_f32_32x32x16_bf16 v[208:223], v[44:47], v[32:35], v[208:223]
    v_mfma_f32_32x32x16_bf16 v[224:239], v[40:43], v[36:39], v[224:239]
    v_mfma_f32_32x32x16_bf16 v[240:255], v[44:47], v[36:39], v[240:255]
    ds_read_b128 v[24:27], v10 offset:16384
    ds_read_b128 v[28:31], v10 offset:20480
    ds_read_b128 v[32:35], v10 offset:24576
    ds_read_b128 v[36:39], v10 offset:28672
    ds_read_b64_tr_b16 v[40:41], v12 offset:16384
    ds_read_b64_tr_b16 v[42:43], v12 offset:18432
    ds_read_b64_tr_b16 v[44:45], v13 offset:16384
    ds_read_b64_tr_b16 v[46:47], v13 offset:18432
    s_waitcnt lgkmcnt(8)
    v_mfma_f32_32x32x16_bf16 v[128:143], v[64:67], v[48:51], v[128:143]
    v_mfma_f32_32x32x16_bf16 v[144:159], v[68:71], v[48:51], v[144:159]
    v_mfma_f32_32x32x16_bf16 v[160:175], v[64:67], v[52:55], v[160:175]
    v_mfma_f32_32x32x16_bf16 v[176:191], v[68:71], v[52:55], v[176:191]
    v_mfma_f32_32x32x16_bf16 v[192:207], v[64:67], v[56:59], v[192:207]
    v_mfma_f32_32x32x16_bf16 v[208:223], v[68:71], v[56:59], v[208:223]
    v_mfma_f32_32x32x16_bf16 v[224:239], v[64:67], v[60:63], v[224:239]
    v_mfma_f32_32x32x16_bf16 v[240:255], v[68:71], v[60:63], v[240:255]
    ds_read_b128 v[48:51], v11 offset:16384
    ds_read_b128 v[52:55], v11 offset:20480
    ds_read_b128 v[56:59], v11 offset:24576
    ds_read_b128 v[60:63], v11 offset:28672
    ds_read_b64_tr_b16 v[64:65], v12 offset:24576
    ds_read_b64_tr_b16 v[66:67], v12 offset:26624
    ds_read_b64_tr_b16 v[68:69], v13 offset:24576
    ds_read_b64_tr_b16 v[70:71], v13 offset:26624
    s_waitcnt lgkmcnt(8)
    v_mfma_f32_32x32x16_bf16 v[128:143], v[40:43], v[24:27], v[128:143]
    v_mfma_f32_32x32x16_bf16 v[144:159], v[44:47], v[24:27], v[144:159]
    v_mfma_f32_32x32x16_bf16 v[160:175], v[40:43], v[28:31], v[160:175]
    v_mfma_f32_32x32x16_bf16 v[176:191], v[44:47], v[28:31], v[176:191]
    v_mfma_f32_32x32x16_bf16 v[192:207], v[40:43], v[32:35], v[192:207]
    v_mfma_f32_32x32x16_bf16 v[208:223], v[44:47], v[32:35], v[208:223]
    v_mfma_f32_32x32x16_bf16 v[224:239], v[40:43], v[36:39], v[224:239]
    v_mfma_f32_32x32x16_bf16 v[240:255], v[44:47], v[36:39], v[240:255]
    s_waitcnt lgkmcnt(0)
    v_mfma_f32_32x32x16_bf16 v[128:143], v[64:67], v[48:51], v[128:143]
    v_mfma_f32_32x32x16_bf16 v[144:159], v[68:71], v[48:51], v[144:159]
    v_mfma_f32_32x32x16_bf16 v[160:175], v[64:67], v[52:55], v[160:175]
    v_mfma_f32_32x32x16_bf16 v[176:191], v[68:71], v[52:55], v[176:191]
    v_mfma_f32_32x32x16_bf16 v[192:207], v[64:67], v[56:59], v[192:207]
    v_mfma_f32_32x32x16_bf16 v[208:223], v[68:71], v[56:59], v[208:223]
    v_mfma_f32_32x32x16_bf16 v[224:239], v[64:67], v[60:63], v[224:239]
    v_mfma_f32_32x32x16_bf16 v[240:255], v[68:71], v[60:63], v[240:255]
    s_barrier
    ds_read_b128 v[24:27], v8 offset:32768
    ds_read_b128 v[28:31], v8 offset:36864
    ds_read_b128 v[32:35], v8 offset:40960
    ds_read_b128 v[36:39], v8 offset:45056
    ds_read_b64_tr_b16 v[40:41], v12 offset:32768
    ds_read_b64_tr_b16 v[42:43], v12 offset:34816
    ds_read_b64_tr_b16 v[44:45], v13 offset:32768
    ds_read_b64_tr_b16 v[46:47], v13 offset:34816
    ds_read_b128 v[48:51], v9 offset:32768
    ds_read_b128 v[52:55], v9 offset:36864
    ds_read_b128 v[56:59], v9 offset:40960
    ds_read_b128 v[60:63], v9 offset:45056
    ds_read_b64_tr_b16 v[64:65], v12 offset:40960
    ds_read_b64_tr_b16 v[66:67], v12 offset:43008
    ds_read_b64_tr_b16 v[68:69], v13 offset:40960
    ds_read_b64_tr_b16 v[70:71], v13 offset:43008
    s_waitcnt lgkmcnt(8)
    v_mfma_f32_32x32x16_bf16 v[128:143], v[40:43], v[24:27], v[128:143]
    v_mfma_f32_32x32x16_bf16 v[144:159], v[44:47], v[24:27], v[144:159]
    v_mfma_f32_32x32x16_bf16 v[160:175], v[40:43], v[28:31], v[160:175]
    v_mfma_f32_32x32x16_bf16 v[176:191], v[44:47], v[28:31], v[176:191]
    v_mfma_f32_32x32x16_bf16 v[192:207], v[40:43], v[32:35], v[192:207]
    v_mfma_f32_32x32x16_bf16 v[208:223], v[44:47], v[32:35], v[208:223]
    v_mfma_f32_32x32x16_bf16 v[224:239], v[40:43], v[36:39], v[224:239]
    v_mfma_f32_32x32x16_bf16 v[240:255], v[44:47], v[36:39], v[240:255]
    ds_read_b128 v[24:27], v10 offset:32768
    ds_read_b128 v[28:31], v10 offset:36864
    ds_read_b128 v[32:35], v10 offset:40960
    ds_read_b128 v[36:39], v10 offset:45056
    ds_read_b64_tr_b16 v[40:41], v12 offset:49152
    ds_read_b64_tr_b16 v[42:43], v12 offset:51200
    ds_read_b64_tr_b16 v[44:45], v13 offset:49152
    ds_read_b64_tr_b16 v[46:47], v13 offset:51200
    s_waitcnt lgkmcnt(8)
    v_mfma_f32_32x32x16_bf16 v[128:143], v[64:67], v[48:51], v[128:143]
    v_mfma_f32_32x32x16_bf16 v[144:159], v[68:71], v[48:51], v[144:159]
    v_mfma_f32_32x32x16_bf16 v[160:175], v[64:67], v[52:55], v[160:175]
    v_mfma_f32_32x32x16_bf16 v[176:191], v[68:71], v[52:55], v[176:191]
    v_mfma_f32_32x32x16_bf16 v[192:207], v[64:67], v[56:59], v[192:207]
    v_mfma_f32_32x32x16_bf16 v[208:223], v[68:71], v[56:59], v[208:223]
    v_mfma_f32_32x32x16_bf16 v[224:239], v[64:67], v[60:63], v[224:239]
    v_mfma_f32_32x32x16_bf16 v[240:255], v[68:71], v[60:63], v[240:255]
    ds_read_b128 v[48:51], v11 offset:32768
    ds_read_b128 v[52:55], v11 offset:36864
    ds_read_b128 v[56:59], v11 offset:40960
    ds_read_b128 v[60:63], v11 offset:45056
    ds_read_b64_tr_b16 v[64:65], v12 offset:57344
    ds_read_b64_tr_b16 v[66:67], v12 offset:59392
    ds_read_b64_tr_b16 v[68:69], v13 offset:57344
    ds_read_b64_tr_b16 v[70:71], v13 offset:59392
    s_waitcnt lgkmcnt(8)
    v_mfma_f32_32x32x16_bf16 v[128:143], v[40:43], v[24:27], v[128:143]
    v_mfma_f32_32x32x16_bf16 v[144:159], v[44:47], v[24:27], v[144:159]
    v_mfma_f32_32x32x16_bf16 v[160:175], v[40:43], v[28:31], v[160:175]
    v_mfma_f32_32x32x16_bf16 v[176:191], v[44:47], v[28:31], v[176:191]
    v_mfma_f32_32x32x16_bf16 v[192:207], v[40:43], v[32:35], v[192:207]
    v_mfma_f32_32x32x16_bf16 v[208:223], v[44:47], v[32:35], v[208:223]
    v_mfma_f32_32x32x16_bf16 v[224:239], v[40:43], v[36:39], v[224:239]
    v_mfma_f32_32x32x16_bf16 v[240:255], v[44:47], v[36:39], v[240:255]
    s_waitcnt lgkmcnt(0)
    v_mfma_f32_32x32x16_bf16 v[128:143], v[64:67], v[48:51], v[128:143]
    v_mfma_f32_32x32x16_bf16 v[144:159], v[68:71], v[48:51], v[144:159]
    v_mfma_f32_32x32x16_bf16 v[160:175], v[64:67], v[52:55], v[160:175]
    v_mfma_f32_32x32x16_bf16 v[176:191], v[68:71], v[52:55], v[176:191]
    v_mfma_f32_32x32x16_bf16 v[192:207], v[64:67], v[56:59], v[192:207]
    v_mfma_f32_32x32x16_bf16 v[208:223], v[68:71], v[56:59], v[208:223]
    v_mfma_f32_32x32x16_bf16 v[224:239], v[64:67], v[60:63], v[224:239]
    v_mfma_f32_32x32x16_bf16 v[240:255], v[68:71], v[60:63], v[240:255]
    s_barrier
    ds_read_b128 v[24:27], v8 offset:49152
    ds_read_b128 v[28:31], v8 offset:53248
    ds_read_b128 v[32:35], v8 offset:57344
    ds_read_b128 v[36:39], v8 offset:61440
    ds_read_b64_tr_b16 v[40:41], v16 offset:0
    ds_read_b64_tr_b16 v[42:43], v16 offset:2048
    ds_read_b64_tr_b16 v[44:45], v17 offset:0
    ds_read_b64_tr_b16 v[46:47], v17 offset:2048
    ds_read_b128 v[48:51], v9 offset:49152
    ds_read_b128 v[52:55], v9 offset:53248
    ds_read_b128 v[56:59], v9 offset:57344
    ds_read_b128 v[60:63], v9 offset:61440
    ds_read_b64_tr_b16 v[64:65], v16 offset:8192
    ds_read_b64_tr_b16 v[66:67], v16 offset:10240
    ds_read_b64_tr_b16 v[68:69], v17 offset:8192
    ds_read_b64_tr_b16 v[70:71], v17 offset:10240
    s_waitcnt lgkmcnt(8)
    v_mfma_f32_32x32x16_bf16 v[128:143], v[40:43], v[24:27], v[128:143]
    v_mfma_f32_32x32x16_bf16 v[144:159], v[44:47], v[24:27], v[144:159]
    v_mfma_f32_32x32x16_bf16 v[160:175], v[40:43], v[28:31], v[160:175]
    v_mfma_f32_32x32x16_bf16 v[176:191], v[44:47], v[28:31], v[176:191]
    v_mfma_f32_32x32x16_bf16 v[192:207], v[40:43], v[32:35], v[192:207]
    v_mfma_f32_32x32x16_bf16 v[208:223], v[44:47], v[32:35], v[208:223]
    v_mfma_f32_32x32x16_bf16 v[224:239], v[40:43], v[36:39], v[224:239]
    v_mfma_f32_32x32x16_bf16 v[240:255], v[44:47], v[36:39], v[240:255]
    ds_read_b128 v[24:27], v10 offset:49152
    ds_read_b128 v[28:31], v10 offset:53248
    ds_read_b128 v[32:35], v10 offset:57344
    ds_read_b128 v[36:39], v10 offset:61440
    ds_read_b64_tr_b16 v[40:41], v16 offset:16384
    ds_read_b64_tr_b16 v[42:43], v16 offset:18432
    ds_read_b64_tr_b16 v[44:45], v17 offset:16384
    ds_read_b64_tr_b16 v[46:47], v17 offset:18432
    s_waitcnt lgkmcnt(8)
    v_mfma_f32_32x32x16_bf16 v[128:143], v[64:67], v[48:51], v[128:143]
    v_mfma_f32_32x32x16_bf16 v[144:159], v[68:71], v[48:51], v[144:159]
    v_mfma_f32_32x32x16_bf16 v[160:175], v[64:67], v[52:55], v[160:175]
    v_mfma_f32_32x32x16_bf16 v[176:191], v[68:71], v[52:55], v[176:191]
    v_mfma_f32_32x32x16_bf16 v[192:207], v[64:67], v[56:59], v[192:207]
    v_mfma_f32_32x32x16_bf16 v[208:223], v[68:71], v[56:59], v[208:223]
    v_mfma_f32_32x32x16_bf16 v[224:239], v[64:67], v[60:63], v[224:239]
    v_mfma_f32_32x32x16_bf16 v[240:255], v[68:71], v[60:63], v[240:255]
    ds_read_b128 v[48:51], v11 offset:49152
    ds_read_b128 v[52:55], v11 offset:53248
    ds_read_b128 v[56:59], v11 offset:57344
    ds_read_b128 v[60:63], v11 offset:61440
    ds_read_b64_tr_b16 v[64:65], v16 offset:24576
    ds_read_b64_tr_b16 v[66:67], v16 offset:26624
    ds_read_b64_tr_b16 v[68:69], v17 offset:24576
    ds_read_b64_tr_b16 v[70:71], v17 offset:26624
    s_waitcnt lgkmcnt(8)
    v_mfma_f32_32x32x16_bf16 v[128:143], v[40:43], v[24:27], v[128:143]
    v_mfma_f32_32x32x16_bf16 v[144:159], v[44:47], v[24:27], v[144:159]
    v_mfma_f32_32x32x16_bf16 v[160:175], v[40:43], v[28:31], v[160:175]
    v_mfma_f32_32x32x16_bf16 v[176:191], v[44:47], v[28:31], v[176:191]
    v_mfma_f32_32x32x16_bf16 v[192:207], v[40:43], v[32:35], v[192:207]
    v_mfma_f32_32x32x16_bf16 v[208:223], v[44:47], v[32:35], v[208:223]
    v_mfma_f32_32x32x16_bf16 v[224:239], v[40:43], v[36:39], v[224:239]
    v_mfma_f32_32x32x16_bf16 v[240:255], v[44:47], v[36:39], v[240:255]
    s_waitcnt lgkmcnt(0)
    v_mfma_f32_32x32x16_bf16 v[128:143], v[64:67], v[48:51], v[128:143]
    v_mfma_f32_32x32x16_bf16 v[144:159], v[68:71], v[48:51], v[144:159]
    v_mfma_f32_32x32x16_bf16 v[160:175], v[64:67], v[52:55], v[160:175]
    v_mfma_f32_32x32x16_bf16 v[176:191], v[68:71], v[52:55], v[176:191]
    v_mfma_f32_32x32x16_bf16 v[192:207], v[64:67], v[56:59], v[192:207]
    v_mfma_f32_32x32x16_bf16 v[208:223], v[68:71], v[56:59], v[208:223]
    v_mfma_f32_32x32x16_bf16 v[224:239], v[64:67], v[60:63], v[224:239]
    v_mfma_f32_32x32x16_bf16 v[240:255], v[68:71], v[60:63], v[240:255]
    s_barrier
    ds_read_b128 v[24:27], v8 offset:16384
    ds_read_b128 v[28:31], v8 offset:20480
    ds_read_b128 v[32:35], v8 offset:24576
    ds_read_b128 v[36:39], v8 offset:28672
    ds_read_b64_tr_b16 v[40:41], v12 offset:0
    ds_read_b64_tr_b16 v[42:43], v12 offset:2048
    ds_read_b64_tr_b16 v[44:45], v13 offset:0
    ds_read_b64_tr_b16 v[46:47], v13 offset:2048
    ds_read_b128 v[48:51], v9 offset:16384
    ds_read_b128 v[52:55], v9 offset:20480
    ds_read_b128 v[56:59], v9 offset:24576
    ds_read_b128 v[60:63], v9 offset:28672
    ds_read_b64_tr_b16 v[64:65], v12 offset:8192
    ds_read_b64_tr_b16 v[66:67], v12 offset:10240
    ds_read_b64_tr_b16 v[68:69], v13 offset:8192
    ds_read_b64_tr_b16 v[70:71], v13 offset:10240
    s_waitcnt lgkmcnt(8)
    v_mfma_f32_32x32x16_bf16 v[128:143], v[40:43], v[24:27], v[128:143]
    v_mfma_f32_32x32x16_bf16 v[144:159], v[44:47], v[24:27], v[144:159]
    v_mfma_f32_32x32x16_bf16 v[160:175], v[40:43], v[28:31], v[160:175]
    v_mfma_f32_32x32x16_bf16 v[176:191], v[44:47], v[28:31], v[176:191]
    v_mfma_f32_32x32x16_bf16 v[192:207], v[40:43], v[32:35], v[192:207]
    v_mfma_f32_32x32x16_bf16 v[208:223], v[44:47], v[32:35], v[208:223]
    v_mfma_f32_32x32x16_bf16 v[224:239], v[40:43], v[36:39], v[224:239]
    v_mfma_f32_32x32x16_bf16 v[240:255], v[44:47], v[36:39], v[240:255]
    ds_read_b128 v[24:27], v10 offset:16384
    ds_read_b128 v[28:31], v10 offset:20480
    ds_read_b128 v[32:35], v10 offset:24576
    ds_read_b128 v[36:39], v10 offset:28672
    ds_read_b64_tr_b16 v[40:41], v12 offset:16384
    ds_read_b64_tr_b16 v[42:43], v12 offset:18432
    ds_read_b64_tr_b16 v[44:45], v13 offset:16384
    ds_read_b64_tr_b16 v[46:47], v13 offset:18432
    s_waitcnt lgkmcnt(8)
    v_mfma_f32_32x32x16_bf16 v[128:143], v[64:67], v[48:51], v[128:143]
    v_mfma_f32_32x32x16_bf16 v[144:159], v[68:71], v[48:51], v[144:159]
    v_mfma_f32_32x32x16_bf16 v[160:175], v[64:67], v[52:55], v[160:175]
    v_mfma_f32_32x32x16_bf16 v[176:191], v[68:71], v[52:55], v[176:191]
    v_mfma_f32_32x32x16_bf16 v[192:207], v[64:67], v[56:59], v[192:207]
    v_mfma_f32_32x32x16_bf16 v[208:223], v[68:71], v[56:59], v[208:223]
    v_mfma_f32_32x32x16_bf16 v[224:239], v[64:67], v[60:63], v[224:239]
    v_mfma_f32_32x32x16_bf16 v[240:255], v[68:71], v[60:63], v[240:255]
    ds_read_b128 v[48:51], v11 offset:16384
    ds_read_b128 v[52:55], v11 offset:20480
    ds_read_b128 v[56:59], v11 offset:24576
    ds_read_b128 v[60:63], v11 offset:28672
    ds_read_b64_tr_b16 v[64:65], v12 offset:24576
    ds_read_b64_tr_b16 v[66:67], v12 offset:26624
    ds_read_b64_tr_b16 v[68:69], v13 offset:24576
    ds_read_b64_tr_b16 v[70:71], v13 offset:26624
    s_waitcnt lgkmcnt(8)
    v_mfma_f32_32x32x16_bf16 v[128:143], v[40:43], v[24:27], v[128:143]
    v_mfma_f32_32x32x16_bf16 v[144:159], v[44:47], v[24:27], v[144:159]
    v_mfma_f32_32x32x16_bf16 v[160:175], v[40:43], v[28:31], v[160:175]
    v_mfma_f32_32x32x16_bf16 v[176:191], v[44:47], v[28:31], v[176:191]
    v_mfma_f32_32x32x16_bf16 v[192:207], v[40:43], v[32:35], v[192:207]
    v_mfma_f32_32x32x16_bf16 v[208:223], v[44:47], v[32:35], v[208:223]
    v_mfma_f32_32x32x16_bf16 v[224:239], v[40:43], v[36:39], v[224:239]
    v_mfma_f32_32x32x16_bf16 v[240:255], v[44:47], v[36:39], v[240:255]
    s_waitcnt lgkmcnt(0)
    v_mfma_f32_32x32x16_bf16 v[128:143], v[64:67], v[48:51], v[128:143]
    v_mfma_f32_32x32x16_bf16 v[144:159], v[68:71], v[48:51], v[144:159]
    v_mfma_f32_32x32x16_bf16 v[160:175], v[64:67], v[52:55], v[160:175]
    v_mfma_f32_32x32x16_bf16 v[176:191], v[68:71], v[52:55], v[176:191]
    v_mfma_f32_32x32x16_bf16 v[192:207], v[64:67], v[56:59], v[192:207]
    v_mfma_f32_32x32x16_bf16 v[208:223], v[68:71], v[56:59], v[208:223]
    v_mfma_f32_32x32x16_bf16 v[224:239], v[64:67], v[60:63], v[224:239]
    v_mfma_f32_32x32x16_bf16 v[240:255], v[68:71], v[60:63], v[240:255]
    v_lshlrev_b32 v2, 4, v1
    s_lshl_b32 s30, s3, 14
    s_add_u32 s30, s30, 98304
    v_add_u32 v2, s30, v2
    s_nop 7
    ds_write_b128 v2, v[192:195] offset:0
    ds_write_b128 v2, v[196:199] offset:1024
    ds_write_b128 v2, v[200:203] offset:2048
    ds_write_b128 v2, v[204:207] offset:3072
    ds_write_b128 v2, v[208:211] offset:4096
    ds_write_b128 v2, v[212:215] offset:5120
    ds_write_b128 v2, v[216:219] offset:6144
    ds_write_b128 v2, v[220:223] offset:7168
    ds_write_b128 v2, v[224:227] offset:8192
    ds_write_b128 v2, v[228:231] offset:9216
    ds_write_b128 v2, v[232:235] offset:10240
    ds_write_b128 v2, v[236:239] offset:11264
    ds_write_b128 v2, v[240:243] offset:12288
    ds_write_b128 v2, v[244:247] offset:13312
    ds_write_b128 v2, v[248:251] offset:14336
    ds_write_b128 v2, v[252:255] offset:15360
    s_waitcnt vmcnt(0) lgkmcnt(0)
    s_barrier
    v_lshlrev_b32 v24, 16, v96
    v_and_b32 v25, 0xffff0000, v96
    v_lshlrev_b32 v26, 16, v97
    v_and_b32 v27, 0xffff0000, v97
    v_lshlrev_b32 v28, 16, v98
    v_and_b32 v29, 0xffff0000, v98
    v_lshlrev_b32 v30, 16, v99
    v_and_b32 v31, 0xffff0000, v99
    v_lshlrev_b32 v32, 16, v100
    v_and_b32 v33, 0xffff0000, v100
    v_lshlrev_b32 v34, 16, v101
    v_and_b32 v35, 0xffff0000, v101
    v_lshlrev_b32 v36, 16, v102
    v_and_b32 v37, 0xffff0000, v102
    v_lshlrev_b32 v38, 16, v103
    v_and_b32 v39, 0xffff0000, v103
    v_lshlrev_b32 v40, 16, v104
    v_and_b32 v41, 0xffff0000, v104
    v_lshlrev_b32 v42, 16, v105
    v_and_b32 v43, 0xffff0000, v105
    v_lshlrev_b32 v44, 16, v106
    v_and_b32 v45, 0xffff0000, v106
    v_lshlrev_b32 v46, 16, v107
    v_and_b32 v47, 0xffff0000, v107
    v_lshlrev_b32 v48, 16, v108
    v_and_b32 v49, 0xffff0000, v108
    v_lshlrev_b32 v50, 16, v109
    v_and_b32 v51, 0xffff0000, v109
    v_lshlrev_b32 v52, 16, v110
    v_and_b32 v53, 0xffff0000, v110
    v_lshlrev_b32 v54, 16, v111
    v_and_b32 v55, 0xffff0000, v111
    v_bfe_u32 v74, v1, 4, 1
    v_lshlrev_b32 v74, 10, v74
    v_and_b32 v75, 15, v1
    v_lshl_add_u32 v74, v75, 4, v74
    v_lshl_add_u32 v74, v72, 8, v74
    s_mul_i32 s31, s24, 393216
    s_lshl_b32 s30, s42, 7
    s_add_u32 s31, s31, s30
    s_mov_b32 s37, 1962964224
    v_mov_b32 v75, 0
    v_cvt_pk_bf16_f32 v112, v128, v129
    v_lshlrev_b32 v128, 16, v112
    v_and_b32 v129, 0xffff0000, v112
    v_pk_add_f32 v[128:129], v[128:129], v[24:25]
    v_cvt_pk_bf16_f32 v112, v128, v129
    v_lshlrev_b32 v128, 16, v112
    v_and_b32 v129, 0xffff0000, v112
    v_pk_lshlrev_b16 v113, 1, v112 op_sel_hi:[0,1]
    v_pk_lshrrev_b16 v112, 15, v112 op_sel_hi:[0,1]
    v_or_b32 v112, v112, v113
    v_pk_sub_u16 v112, v112, s37 clamp
    v_pk_max_u16 v75, v75, v112
    v_lshlrev_b32_sdwa v113, 2, v112 dst_sel:DWORD dst_unused:UNUSED_PAD src0_sel:DWORD src1_sel:WORD_1
    v_lshlrev_b32_sdwa v112, 2, v112 dst_sel:DWORD dst_unused:UNUSED_PAD src0_sel:DWORD src1_sel:WORD_0
    ds_read_b32 v96, v112 offset:0
    ds_read_b32 v97, v113 offset:0
    v_cvt_pk_bf16_f32 v114, v130, v131
    v_lshlrev_b32 v130, 16, v114
    v_and_b32 v131, 0xffff0000, v114
    v_pk_add_f32 v[130:131], v[130:131], v[26:27]
    v_cvt_pk_bf16_f32 v114, v130, v131
    v_lshlrev_b32 v130, 16, v114
    v_and_b32 v131, 0xffff0000, v114
    v_pk_lshlrev_b16 v115, 1, v114 op_sel_hi:[0,1]
    v_pk_lshrrev_b16 v114, 15, v114 op_sel_hi:[0,1]
    v_or_b32 v114, v114, v115
    v_pk_sub_u16 v114, v114, s37 clamp
    v_pk_max_u16 v75, v75, v114
    v_lshlrev_b32_sdwa v115, 2, v114 dst_sel:DWORD dst_unused:UNUSED_PAD src0_sel:DWORD src1_sel:WORD_1
    v_lshlrev_b32_sdwa v114, 2, v114 dst_sel:DWORD dst_unused:UNUSED_PAD src0_sel:DWORD src1_sel:WORD_0
    ds_read_b32 v98, v114 offset:0
    ds_read_b32 v99, v115 offset:0
    v_cvt_pk_bf16_f32 v116, v132, v133
    v_lshlrev_b32 v132, 16, v116
    v_and_b32 v133, 0xffff0000, v116
    v_pk_add_f32 v[132:133], v[132:133], v[28:29]
    v_cvt_pk_bf16_f32 v116, v132, v133
    v_lshlrev_b32 v132, 16, v116
    v_and_b32 v133, 0xffff0000, v116
    v_pk_lshlrev_b16 v117, 1, v116 op_sel_hi:[0,1]
    v_pk_lshrrev_b16 v116, 15, v116 op_sel_hi:[0,1]
    v_or_b32 v116, v116, v117
    v_pk_sub_u16 v116, v116, s37 clamp
    v_pk_max_u16 v75, v75, v116
    v_lshlrev_b32_sdwa v117, 2, v116 dst_sel:DWORD dst_unused:UNUSED_PAD src0_sel:DWORD src1_sel:WORD_1
    v_lshlrev_b32_sdwa v116, 2, v116 dst_sel:DWORD dst_unused:UNUSED_PAD src0_sel:DWORD src1_sel:WORD_0
    ds_read_b32 v100, v116 offset:0
    ds_read_b32 v101, v117 offset:0
    v_cvt_pk_bf16_f32 v118, v134, v135
    v_lshlrev_b32 v134, 16, v118
    v_and_b32 v135, 0xffff0000, v118
    v_pk_add_f32 v[134:135], v[134:135], v[30:31]
    v_cvt_pk_bf16_f32 v118, v134, v135
    v_lshlrev_b32 v134, 16, v118
    v_and_b32 v135, 0xffff0000, v118
    v_pk_lshlrev_b16 v119, 1, v118 op_sel_hi:[0,1]
    v_pk_lshrrev_b16 v118, 15, v118 op_sel_hi:[0,1]
    v_or_b32 v118, v118, v119
    v_pk_sub_u16 v118, v118, s37 clamp
    v_pk_max_u16 v75, v75, v118
    v_lshlrev_b32_sdwa v119, 2, v118 dst_sel:DWORD dst_unused:UNUSED_PAD src0_sel:DWORD src1_sel:WORD_1
    v_lshlrev_b32_sdwa v118, 2, v118 dst_sel:DWORD dst_unused:UNUSED_PAD src0_sel:DWORD src1_sel:WORD_0
    ds_read_b32 v102, v118 offset:0
    ds_read_b32 v103, v119 offset:0
    v_cvt_pk_bf16_f32 v112, v136, v137
    v_lshlrev_b32 v136, 16, v112
    v_and_b32 v137, 0xffff0000, v112
    v_pk_add_f32 v[136:137], v[136:137], v[32:33]
    v_cvt_pk_bf16_f32 v112, v136, v137
    v_lshlrev_b32 v136, 16, v112
    v_and_b32 v137, 0xffff0000, v112
    v_pk_lshlrev_b16 v113, 1, v112 op_sel_hi:[0,1]
    v_pk_lshrrev_b16 v112, 15, v112 op_sel_hi:[0,1]
    v_or_b32 v112, v112, v113
    v_pk_sub_u16 v112, v112, s37 clamp
    v_pk_max_u16 v75, v75, v112
    v_lshlrev_b32_sdwa v113, 2, v112 dst_sel:DWORD dst_unused:UNUSED_PAD src0_sel:DWORD src1_sel:WORD_1
    v_lshlrev_b32_sdwa v112, 2, v112 dst_sel:DWORD dst_unused:UNUSED_PAD src0_sel:DWORD src1_sel:WORD_0
    ds_read_b32 v104, v112 offset:0
    ds_read_b32 v105, v113 offset:0
    v_cvt_pk_bf16_f32 v114, v138, v139
    v_lshlrev_b32 v138, 16, v114
    v_and_b32 v139, 0xffff0000, v114
    v_pk_add_f32 v[138:139], v[138:139], v[34:35]
    v_cvt_pk_bf16_f32 v114, v138, v139
    v_lshlrev_b32 v138, 16, v114
    v_and_b32 v139, 0xffff0000, v114
    v_pk_lshlrev_b16 v115, 1, v114 op_sel_hi:[0,1]
    v_pk_lshrrev_b16 v114, 15, v114 op_sel_hi:[0,1]
    v_or_b32 v114, v114, v115
    v_pk_sub_u16 v114, v114, s37 clamp
    v_pk_max_u16 v75, v75, v114
    v_lshlrev_b32_sdwa v115, 2, v114 dst_sel:DWORD dst_unused:UNUSED_PAD src0_sel:DWORD src1_sel:WORD_1
    v_lshlrev_b32_sdwa v114, 2, v114 dst_sel:DWORD dst_unused:UNUSED_PAD src0_sel:DWORD src1_sel:WORD_0
    ds_read_b32 v106, v114 offset:0
    ds_read_b32 v107, v115 offset:0
    v_cvt_pk_bf16_f32 v116, v140, v141
    v_lshlrev_b32 v140, 16, v116
    v_and_b32 v141, 0xffff0000, v116
    v_pk_add_f32 v[140:141], v[140:141], v[36:37]
    v_cvt_pk_bf16_f32 v116, v140, v141
    v_lshlrev_b32 v140, 16, v116
    v_and_b32 v141, 0xffff0000, v116
    v_pk_lshlrev_b16 v117, 1, v116 op_sel_hi:[0,1]
    v_pk_lshrrev_b16 v116, 15, v116 op_sel_hi:[0,1]
    v_or_b32 v116, v116, v117
    v_pk_sub_u16 v116, v116, s37 clamp
    v_pk_max_u16 v75, v75, v116
    v_lshlrev_b32_sdwa v117, 2, v116 dst_sel:DWORD dst_unused:UNUSED_PAD src0_sel:DWORD src1_sel:WORD_1
    v_lshlrev_b32_sdwa v116, 2, v116 dst_sel:DWORD dst_unused:UNUSED_PAD src0_sel:DWORD src1_sel:WORD_0
    ds_read_b32 v108, v116 offset:0
    ds_read_b32 v109, v117 offset:0
    v_cvt_pk_bf16_f32 v118, v142, v143
    v_lshlrev_b32 v142, 16, v118
    v_and_b32 v143, 0xffff0000, v118
    v_pk_add_f32 v[142:143], v[142:143], v[38:39]
    v_cvt_pk_bf16_f32 v118, v142, v143
    v_lshlrev_b32 v142, 16, v118
    v_and_b32 v143, 0xffff0000, v118
    v_pk_lshlrev_b16 v119, 1, v118 op_sel_hi:[0,1]
    v_pk_lshrrev_b16 v118, 15, v118 op_sel_hi:[0,1]
    v_or_b32 v118, v118, v119
    v_pk_sub_u16 v118, v118, s37 clamp
    v_pk_max_u16 v75, v75, v118
    v_lshlrev_b32_sdwa v119, 2, v118 dst_sel:DWORD dst_unused:UNUSED_PAD src0_sel:DWORD src1_sel:WORD_1
    v_lshlrev_b32_sdwa v118, 2, v118 dst_sel:DWORD dst_unused:UNUSED_PAD src0_sel:DWORD src1_sel:WORD_0
    ds_read_b32 v110, v118 offset:0
    ds_read_b32 v111, v119 offset:0
    s_waitcnt lgkmcnt(8)
    v_pk_mul_f32 v[96:97], v[96:97], v[128:129]
    v_cvt_pk_bf16_f32 v64, v96, v97
    v_pk_mul_f32 v[98:99], v[98:99], v[130:131]
    v_cvt_pk_bf16_f32 v65, v98, v99
    v_pk_mul_f32 v[100:101], v[100:101], v[132:133]
    v_cvt_pk_bf16_f32 v66, v100, v101
    v_pk_mul_f32 v[102:103], v[102:103], v[134:135]
    v_cvt_pk_bf16_f32 v67, v102, v103
    s_add_u32 s30, s31, 0
    buffer_store_dwordx4 v[64:67], v74, s[20:23], s30 offen sc1
    v_cvt_pk_bf16_f32 v112, v144, v145
    v_lshlrev_b32 v144, 16, v112
    v_and_b32 v145, 0xffff0000, v112
    v_pk_add_f32 v[144:145], v[144:145], v[40:41]
    v_cvt_pk_bf16_f32 v112, v144, v145
    v_lshlrev_b32 v144, 16, v112
    v_and_b32 v145, 0xffff0000, v112
    v_pk_lshlrev_b16 v113, 1, v112 op_sel_hi:[0,1]
    v_pk_lshrrev_b16 v112, 15, v112 op_sel_hi:[0,1]
    v_or_b32 v112, v112, v113
    v_pk_sub_u16 v112, v112, s37 clamp
    v_pk_max_u16 v75, v75, v112
    v_lshlrev_b32_sdwa v113, 2, v112 dst_sel:DWORD dst_unused:UNUSED_PAD src0_sel:DWORD src1_sel:WORD_1
    v_lshlrev_b32_sdwa v112, 2, v112 dst_sel:DWORD dst_unused:UNUSED_PAD src0_sel:DWORD src1_sel:WORD_0
    ds_read_b32 v96, v112 offset:0
    ds_read_b32 v97, v113 offset:0
    v_cvt_pk_bf16_f32 v114, v146, v147
    v_lshlrev_b32 v146, 16, v114
    v_and_b32 v147, 0xffff0000, v114
    v_pk_add_f32 v[146:147], v[146:147], v[42:43]
    v_cvt_pk_bf16_f32 v114, v146, v147
    v_lshlrev_b32 v146, 16, v114
    v_and_b32 v147, 0xffff0000, v114
    v_pk_lshlrev_b16 v115, 1, v114 op_sel_hi:[0,1]
    v_pk_lshrrev_b16 v114, 15, v114 op_sel_hi:[0,1]
    v_or_b32 v114, v114, v115
    v_pk_sub_u16 v114, v114, s37 clamp
    v_pk_max_u16 v75, v75, v114
    v_lshlrev_b32_sdwa v115, 2, v114 dst_sel:DWORD dst_unused:UNUSED_PAD src0_sel:DWORD src1_sel:WORD_1
    v_lshlrev_b32_sdwa v114, 2, v114 dst_sel:DWORD dst_unused:UNUSED_PAD src0_sel:DWORD src1_sel:WORD_0
    ds_read_b32 v98, v114 offset:0
    ds_read_b32 v99, v115 offset:0
    v_cvt_pk_bf16_f32 v116, v148, v149
    v_lshlrev_b32 v148, 16, v116
    v_and_b32 v149, 0xffff0000, v116
    v_pk_add_f32 v[148:149], v[148:149], v[44:45]
    v_cvt_pk_bf16_f32 v116, v148, v149
    v_lshlrev_b32 v148, 16, v116
    v_and_b32 v149, 0xffff0000, v116
    v_pk_lshlrev_b16 v117, 1, v116 op_sel_hi:[0,1]
    v_pk_lshrrev_b16 v116, 15, v116 op_sel_hi:[0,1]
    v_or_b32 v116, v116, v117
    v_pk_sub_u16 v116, v116, s37 clamp
    v_pk_max_u16 v75, v75, v116
    v_lshlrev_b32_sdwa v117, 2, v116 dst_sel:DWORD dst_unused:UNUSED_PAD src0_sel:DWORD src1_sel:WORD_1
    v_lshlrev_b32_sdwa v116, 2, v116 dst_sel:DWORD dst_unused:UNUSED_PAD src0_sel:DWORD src1_sel:WORD_0
    ds_read_b32 v100, v116 offset:0
    ds_read_b32 v101, v117 offset:0
    v_cvt_pk_bf16_f32 v118, v150, v151
    v_lshlrev_b32 v150, 16, v118
    v_and_b32 v151, 0xffff0000, v118
    v_pk_add_f32 v[150:151], v[150:151], v[46:47]
    v_cvt_pk_bf16_f32 v118, v150, v151
    v_lshlrev_b32 v150, 16, v118
    v_and_b32 v151, 0xffff0000, v118
    v_pk_lshlrev_b16 v119, 1, v118 op_sel_hi:[0,1]
    v_pk_lshrrev_b16 v118, 15, v118 op_sel_hi:[0,1]
    v_or_b32 v118, v118, v119
    v_pk_sub_u16 v118, v118, s37 clamp
    v_pk_max_u16 v75, v75, v118
    v_lshlrev_b32_sdwa v119, 2, v118 dst_sel:DWORD dst_unused:UNUSED_PAD src0_sel:DWORD src1_sel:WORD_1
    v_lshlrev_b32_sdwa v118, 2, v118 dst_sel:DWORD dst_unused:UNUSED_PAD src0_sel:DWORD src1_sel:WORD_0
    ds_read_b32 v102, v118 offset:0
    ds_read_b32 v103, v119 offset:0
    s_waitcnt lgkmcnt(8)
    v_pk_mul_f32 v[104:105], v[104:105], v[136:137]
    v_cvt_pk_bf16_f32 v68, v104, v105
    v_pk_mul_f32 v[106:107], v[106:107], v[138:139]
    v_cvt_pk_bf16_f32 v69, v106, v107
    v_pk_mul_f32 v[108:109], v[108:109], v[140:141]
    v_cvt_pk_bf16_f32 v70, v108, v109
    v_pk_mul_f32 v[110:111], v[110:111], v[142:143]
    v_cvt_pk_bf16_f32 v71, v110, v111
    s_add_u32 s30, s31, 512
    buffer_store_dwordx4 v[68:71], v74, s[20:23], s30 offen sc1
    v_cvt_pk_bf16_f32 v112, v152, v153
    v_lshlrev_b32 v152, 16, v112
    v_and_b32 v153, 0xffff0000, v112
    v_pk_add_f32 v[152:153], v[152:153], v[48:49]
    v_cvt_pk_bf16_f32 v112, v152, v153
    v_lshlrev_b32 v152, 16, v112
    v_and_b32 v153, 0xffff0000, v112
    v_pk_lshlrev_b16 v113, 1, v112 op_sel_hi:[0,1]
    v_pk_lshrrev_b16 v112, 15, v112 op_sel_hi:[0,1]
    v_or_b32 v112, v112, v113
    v_pk_sub_u16 v112, v112, s37 clamp
    v_pk_max_u16 v75, v75, v112
    v_lshlrev_b32_sdwa v113, 2, v112 dst_sel:DWORD dst_unused:UNUSED_PAD src0_sel:DWORD src1_sel:WORD_1
    v_lshlrev_b32_sdwa v112, 2, v112 dst_sel:DWORD dst_unused:UNUSED_PAD src0_sel:DWORD src1_sel:WORD_0
    ds_read_b32 v104, v112 offset:0
    ds_read_b32 v105, v113 offset:0
    v_cvt_pk_bf16_f32 v114, v154, v155
    v_lshlrev_b32 v154, 16, v114
    v_and_b32 v155, 0xffff0000, v114
    v_pk_add_f32 v[154:155], v[154:155], v[50:51]
    v_cvt_pk_bf16_f32 v114, v154, v155
    v_lshlrev_b32 v154, 16, v114
    v_and_b32 v155, 0xffff0000, v114
    v_pk_lshlrev_b16 v115, 1, v114 op_sel_hi:[0,1]
    v_pk_lshrrev_b16 v114, 15, v114 op_sel_hi:[0,1]
    v_or_b32 v114, v114, v115
    v_pk_sub_u16 v114, v114, s37 clamp
    v_pk_max_u16 v75, v75, v114
    v_lshlrev_b32_sdwa v115, 2, v114 dst_sel:DWORD dst_unused:UNUSED_PAD src0_sel:DWORD src1_sel:WORD_1
    v_lshlrev_b32_sdwa v114, 2, v114 dst_sel:DWORD dst_unused:UNUSED_PAD src0_sel:DWORD src1_sel:WORD_0
    ds_read_b32 v106, v114 offset:0
    ds_read_b32 v107, v115 offset:0
    v_cvt_pk_bf16_f32 v116, v156, v157
    v_lshlrev_b32 v156, 16, v116
    v_and_b32 v157, 0xffff0000, v116
    v_pk_add_f32 v[156:157], v[156:157], v[52:53]
    v_cvt_pk_bf16_f32 v116, v156, v157
    v_lshlrev_b32 v156, 16, v116
    v_and_b32 v157, 0xffff0000, v116
    v_pk_lshlrev_b16 v117, 1, v116 op_sel_hi:[0,1]
    v_pk_lshrrev_b16 v116, 15, v116 op_sel_hi:[0,1]
    v_or_b32 v116, v116, v117
    v_pk_sub_u16 v116, v116, s37 clamp
    v_pk_max_u16 v75, v75, v116
    v_lshlrev_b32_sdwa v117, 2, v116 dst_sel:DWORD dst_unused:UNUSED_PAD src0_sel:DWORD src1_sel:WORD_1
    v_lshlrev_b32_sdwa v116, 2, v116 dst_sel:DWORD dst_unused:UNUSED_PAD src0_sel:DWORD src1_sel:WORD_0
    ds_read_b32 v108, v116 offset:0
    ds_read_b32 v109, v117 offset:0
    v_cvt_pk_bf16_f32 v118, v158, v159
    v_lshlrev_b32 v158, 16, v118
    v_and_b32 v159, 0xffff0000, v118
    v_pk_add_f32 v[158:159], v[158:159], v[54:55]
    v_cvt_pk_bf16_f32 v118, v158, v159
    v_lshlrev_b32 v158, 16, v118
    v_and_b32 v159, 0xffff0000, v118
    v_pk_lshlrev_b16 v119, 1, v118 op_sel_hi:[0,1]
    v_pk_lshrrev_b16 v118, 15, v118 op_sel_hi:[0,1]
    v_or_b32 v118, v118, v119
    v_pk_sub_u16 v118, v118, s37 clamp
    v_pk_max_u16 v75, v75, v118
    v_lshlrev_b32_sdwa v119, 2, v118 dst_sel:DWORD dst_unused:UNUSED_PAD src0_sel:DWORD src1_sel:WORD_1
    v_lshlrev_b32_sdwa v118, 2, v118 dst_sel:DWORD dst_unused:UNUSED_PAD src0_sel:DWORD src1_sel:WORD_0
    ds_read_b32 v110, v118 offset:0
    ds_read_b32 v111, v119 offset:0
    s_waitcnt lgkmcnt(8)
    v_pk_mul_f32 v[96:97], v[96:97], v[144:145]
    v_cvt_pk_bf16_f32 v64, v96, v97
    v_pk_mul_f32 v[98:99], v[98:99], v[146:147]
    v_cvt_pk_bf16_f32 v65, v98, v99
    v_pk_mul_f32 v[100:101], v[100:101], v[148:149]
    v_cvt_pk_bf16_f32 v66, v100, v101
    v_pk_mul_f32 v[102:103], v[102:103], v[150:151]
    v_cvt_pk_bf16_f32 v67, v102, v103
    s_add_u32 s30, s31, 4096
    buffer_store_dwordx4 v[64:67], v74, s[20:23], s30 offen sc1
    v_cvt_pk_bf16_f32 v112, v160, v161
    v_lshlrev_b32 v160, 16, v112
    v_and_b32 v161, 0xffff0000, v112
    v_pk_add_f32 v[160:161], v[160:161], v[24:25]
    v_cvt_pk_bf16_f32 v112, v160, v161
    v_lshlrev_b32 v160, 16, v112
    v_and_b32 v161, 0xffff0000, v112
    v_pk_lshlrev_b16 v113, 1, v112 op_sel_hi:[0,1]
    v_pk_lshrrev_b16 v112, 15, v112 op_sel_hi:[0,1]
    v_or_b32 v112, v112, v113
    v_pk_sub_u16 v112, v112, s37 clamp
    v_pk_max_u16 v75, v75, v112
    v_lshlrev_b32_sdwa v113, 2, v112 dst_sel:DWORD dst_unused:UNUSED_PAD src0_sel:DWORD src1_sel:WORD_1
    v_lshlrev_b32_sdwa v112, 2, v112 dst_sel:DWORD dst_unused:UNUSED_PAD src0_sel:DWORD src1_sel:WORD_0
    ds_read_b32 v96, v112 offset:0
    ds_read_b32 v97, v113 offset:0
    v_cvt_pk_bf16_f32 v114, v162, v163
    v_lshlrev_b32 v162, 16, v114
    v_and_b32 v163, 0xffff0000, v114
    v_pk_add_f32 v[162:163], v[162:163], v[26:27]
    v_cvt_pk_bf16_f32 v114, v162, v163
    v_lshlrev_b32 v162, 16, v114
    v_and_b32 v163, 0xffff0000, v114
    v_pk_lshlrev_b16 v115, 1, v114 op_sel_hi:[0,1]
    v_pk_lshrrev_b16 v114, 15, v114 op_sel_hi:[0,1]
    v_or_b32 v114, v114, v115
    v_pk_sub_u16 v114, v114, s37 clamp
    v_pk_max_u16 v75, v75, v114
    v_lshlrev_b32_sdwa v115, 2, v114 dst_sel:DWORD dst_unused:UNUSED_PAD src0_sel:DWORD src1_sel:WORD_1
    v_lshlrev_b32_sdwa v114, 2, v114 dst_sel:DWORD dst_unused:UNUSED_PAD src0_sel:DWORD src1_sel:WORD_0
    ds_read_b32 v98, v114 offset:0
    ds_read_b32 v99, v115 offset:0
    v_cvt_pk_bf16_f32 v116, v164, v165
    v_lshlrev_b32 v164, 16, v116
    v_and_b32 v165, 0xffff0000, v116
    v_pk_add_f32 v[164:165], v[164:165], v[28:29]
    v_cvt_pk_bf16_f32 v116, v164, v165
    v_lshlrev_b32 v164, 16, v116
    v_and_b32 v165, 0xffff0000, v116
    v_pk_lshlrev_b16 v117, 1, v116 op_sel_hi:[0,1]
    v_pk_lshrrev_b16 v116, 15, v116 op_sel_hi:[0,1]
    v_or_b32 v116, v116, v117
    v_pk_sub_u16 v116, v116, s37 clamp
    v_pk_max_u16 v75, v75, v116
    v_lshlrev_b32_sdwa v117, 2, v116 dst_sel:DWORD dst_unused:UNUSED_PAD src0_sel:DWORD src1_sel:WORD_1
    v_lshlrev_b32_sdwa v116, 2, v116 dst_sel:DWORD dst_unused:UNUSED_PAD src0_sel:DWORD src1_sel:WORD_0
    ds_read_b32 v100, v116 offset:0
    ds_read_b32 v101, v117 offset:0
    v_cvt_pk_bf16_f32 v118, v166, v167
    v_lshlrev_b32 v166, 16, v118
    v_and_b32 v167, 0xffff0000, v118
    v_pk_add_f32 v[166:167], v[166:167], v[30:31]
    v_cvt_pk_bf16_f32 v118, v166, v167
    v_lshlrev_b32 v166, 16, v118
    v_and_b32 v167, 0xffff0000, v118
    v_pk_lshlrev_b16 v119, 1, v118 op_sel_hi:[0,1]
    v_pk_lshrrev_b16 v118, 15, v118 op_sel_hi:[0,1]
    v_or_b32 v118, v118, v119
    v_pk_sub_u16 v118, v118, s37 clamp
    v_pk_max_u16 v75, v75, v118
    v_lshlrev_b32_sdwa v119, 2, v118 dst_sel:DWORD dst_unused:UNUSED_PAD src0_sel:DWORD src1_sel:WORD_1
    v_lshlrev_b32_sdwa v118, 2, v118 dst_sel:DWORD dst_unused:UNUSED_PAD src0_sel:DWORD src1_sel:WORD_0
    ds_read_b32 v102, v118 offset:0
    ds_read_b32 v103, v119 offset:0
    s_waitcnt lgkmcnt(8)
    v_pk_mul_f32 v[104:105], v[104:105], v[152:153]
    v_cvt_pk_bf16_f32 v68, v104, v105
    v_pk_mul_f32 v[106:107], v[106:107], v[154:155]
    v_cvt_pk_bf16_f32 v69, v106, v107
    v_pk_mul_f32 v[108:109], v[108:109], v[156:157]
    v_cvt_pk_bf16_f32 v70, v108, v109
    v_pk_mul_f32 v[110:111], v[110:111], v[158:159]
    v_cvt_pk_bf16_f32 v71, v110, v111
    s_add_u32 s30, s31, 4608
    buffer_store_dwordx4 v[68:71], v74, s[20:23], s30 offen sc1
    v_cvt_pk_bf16_f32 v112, v168, v169
    v_lshlrev_b32 v168, 16, v112
    v_and_b32 v169, 0xffff0000, v112
    v_pk_add_f32 v[168:169], v[168:169], v[32:33]
    v_cvt_pk_bf16_f32 v112, v168, v169
    v_lshlrev_b32 v168, 16, v112
    v_and_b32 v169, 0xffff0000, v112
    v_pk_lshlrev_b16 v113, 1, v112 op_sel_hi:[0,1]
    v_pk_lshrrev_b16 v112, 15, v112 op_sel_hi:[0,1]
    v_or_b32 v112, v112, v113
    v_pk_sub_u16 v112, v112, s37 clamp
    v_pk_max_u16 v75, v75, v112
    v_lshlrev_b32_sdwa v113, 2, v112 dst_sel:DWORD dst_unused:UNUSED_PAD src0_sel:DWORD src1_sel:WORD_1
    v_lshlrev_b32_sdwa v112, 2, v112 dst_sel:DWORD dst_unused:UNUSED_PAD src0_sel:DWORD src1_sel:WORD_0
    ds_read_b32 v104, v112 offset:0
    ds_read_b32 v105, v113 offset:0
    v_cvt_pk_bf16_f32 v114, v170, v171
    v_lshlrev_b32 v170, 16, v114
    v_and_b32 v171, 0xffff0000, v114
    v_pk_add_f32 v[170:171], v[170:171], v[34:35]
    v_cvt_pk_bf16_f32 v114, v170, v171
    v_lshlrev_b32 v170, 16, v114
    v_and_b32 v171, 0xffff0000, v114
    v_pk_lshlrev_b16 v115, 1, v114 op_sel_hi:[0,1]
    v_pk_lshrrev_b16 v114, 15, v114 op_sel_hi:[0,1]
    v_or_b32 v114, v114, v115
    v_pk_sub_u16 v114, v114, s37 clamp
    v_pk_max_u16 v75, v75, v114
    v_lshlrev_b32_sdwa v115, 2, v114 dst_sel:DWORD dst_unused:UNUSED_PAD src0_sel:DWORD src1_sel:WORD_1
    v_lshlrev_b32_sdwa v114, 2, v114 dst_sel:DWORD dst_unused:UNUSED_PAD src0_sel:DWORD src1_sel:WORD_0
    ds_read_b32 v106, v114 offset:0
    ds_read_b32 v107, v115 offset:0
    v_cvt_pk_bf16_f32 v116, v172, v173
    v_lshlrev_b32 v172, 16, v116
    v_and_b32 v173, 0xffff0000, v116
    v_pk_add_f32 v[172:173], v[172:173], v[36:37]
    v_cvt_pk_bf16_f32 v116, v172, v173
    v_lshlrev_b32 v172, 16, v116
    v_and_b32 v173, 0xffff0000, v116
    v_pk_lshlrev_b16 v117, 1, v116 op_sel_hi:[0,1]
    v_pk_lshrrev_b16 v116, 15, v116 op_sel_hi:[0,1]
    v_or_b32 v116, v116, v117
    v_pk_sub_u16 v116, v116, s37 clamp
    v_pk_max_u16 v75, v75, v116
    v_lshlrev_b32_sdwa v117, 2, v116 dst_sel:DWORD dst_unused:UNUSED_PAD src0_sel:DWORD src1_sel:WORD_1
    v_lshlrev_b32_sdwa v116, 2, v116 dst_sel:DWORD dst_unused:UNUSED_PAD src0_sel:DWORD src1_sel:WORD_0
    ds_read_b32 v108, v116 offset:0
    ds_read_b32 v109, v117 offset:0
    v_cvt_pk_bf16_f32 v118, v174, v175
    v_lshlrev_b32 v174, 16, v118
    v_and_b32 v175, 0xffff0000, v118
    v_pk_add_f32 v[174:175], v[174:175], v[38:39]
    v_cvt_pk_bf16_f32 v118, v174, v175
    v_lshlrev_b32 v174, 16, v118
    v_and_b32 v175, 0xffff0000, v118
    v_pk_lshlrev_b16 v119, 1, v118 op_sel_hi:[0,1]
    v_pk_lshrrev_b16 v118, 15, v118 op_sel_hi:[0,1]
    v_or_b32 v118, v118, v119
    v_pk_sub_u16 v118, v118, s37 clamp
    v_pk_max_u16 v75, v75, v118
    v_lshlrev_b32_sdwa v119, 2, v118 dst_sel:DWORD dst_unused:UNUSED_PAD src0_sel:DWORD src1_sel:WORD_1
    v_lshlrev_b32_sdwa v118, 2, v118 dst_sel:DWORD dst_unused:UNUSED_PAD src0_sel:DWORD src1_sel:WORD_0
    ds_read_b32 v110, v118 offset:0
    ds_read_b32 v111, v119 offset:0
    s_waitcnt lgkmcnt(8)
    v_pk_mul_f32 v[96:97], v[96:97], v[160:161]
    v_cvt_pk_bf16_f32 v64, v96, v97
    v_pk_mul_f32 v[98:99], v[98:99], v[162:163]
    v_cvt_pk_bf16_f32 v65, v98, v99
    v_pk_mul_f32 v[100:101], v[100:101], v[164:165]
    v_cvt_pk_bf16_f32 v66, v100, v101
    v_pk_mul_f32 v[102:103], v[102:103], v[166:167]
    v_cvt_pk_bf16_f32 v67, v102, v103
    s_add_u32 s30, s31, 2048
    buffer_store_dwordx4 v[64:67], v74, s[20:23], s30 offen sc1
    v_cvt_pk_bf16_f32 v112, v176, v177
    v_lshlrev_b32 v176, 16, v112
    v_and_b32 v177, 0xffff0000, v112
    v_pk_add_f32 v[176:177], v[176:177], v[40:41]
    v_cvt_pk_bf16_f32 v112, v176, v177
    v_lshlrev_b32 v176, 16, v112
    v_and_b32 v177, 0xffff0000, v112
    v_pk_lshlrev_b16 v113, 1, v112 op_sel_hi:[0,1]
    v_pk_lshrrev_b16 v112, 15, v112 op_sel_hi:[0,1]
    v_or_b32 v112, v112, v113
    v_pk_sub_u16 v112, v112, s37 clamp
    v_pk_max_u16 v75, v75, v112
    v_lshlrev_b32_sdwa v113, 2, v112 dst_sel:DWORD dst_unused:UNUSED_PAD src0_sel:DWORD src1_sel:WORD_1
    v_lshlrev_b32_sdwa v112, 2, v112 dst_sel:DWORD dst_unused:UNUSED_PAD src0_sel:DWORD src1_sel:WORD_0
    ds_read_b32 v96, v112 offset:0
    ds_read_b32 v97, v113 offset:0
    v_cvt_pk_bf16_f32 v114, v178, v179
    v_lshlrev_b32 v178, 16, v114
    v_and_b32 v179, 0xffff0000, v114
    v_pk_add_f32 v[178:179], v[178:179], v[42:43]
    v_cvt_pk_bf16_f32 v114, v178, v179
    v_lshlrev_b32 v178, 16, v114
    v_and_b32 v179, 0xffff0000, v114
    v_pk_lshlrev_b16 v115, 1, v114 op_sel_hi:[0,1]
    v_pk_lshrrev_b16 v114, 15, v114 op_sel_hi:[0,1]
    v_or_b32 v114, v114, v115
    v_pk_sub_u16 v114, v114, s37 clamp
    v_pk_max_u16 v75, v75, v114
    v_lshlrev_b32_sdwa v115, 2, v114 dst_sel:DWORD dst_unused:UNUSED_PAD src0_sel:DWORD src1_sel:WORD_1
    v_lshlrev_b32_sdwa v114, 2, v114 dst_sel:DWORD dst_unused:UNUSED_PAD src0_sel:DWORD src1_sel:WORD_0
    ds_read_b32 v98, v114 offset:0
    ds_read_b32 v99, v115 offset:0
    v_cvt_pk_bf16_f32 v116, v180, v181
    v_lshlrev_b32 v180, 16, v116
    v_and_b32 v181, 0xffff0000, v116
    v_pk_add_f32 v[180:181], v[180:181], v[44:45]
    v_cvt_pk_bf16_f32 v116, v180, v181
    v_lshlrev_b32 v180, 16, v116
    v_and_b32 v181, 0xffff0000, v116
    v_pk_lshlrev_b16 v117, 1, v116 op_sel_hi:[0,1]
    v_pk_lshrrev_b16 v116, 15, v116 op_sel_hi:[0,1]
    v_or_b32 v116, v116, v117
    v_pk_sub_u16 v116, v116, s37 clamp
    v_pk_max_u16 v75, v75, v116
    v_lshlrev_b32_sdwa v117, 2, v116 dst_sel:DWORD dst_unused:UNUSED_PAD src0_sel:DWORD src1_sel:WORD_1
    v_lshlrev_b32_sdwa v116, 2, v116 dst_sel:DWORD dst_unused:UNUSED_PAD src0_sel:DWORD src1_sel:WORD_0
    ds_read_b32 v100, v116 offset:0
    ds_read_b32 v101, v117 offset:0
    v_cvt_pk_bf16_f32 v118, v182, v183
    v_lshlrev_b32 v182, 16, v118
    v_and_b32 v183, 0xffff0000, v118
    v_pk_add_f32 v[182:183], v[182:183], v[46:47]
    v_cvt_pk_bf16_f32 v118, v182, v183
    v_lshlrev_b32 v182, 16, v118
    v_and_b32 v183, 0xffff0000, v118
    v_pk_lshlrev_b16 v119, 1, v118 op_sel_hi:[0,1]
    v_pk_lshrrev_b16 v118, 15, v118 op_sel_hi:[0,1]
    v_or_b32 v118, v118, v119
    v_pk_sub_u16 v118, v118, s37 clamp
    v_pk_max_u16 v75, v75, v118
    v_lshlrev_b32_sdwa v119, 2, v118 dst_sel:DWORD dst_unused:UNUSED_PAD src0_sel:DWORD src1_sel:WORD_1
    v_lshlrev_b32_sdwa v118, 2, v118 dst_sel:DWORD dst_unused:UNUSED_PAD src0_sel:DWORD src1_sel:WORD_0
    ds_read_b32 v102, v118 offset:0
    ds_read_b32 v103, v119 offset:0
    s_waitcnt lgkmcnt(8)
    v_pk_mul_f32 v[104:105], v[104:105], v[168:169]
    v_cvt_pk_bf16_f32 v68, v104, v105
    v_pk_mul_f32 v[106:107], v[106:107], v[170:171]
    v_cvt_pk_bf16_f32 v69, v106, v107
    v_pk_mul_f32 v[108:109], v[108:109], v[172:173]
    v_cvt_pk_bf16_f32 v70, v108, v109
    v_pk_mul_f32 v[110:111], v[110:111], v[174:175]
    v_cvt_pk_bf16_f32 v71, v110, v111
    s_add_u32 s30, s31, 2560
    buffer_store_dwordx4 v[68:71], v74, s[20:23], s30 offen sc1
    v_cvt_pk_bf16_f32 v112, v184, v185
    v_lshlrev_b32 v184, 16, v112
    v_and_b32 v185, 0xffff0000, v112
    v_pk_add_f32 v[184:185], v[184:185], v[48:49]
    v_cvt_pk_bf16_f32 v112, v184, v185
    v_lshlrev_b32 v184, 16, v112
    v_and_b32 v185, 0xffff0000, v112
    v_pk_lshlrev_b16 v113, 1, v112 op_sel_hi:[0,1]
    v_pk_lshrrev_b16 v112, 15, v112 op_sel_hi:[0,1]
    v_or_b32 v112, v112, v113
    v_pk_sub_u16 v112, v112, s37 clamp
    v_pk_max_u16 v75, v75, v112
    v_lshlrev_b32_sdwa v113, 2, v112 dst_sel:DWORD dst_unused:UNUSED_PAD src0_sel:DWORD src1_sel:WORD_1
    v_lshlrev_b32_sdwa v112, 2, v112 dst_sel:DWORD dst_unused:UNUSED_PAD src0_sel:DWORD src1_sel:WORD_0
    ds_read_b32 v104, v112 offset:0
    ds_read_b32 v105, v113 offset:0
    v_cvt_pk_bf16_f32 v114, v186, v187
    v_lshlrev_b32 v186, 16, v114
    v_and_b32 v187, 0xffff0000, v114
    v_pk_add_f32 v[186:187], v[186:187], v[50:51]
    v_cvt_pk_bf16_f32 v114, v186, v187
    v_lshlrev_b32 v186, 16, v114
    v_and_b32 v187, 0xffff0000, v114
    v_pk_lshlrev_b16 v115, 1, v114 op_sel_hi:[0,1]
    v_pk_lshrrev_b16 v114, 15, v114 op_sel_hi:[0,1]
    v_or_b32 v114, v114, v115
    v_pk_sub_u16 v114, v114, s37 clamp
    v_pk_max_u16 v75, v75, v114
    v_lshlrev_b32_sdwa v115, 2, v114 dst_sel:DWORD dst_unused:UNUSED_PAD src0_sel:DWORD src1_sel:WORD_1
    v_lshlrev_b32_sdwa v114, 2, v114 dst_sel:DWORD dst_unused:UNUSED_PAD src0_sel:DWORD src1_sel:WORD_0
    ds_read_b32 v106, v114 offset:0
    ds_read_b32 v107, v115 offset:0
    v_cvt_pk_bf16_f32 v116, v188, v189
    v_lshlrev_b32 v188, 16, v116
    v_and_b32 v189, 0xffff0000, v116
    v_pk_add_f32 v[188:189], v[188:189], v[52:53]
    v_cvt_pk_bf16_f32 v116, v188, v189
    v_lshlrev_b32 v188, 16, v116
    v_and_b32 v189, 0xffff0000, v116
    v_pk_lshlrev_b16 v117, 1, v116 op_sel_hi:[0,1]
    v_pk_lshrrev_b16 v116, 15, v116 op_sel_hi:[0,1]
    v_or_b32 v116, v116, v117
    v_pk_sub_u16 v116, v116, s37 clamp
    v_pk_max_u16 v75, v75, v116
    v_lshlrev_b32_sdwa v117, 2, v116 dst_sel:DWORD dst_unused:UNUSED_PAD src0_sel:DWORD src1_sel:WORD_1
    v_lshlrev_b32_sdwa v116, 2, v116 dst_sel:DWORD dst_unused:UNUSED_PAD src0_sel:DWORD src1_sel:WORD_0
    ds_read_b32 v108, v116 offset:0
    ds_read_b32 v109, v117 offset:0
    v_cvt_pk_bf16_f32 v118, v190, v191
    v_lshlrev_b32 v190, 16, v118
    v_and_b32 v191, 0xffff0000, v118
    v_pk_add_f32 v[190:191], v[190:191], v[54:55]
    v_cvt_pk_bf16_f32 v118, v190, v191
    v_lshlrev_b32 v190, 16, v118
    v_and_b32 v191, 0xffff0000, v118
    v_pk_lshlrev_b16 v119, 1, v118 op_sel_hi:[0,1]
    v_pk_lshrrev_b16 v118, 15, v118 op_sel_hi:[0,1]
    v_or_b32 v118, v118, v119
    v_pk_sub_u16 v118, v118, s37 clamp
    v_pk_max_u16 v75, v75, v118
    v_lshlrev_b32_sdwa v119, 2, v118 dst_sel:DWORD dst_unused:UNUSED_PAD src0_sel:DWORD src1_sel:WORD_1
    v_lshlrev_b32_sdwa v118, 2, v118 dst_sel:DWORD dst_unused:UNUSED_PAD src0_sel:DWORD src1_sel:WORD_0
    ds_read_b32 v110, v118 offset:0
    ds_read_b32 v111, v119 offset:0
    s_waitcnt lgkmcnt(8)
    v_pk_mul_f32 v[96:97], v[96:97], v[176:177]
    v_cvt_pk_bf16_f32 v64, v96, v97
    v_pk_mul_f32 v[98:99], v[98:99], v[178:179]
    v_cvt_pk_bf16_f32 v65, v98, v99
    v_pk_mul_f32 v[100:101], v[100:101], v[180:181]
    v_cvt_pk_bf16_f32 v66, v100, v101
    v_pk_mul_f32 v[102:103], v[102:103], v[182:183]
    v_cvt_pk_bf16_f32 v67, v102, v103
    s_add_u32 s30, s31, 6144
    buffer_store_dwordx4 v[64:67], v74, s[20:23], s30 offen sc1
    s_waitcnt lgkmcnt(0)
    v_pk_mul_f32 v[104:105], v[104:105], v[184:185]
    v_cvt_pk_bf16_f32 v68, v104, v105
    v_pk_mul_f32 v[106:107], v[106:107], v[186:187]
    v_cvt_pk_bf16_f32 v69, v106, v107
    v_pk_mul_f32 v[108:109], v[108:109], v[188:189]
    v_cvt_pk_bf16_f32 v70, v108, v109
    v_pk_mul_f32 v[110:111], v[110:111], v[190:191]
    v_cvt_pk_bf16_f32 v71, v110, v111
    s_add_u32 s30, s31, 6656
    buffer_store_dwordx4 v[68:71], v74, s[20:23], s30 offen sc1
    s_mov_b32 s30, 234819071
    v_pk_sub_u16 v76, v75, s30 clamp
    v_cmp_ne_u32 vcc, 0, v76
    s_cbranch_vccz K1_MLP_DONEC
    s_waitcnt vmcnt(0)
    v_mul_f32 v56, -abs(v128), s32
    v_mul_f32 v57, -abs(v129), s32
    v_exp_f32 v56, v56
    v_exp_f32 v57, v57
    v_max_f32 v60, 0, v128
    v_max_f32 v61, 0, v129
    v_cvt_pk_bf16_f32 v62, v56, v57
    v_lshlrev_b32 v56, 16, v62
    v_and_b32 v57, 0xffff0000, v62
    v_add_f32 v58, 1.0, v56
    v_add_f32 v59, 1.0, v57
    v_log_f32 v58, v58
    v_log_f32 v59, v59
    v_cmp_gt_f32 s[38:39], s35, v56
    v_cmp_gt_f32 s[40:41], s35, v57
    v_mul_f32 v58, s33, v58
    v_mul_f32 v59, s33, v59
    v_cndmask_b32 v58, v58, v56, s[38:39]
    v_cndmask_b32 v59, v59, v57, s[40:41]
    v_cvt_pk_bf16_f32 v62, v58, v59
    v_lshlrev_b32 v58, 16, v62
    v_and_b32 v59, 0xffff0000, v62
    v_add_f32 v60, v60, v58
    v_add_f32 v61, v61, v59
    v_cvt_pk_bf16_f32 v62, v60, v61
    v_lshlrev_b32 v60, 16, v62
    v_and_b32 v61, 0xffff0000, v62
    v_mul_f32 v56, s34, v60
    v_mul_f32 v57, s34, v61
    v_exp_f32 v56, v56
    v_exp_f32 v57, v57
    v_cmp_gt_f32 s[38:39], s36, v60
    v_cmp_gt_f32 s[40:41], s36, v61
    v_add_f32 v62, 1.0, v56
    v_add_f32 v63, 1.0, v57
    v_rcp_f32 v62, v62
    v_rcp_f32 v63, v63
    v_sub_f32 v56, 1.0, v56
    v_sub_f32 v57, 1.0, v57
    v_mul_f32 v56, v56, v62
    v_mul_f32 v57, v57, v63
    v_cndmask_b32 v56, v56, v60, s[38:39]
    v_cndmask_b32 v57, v57, v61, s[40:41]
    v_cvt_pk_bf16_f32 v62, v56, v57
    v_lshlrev_b32 v56, 16, v62
    v_and_b32 v57, 0xffff0000, v62
    v_mul_f32 v56, v128, v56
    v_mul_f32 v57, v129, v57
    v_cvt_pk_bf16_f32 v64, v56, v57
    v_mul_f32 v56, -abs(v130), s32
    v_mul_f32 v57, -abs(v131), s32
    v_exp_f32 v56, v56
    v_exp_f32 v57, v57
    v_max_f32 v60, 0, v130
    v_max_f32 v61, 0, v131
    v_cvt_pk_bf16_f32 v62, v56, v57
    v_lshlrev_b32 v56, 16, v62
    v_and_b32 v57, 0xffff0000, v62
    v_add_f32 v58, 1.0, v56
    v_add_f32 v59, 1.0, v57
    v_log_f32 v58, v58
    v_log_f32 v59, v59
    v_cmp_gt_f32 s[38:39], s35, v56
    v_cmp_gt_f32 s[40:41], s35, v57
    v_mul_f32 v58, s33, v58
    v_mul_f32 v59, s33, v59
    v_cndmask_b32 v58, v58, v56, s[38:39]
    v_cndmask_b32 v59, v59, v57, s[40:41]
    v_cvt_pk_bf16_f32 v62, v58, v59
    v_lshlrev_b32 v58, 16, v62
    v_and_b32 v59, 0xffff0000, v62
    v_add_f32 v60, v60, v58
    v_add_f32 v61, v61, v59
    v_cvt_pk_bf16_f32 v62, v60, v61
    v_lshlrev_b32 v60, 16, v62
    v_and_b32 v61, 0xffff0000, v62
    v_mul_f32 v56, s34, v60
    v_mul_f32 v57, s34, v61
    v_exp_f32 v56, v56
    v_exp_f32 v57, v57
    v_cmp_gt_f32 s[38:39], s36, v60
    v_cmp_gt_f32 s[40:41], s36, v61
    v_add_f32 v62, 1.0, v56
    v_add_f32 v63, 1.0, v57
    v_rcp_f32 v62, v62
    v_rcp_f32 v63, v63
    v_sub_f32 v56, 1.0, v56
    v_sub_f32 v57, 1.0, v57
    v_mul_f32 v56, v56, v62
    v_mul_f32 v57, v57, v63
    v_cndmask_b32 v56, v56, v60, s[38:39]
    v_cndmask_b32 v57, v57, v61, s[40:41]
    v_cvt_pk_bf16_f32 v62, v56, v57
    v_lshlrev_b32 v56, 16, v62
    v_and_b32 v57, 0xffff0000, v62
    v_mul_f32 v56, v130, v56
    v_mul_f32 v57, v131, v57
    v_cvt_pk_bf16_f32 v65, v56, v57
    v_mul_f32 v56, -abs(v132), s32
    v_mul_f32 v57, -abs(v133), s32
    v_exp_f32 v56, v56
    v_exp_f32 v57, v57
    v_max_f32 v60, 0, v132
    v_max_f32 v61, 0, v133
    v_cvt_pk_bf16_f32 v62, v56, v57
    v_lshlrev_b32 v56, 16, v62
    v_and_b32 v57, 0xffff0000, v62
    v_add_f32 v58, 1.0, v56
    v_add_f32 v59, 1.0, v57
    v_log_f32 v58, v58
    v_log_f32 v59, v59
    v_cmp_gt_f32 s[38:39], s35, v56
    v_cmp_gt_f32 s[40:41], s35, v57
    v_mul_f32 v58, s33, v58
    v_mul_f32 v59, s33, v59
    v_cndmask_b32 v58, v58, v56, s[38:39]
    v_cndmask_b32 v59, v59, v57, s[40:41]
    v_cvt_pk_bf16_f32 v62, v58, v59
    v_lshlrev_b32 v58, 16, v62
    v_and_b32 v59, 0xffff0000, v62
    v_add_f32 v60, v60, v58
    v_add_f32 v61, v61, v59
    v_cvt_pk_bf16_f32 v62, v60, v61
    v_lshlrev_b32 v60, 16, v62
    v_and_b32 v61, 0xffff0000, v62
    v_mul_f32 v56, s34, v60
    v_mul_f32 v57, s34, v61
    v_exp_f32 v56, v56
    v_exp_f32 v57, v57
    v_cmp_gt_f32 s[38:39], s36, v60
    v_cmp_gt_f32 s[40:41], s36, v61
    v_add_f32 v62, 1.0, v56
    v_add_f32 v63, 1.0, v57
    v_rcp_f32 v62, v62
    v_rcp_f32 v63, v63
    v_sub_f32 v56, 1.0, v56
    v_sub_f32 v57, 1.0, v57
    v_mul_f32 v56, v56, v62
    v_mul_f32 v57, v57, v63
    v_cndmask_b32 v56, v56, v60, s[38:39]
    v_cndmask_b32 v57, v57, v61, s[40:41]
    v_cvt_pk_bf16_f32 v62, v56, v57
    v_lshlrev_b32 v56, 16, v62
    v_and_b32 v57, 0xffff0000, v62
    v_mul_f32 v56, v132, v56
    v_mul_f32 v57, v133, v57
    v_cvt_pk_bf16_f32 v66, v56, v57
    v_mul_f32 v56, -abs(v134), s32
    v_mul_f32 v57, -abs(v135), s32
    v_exp_f32 v56, v56
    v_exp_f32 v57, v57
    v_max_f32 v60, 0, v134
    v_max_f32 v61, 0, v135
    v_cvt_pk_bf16_f32 v62, v56, v57
    v_lshlrev_b32 v56, 16, v62
    v_and_b32 v57, 0xffff0000, v62
    v_add_f32 v58, 1.0, v56
    v_add_f32 v59, 1.0, v57
    v_log_f32 v58, v58
    v_log_f32 v59, v59
    v_cmp_gt_f32 s[38:39], s35, v56
    v_cmp_gt_f32 s[40:41], s35, v57
    v_mul_f32 v58, s33, v58
    v_mul_f32 v59, s33, v59
    v_cndmask_b32 v58, v58, v56, s[38:39]
    v_cndmask_b32 v59, v59, v57, s[40:41]
    v_cvt_pk_bf16_f32 v62, v58, v59
    v_lshlrev_b32 v58, 16, v62
    v_and_b32 v59, 0xffff0000, v62
    v_add_f32 v60, v60, v58
    v_add_f32 v61, v61, v59
    v_cvt_pk_bf16_f32 v62, v60, v61
    v_lshlrev_b32 v60, 16, v62
    v_and_b32 v61, 0xffff0000, v62
    v_mul_f32 v56, s34, v60
    v_mul_f32 v57, s34, v61
    v_exp_f32 v56, v56
    v_exp_f32 v57, v57
    v_cmp_gt_f32 s[38:39], s36, v60
    v_cmp_gt_f32 s[40:41], s36, v61
    v_add_f32 v62, 1.0, v56
    v_add_f32 v63, 1.0, v57
    v_rcp_f32 v62, v62
    v_rcp_f32 v63, v63
    v_sub_f32 v56, 1.0, v56
    v_sub_f32 v57, 1.0, v57
    v_mul_f32 v56, v56, v62
    v_mul_f32 v57, v57, v63
    v_cndmask_b32 v56, v56, v60, s[38:39]
    v_cndmask_b32 v57, v57, v61, s[40:41]
    v_cvt_pk_bf16_f32 v62, v56, v57
    v_lshlrev_b32 v56, 16, v62
    v_and_b32 v57, 0xffff0000, v62
    v_mul_f32 v56, v134, v56
    v_mul_f32 v57, v135, v57
    v_cvt_pk_bf16_f32 v67, v56, v57
    s_add_u32 s30, s31, 0
    buffer_store_dwordx4 v[64:67], v74, s[20:23], s30 offen sc1
    v_mul_f32 v56, -abs(v136), s32
    v_mul_f32 v57, -abs(v137), s32
    v_exp_f32 v56, v56
    v_exp_f32 v57, v57
    v_max_f32 v60, 0, v136
    v_max_f32 v61, 0, v137
    v_cvt_pk_bf16_f32 v62, v56, v57
    v_lshlrev_b32 v56, 16, v62
    v_and_b32 v57, 0xffff0000, v62
    v_add_f32 v58, 1.0, v56
    v_add_f32 v59, 1.0, v57
    v_log_f32 v58, v58
    v_log_f32 v59, v59
    v_cmp_gt_f32 s[38:39], s35, v56
    v_cmp_gt_f32 s[40:41], s35, v57
    v_mul_f32 v58, s33, v58
    v_mul_f32 v59, s33, v59
    v_cndmask_b32 v58, v58, v56, s[38:39]
    v_cndmask_b32 v59, v59, v57, s[40:41]
    v_cvt_pk_bf16_f32 v62, v58, v59
    v_lshlrev_b32 v58, 16, v62
    v_and_b32 v59, 0xffff0000, v62
    v_add_f32 v60, v60, v58
    v_add_f32 v61, v61, v59
    v_cvt_pk_bf16_f32 v62, v60, v61
    v_lshlrev_b32 v60, 16, v62
    v_and_b32 v61, 0xffff0000, v62
    v_mul_f32 v56, s34, v60
    v_mul_f32 v57, s34, v61
    v_exp_f32 v56, v56
    v_exp_f32 v57, v57
    v_cmp_gt_f32 s[38:39], s36, v60
    v_cmp_gt_f32 s[40:41], s36, v61
    v_add_f32 v62, 1.0, v56
    v_add_f32 v63, 1.0, v57
    v_rcp_f32 v62, v62
    v_rcp_f32 v63, v63
    v_sub_f32 v56, 1.0, v56
    v_sub_f32 v57, 1.0, v57
    v_mul_f32 v56, v56, v62
    v_mul_f32 v57, v57, v63
    v_cndmask_b32 v56, v56, v60, s[38:39]
    v_cndmask_b32 v57, v57, v61, s[40:41]
    v_cvt_pk_bf16_f32 v62, v56, v57
    v_lshlrev_b32 v56, 16, v62
    v_and_b32 v57, 0xffff0000, v62
    v_mul_f32 v56, v136, v56
    v_mul_f32 v57, v137, v57
    v_cvt_pk_bf16_f32 v68, v56, v57
    v_mul_f32 v56, -abs(v138), s32
    v_mul_f32 v57, -abs(v139), s32
    v_exp_f32 v56, v56
    v_exp_f32 v57, v57
    v_max_f32 v60, 0, v138
    v_max_f32 v61, 0, v139
    v_cvt_pk_bf16_f32 v62, v56, v57
    v_lshlrev_b32 v56, 16, v62
    v_and_b32 v57, 0xffff0000, v62
    v_add_f32 v58, 1.0, v56
    v_add_f32 v59, 1.0, v57
    v_log_f32 v58, v58
    v_log_f32 v59, v59
    v_cmp_gt_f32 s[38:39], s35, v56
    v_cmp_gt_f32 s[40:41], s35, v57
    v_mul_f32 v58, s33, v58
    v_mul_f32 v59, s33, v59
    v_cndmask_b32 v58, v58, v56, s[38:39]
    v_cndmask_b32 v59, v59, v57, s[40:41]
    v_cvt_pk_bf16_f32 v62, v58, v59
    v_lshlrev_b32 v58, 16, v62
    v_and_b32 v59, 0xffff0000, v62
    v_add_f32 v60, v60, v58
    v_add_f32 v61, v61, v59
    v_cvt_pk_bf16_f32 v62, v60, v61
    v_lshlrev_b32 v60, 16, v62
    v_and_b32 v61, 0xffff0000, v62
    v_mul_f32 v56, s34, v60
    v_mul_f32 v57, s34, v61
    v_exp_f32 v56, v56
    v_exp_f32 v57, v57
    v_cmp_gt_f32 s[38:39], s36, v60
    v_cmp_gt_f32 s[40:41], s36, v61
    v_add_f32 v62, 1.0, v56
    v_add_f32 v63, 1.0, v57
    v_rcp_f32 v62, v62
    v_rcp_f32 v63, v63
    v_sub_f32 v56, 1.0, v56
    v_sub_f32 v57, 1.0, v57
    v_mul_f32 v56, v56, v62
    v_mul_f32 v57, v57, v63
    v_cndmask_b32 v56, v56, v60, s[38:39]
    v_cndmask_b32 v57, v57, v61, s[40:41]
    v_cvt_pk_bf16_f32 v62, v56, v57
    v_lshlrev_b32 v56, 16, v62
    v_and_b32 v57, 0xffff0000, v62
    v_mul_f32 v56, v138, v56
    v_mul_f32 v57, v139, v57
    v_cvt_pk_bf16_f32 v69, v56, v57
    v_mul_f32 v56, -abs(v140), s32
    v_mul_f32 v57, -abs(v141), s32
    v_exp_f32 v56, v56
    v_exp_f32 v57, v57
    v_max_f32 v60, 0, v140
    v_max_f32 v61, 0, v141
    v_cvt_pk_bf16_f32 v62, v56, v57
    v_lshlrev_b32 v56, 16, v62
    v_and_b32 v57, 0xffff0000, v62
    v_add_f32 v58, 1.0, v56
    v_add_f32 v59, 1.0, v57
    v_log_f32 v58, v58
    v_log_f32 v59, v59
    v_cmp_gt_f32 s[38:39], s35, v56
    v_cmp_gt_f32 s[40:41], s35, v57
    v_mul_f32 v58, s33, v58
    v_mul_f32 v59, s33, v59
    v_cndmask_b32 v58, v58, v56, s[38:39]
    v_cndmask_b32 v59, v59, v57, s[40:41]
    v_cvt_pk_bf16_f32 v62, v58, v59
    v_lshlrev_b32 v58, 16, v62
    v_and_b32 v59, 0xffff0000, v62
    v_add_f32 v60, v60, v58
    v_add_f32 v61, v61, v59
    v_cvt_pk_bf16_f32 v62, v60, v61
    v_lshlrev_b32 v60, 16, v62
    v_and_b32 v61, 0xffff0000, v62
    v_mul_f32 v56, s34, v60
    v_mul_f32 v57, s34, v61
    v_exp_f32 v56, v56
    v_exp_f32 v57, v57
    v_cmp_gt_f32 s[38:39], s36, v60
    v_cmp_gt_f32 s[40:41], s36, v61
    v_add_f32 v62, 1.0, v56
    v_add_f32 v63, 1.0, v57
    v_rcp_f32 v62, v62
    v_rcp_f32 v63, v63
    v_sub_f32 v56, 1.0, v56
    v_sub_f32 v57, 1.0, v57
    v_mul_f32 v56, v56, v62
    v_mul_f32 v57, v57, v63
    v_cndmask_b32 v56, v56, v60, s[38:39]
    v_cndmask_b32 v57, v57, v61, s[40:41]
    v_cvt_pk_bf16_f32 v62, v56, v57
    v_lshlrev_b32 v56, 16, v62
    v_and_b32 v57, 0xffff0000, v62
    v_mul_f32 v56, v140, v56
    v_mul_f32 v57, v141, v57
    v_cvt_pk_bf16_f32 v70, v56, v57
    v_mul_f32 v56, -abs(v142), s32
    v_mul_f32 v57, -abs(v143), s32
    v_exp_f32 v56, v56
    v_exp_f32 v57, v57
    v_max_f32 v60, 0, v142
    v_max_f32 v61, 0, v143
    v_cvt_pk_bf16_f32 v62, v56, v57
    v_lshlrev_b32 v56, 16, v62
    v_and_b32 v57, 0xffff0000, v62
    v_add_f32 v58, 1.0, v56
    v_add_f32 v59, 1.0, v57
    v_log_f32 v58, v58
    v_log_f32 v59, v59
    v_cmp_gt_f32 s[38:39], s35, v56
    v_cmp_gt_f32 s[40:41], s35, v57
    v_mul_f32 v58, s33, v58
    v_mul_f32 v59, s33, v59
    v_cndmask_b32 v58, v58, v56, s[38:39]
    v_cndmask_b32 v59, v59, v57, s[40:41]
    v_cvt_pk_bf16_f32 v62, v58, v59
    v_lshlrev_b32 v58, 16, v62
    v_and_b32 v59, 0xffff0000, v62
    v_add_f32 v60, v60, v58
    v_add_f32 v61, v61, v59
    v_cvt_pk_bf16_f32 v62, v60, v61
    v_lshlrev_b32 v60, 16, v62
    v_and_b32 v61, 0xffff0000, v62
    v_mul_f32 v56, s34, v60
    v_mul_f32 v57, s34, v61
    v_exp_f32 v56, v56
    v_exp_f32 v57, v57
    v_cmp_gt_f32 s[38:39], s36, v60
    v_cmp_gt_f32 s[40:41], s36, v61
    v_add_f32 v62, 1.0, v56
    v_add_f32 v63, 1.0, v57
    v_rcp_f32 v62, v62
    v_rcp_f32 v63, v63
    v_sub_f32 v56, 1.0, v56
    v_sub_f32 v57, 1.0, v57
    v_mul_f32 v56, v56, v62
    v_mul_f32 v57, v57, v63
    v_cndmask_b32 v56, v56, v60, s[38:39]
    v_cndmask_b32 v57, v57, v61, s[40:41]
    v_cvt_pk_bf16_f32 v62, v56, v57
    v_lshlrev_b32 v56, 16, v62
    v_and_b32 v57, 0xffff0000, v62
    v_mul_f32 v56, v142, v56
    v_mul_f32 v57, v143, v57
    v_cvt_pk_bf16_f32 v71, v56, v57
    s_add_u32 s30, s31, 512
    buffer_store_dwordx4 v[68:71], v74, s[20:23], s30 offen sc1
    v_mul_f32 v56, -abs(v144), s32
    v_mul_f32 v57, -abs(v145), s32
    v_exp_f32 v56, v56
    v_exp_f32 v57, v57
    v_max_f32 v60, 0, v144
    v_max_f32 v61, 0, v145
    v_cvt_pk_bf16_f32 v62, v56, v57
    v_lshlrev_b32 v56, 16, v62
    v_and_b32 v57, 0xffff0000, v62
    v_add_f32 v58, 1.0, v56
    v_add_f32 v59, 1.0, v57
    v_log_f32 v58, v58
    v_log_f32 v59, v59
    v_cmp_gt_f32 s[38:39], s35, v56
    v_cmp_gt_f32 s[40:41], s35, v57
    v_mul_f32 v58, s33, v58
    v_mul_f32 v59, s33, v59
    v_cndmask_b32 v58, v58, v56, s[38:39]
    v_cndmask_b32 v59, v59, v57, s[40:41]
    v_cvt_pk_bf16_f32 v62, v58, v59
    v_lshlrev_b32 v58, 16, v62
    v_and_b32 v59, 0xffff0000, v62
    v_add_f32 v60, v60, v58
    v_add_f32 v61, v61, v59
    v_cvt_pk_bf16_f32 v62, v60, v61
    v_lshlrev_b32 v60, 16, v62
    v_and_b32 v61, 0xffff0000, v62
    v_mul_f32 v56, s34, v60
    v_mul_f32 v57, s34, v61
    v_exp_f32 v56, v56
    v_exp_f32 v57, v57
    v_cmp_gt_f32 s[38:39], s36, v60
    v_cmp_gt_f32 s[40:41], s36, v61
    v_add_f32 v62, 1.0, v56
    v_add_f32 v63, 1.0, v57
    v_rcp_f32 v62, v62
    v_rcp_f32 v63, v63
    v_sub_f32 v56, 1.0, v56
    v_sub_f32 v57, 1.0, v57
    v_mul_f32 v56, v56, v62
    v_mul_f32 v57, v57, v63
    v_cndmask_b32 v56, v56, v60, s[38:39]
    v_cndmask_b32 v57, v57, v61, s[40:41]
    v_cvt_pk_bf16_f32 v62, v56, v57
    v_lshlrev_b32 v56, 16, v62
    v_and_b32 v57, 0xffff0000, v62
    v_mul_f32 v56, v144, v56
    v_mul_f32 v57, v145, v57
    v_cvt_pk_bf16_f32 v64, v56, v57
    v_mul_f32 v56, -abs(v146), s32
    v_mul_f32 v57, -abs(v147), s32
    v_exp_f32 v56, v56
    v_exp_f32 v57, v57
    v_max_f32 v60, 0, v146
    v_max_f32 v61, 0, v147
    v_cvt_pk_bf16_f32 v62, v56, v57
    v_lshlrev_b32 v56, 16, v62
    v_and_b32 v57, 0xffff0000, v62
    v_add_f32 v58, 1.0, v56
    v_add_f32 v59, 1.0, v57
    v_log_f32 v58, v58
    v_log_f32 v59, v59
    v_cmp_gt_f32 s[38:39], s35, v56
    v_cmp_gt_f32 s[40:41], s35, v57
    v_mul_f32 v58, s33, v58
    v_mul_f32 v59, s33, v59
    v_cndmask_b32 v58, v58, v56, s[38:39]
    v_cndmask_b32 v59, v59, v57, s[40:41]
    v_cvt_pk_bf16_f32 v62, v58, v59
    v_lshlrev_b32 v58, 16, v62
    v_and_b32 v59, 0xffff0000, v62
    v_add_f32 v60, v60, v58
    v_add_f32 v61, v61, v59
    v_cvt_pk_bf16_f32 v62, v60, v61
    v_lshlrev_b32 v60, 16, v62
    v_and_b32 v61, 0xffff0000, v62
    v_mul_f32 v56, s34, v60
    v_mul_f32 v57, s34, v61
    v_exp_f32 v56, v56
    v_exp_f32 v57, v57
    v_cmp_gt_f32 s[38:39], s36, v60
    v_cmp_gt_f32 s[40:41], s36, v61
    v_add_f32 v62, 1.0, v56
    v_add_f32 v63, 1.0, v57
    v_rcp_f32 v62, v62
    v_rcp_f32 v63, v63
    v_sub_f32 v56, 1.0, v56
    v_sub_f32 v57, 1.0, v57
    v_mul_f32 v56, v56, v62
    v_mul_f32 v57, v57, v63
    v_cndmask_b32 v56, v56, v60, s[38:39]
    v_cndmask_b32 v57, v57, v61, s[40:41]
    v_cvt_pk_bf16_f32 v62, v56, v57
    v_lshlrev_b32 v56, 16, v62
    v_and_b32 v57, 0xffff0000, v62
    v_mul_f32 v56, v146, v56
    v_mul_f32 v57, v147, v57
    v_cvt_pk_bf16_f32 v65, v56, v57
    v_mul_f32 v56, -abs(v148), s32
    v_mul_f32 v57, -abs(v149), s32
    v_exp_f32 v56, v56
    v_exp_f32 v57, v57
    v_max_f32 v60, 0, v148
    v_max_f32 v61, 0, v149
    v_cvt_pk_bf16_f32 v62, v56, v57
    v_lshlrev_b32 v56, 16, v62
    v_and_b32 v57, 0xffff0000, v62
    v_add_f32 v58, 1.0, v56
    v_add_f32 v59, 1.0, v57
    v_log_f32 v58, v58
    v_log_f32 v59, v59
    v_cmp_gt_f32 s[38:39], s35, v56
    v_cmp_gt_f32 s[40:41], s35, v57
    v_mul_f32 v58, s33, v58
    v_mul_f32 v59, s33, v59
    v_cndmask_b32 v58, v58, v56, s[38:39]
    v_cndmask_b32 v59, v59, v57, s[40:41]
    v_cvt_pk_bf16_f32 v62, v58, v59
    v_lshlrev_b32 v58, 16, v62
    v_and_b32 v59, 0xffff0000, v62
    v_add_f32 v60, v60, v58
    v_add_f32 v61, v61, v59
    v_cvt_pk_bf16_f32 v62, v60, v61
    v_lshlrev_b32 v60, 16, v62
    v_and_b32 v61, 0xffff0000, v62
    v_mul_f32 v56, s34, v60
    v_mul_f32 v57, s34, v61
    v_exp_f32 v56, v56
    v_exp_f32 v57, v57
    v_cmp_gt_f32 s[38:39], s36, v60
    v_cmp_gt_f32 s[40:41], s36, v61
    v_add_f32 v62, 1.0, v56
    v_add_f32 v63, 1.0, v57
    v_rcp_f32 v62, v62
    v_rcp_f32 v63, v63
    v_sub_f32 v56, 1.0, v56
    v_sub_f32 v57, 1.0, v57
    v_mul_f32 v56, v56, v62
    v_mul_f32 v57, v57, v63
    v_cndmask_b32 v56, v56, v60, s[38:39]
    v_cndmask_b32 v57, v57, v61, s[40:41]
    v_cvt_pk_bf16_f32 v62, v56, v57
    v_lshlrev_b32 v56, 16, v62
    v_and_b32 v57, 0xffff0000, v62
    v_mul_f32 v56, v148, v56
    v_mul_f32 v57, v149, v57
    v_cvt_pk_bf16_f32 v66, v56, v57
    v_mul_f32 v56, -abs(v150), s32
    v_mul_f32 v57, -abs(v151), s32
    v_exp_f32 v56, v56
    v_exp_f32 v57, v57
    v_max_f32 v60, 0, v150
    v_max_f32 v61, 0, v151
    v_cvt_pk_bf16_f32 v62, v56, v57
    v_lshlrev_b32 v56, 16, v62
    v_and_b32 v57, 0xffff0000, v62
    v_add_f32 v58, 1.0, v56
    v_add_f32 v59, 1.0, v57
    v_log_f32 v58, v58
    v_log_f32 v59, v59
    v_cmp_gt_f32 s[38:39], s35, v56
    v_cmp_gt_f32 s[40:41], s35, v57
    v_mul_f32 v58, s33, v58
    v_mul_f32 v59, s33, v59
    v_cndmask_b32 v58, v58, v56, s[38:39]
    v_cndmask_b32 v59, v59, v57, s[40:41]
    v_cvt_pk_bf16_f32 v62, v58, v59
    v_lshlrev_b32 v58, 16, v62
    v_and_b32 v59, 0xffff0000, v62
    v_add_f32 v60, v60, v58
    v_add_f32 v61, v61, v59
    v_cvt_pk_bf16_f32 v62, v60, v61
    v_lshlrev_b32 v60, 16, v62
    v_and_b32 v61, 0xffff0000, v62
    v_mul_f32 v56, s34, v60
    v_mul_f32 v57, s34, v61
    v_exp_f32 v56, v56
    v_exp_f32 v57, v57
    v_cmp_gt_f32 s[38:39], s36, v60
    v_cmp_gt_f32 s[40:41], s36, v61
    v_add_f32 v62, 1.0, v56
    v_add_f32 v63, 1.0, v57
    v_rcp_f32 v62, v62
    v_rcp_f32 v63, v63
    v_sub_f32 v56, 1.0, v56
    v_sub_f32 v57, 1.0, v57
    v_mul_f32 v56, v56, v62
    v_mul_f32 v57, v57, v63
    v_cndmask_b32 v56, v56, v60, s[38:39]
    v_cndmask_b32 v57, v57, v61, s[40:41]
    v_cvt_pk_bf16_f32 v62, v56, v57
    v_lshlrev_b32 v56, 16, v62
    v_and_b32 v57, 0xffff0000, v62
    v_mul_f32 v56, v150, v56
    v_mul_f32 v57, v151, v57
    v_cvt_pk_bf16_f32 v67, v56, v57
    s_add_u32 s30, s31, 4096
    buffer_store_dwordx4 v[64:67], v74, s[20:23], s30 offen sc1
    v_mul_f32 v56, -abs(v152), s32
    v_mul_f32 v57, -abs(v153), s32
    v_exp_f32 v56, v56
    v_exp_f32 v57, v57
    v_max_f32 v60, 0, v152
    v_max_f32 v61, 0, v153
    v_cvt_pk_bf16_f32 v62, v56, v57
    v_lshlrev_b32 v56, 16, v62
    v_and_b32 v57, 0xffff0000, v62
    v_add_f32 v58, 1.0, v56
    v_add_f32 v59, 1.0, v57
    v_log_f32 v58, v58
    v_log_f32 v59, v59
    v_cmp_gt_f32 s[38:39], s35, v56
    v_cmp_gt_f32 s[40:41], s35, v57
    v_mul_f32 v58, s33, v58
    v_mul_f32 v59, s33, v59
    v_cndmask_b32 v58, v58, v56, s[38:39]
    v_cndmask_b32 v59, v59, v57, s[40:41]
    v_cvt_pk_bf16_f32 v62, v58, v59
    v_lshlrev_b32 v58, 16, v62
    v_and_b32 v59, 0xffff0000, v62
    v_add_f32 v60, v60, v58
    v_add_f32 v61, v61, v59
    v_cvt_pk_bf16_f32 v62, v60, v61
    v_lshlrev_b32 v60, 16, v62
    v_and_b32 v61, 0xffff0000, v62
    v_mul_f32 v56, s34, v60
    v_mul_f32 v57, s34, v61
    v_exp_f32 v56, v56
    v_exp_f32 v57, v57
    v_cmp_gt_f32 s[38:39], s36, v60
    v_cmp_gt_f32 s[40:41], s36, v61
    v_add_f32 v62, 1.0, v56
    v_add_f32 v63, 1.0, v57
    v_rcp_f32 v62, v62
    v_rcp_f32 v63, v63
    v_sub_f32 v56, 1.0, v56
    v_sub_f32 v57, 1.0, v57
    v_mul_f32 v56, v56, v62
    v_mul_f32 v57, v57, v63
    v_cndmask_b32 v56, v56, v60, s[38:39]
    v_cndmask_b32 v57, v57, v61, s[40:41]
    v_cvt_pk_bf16_f32 v62, v56, v57
    v_lshlrev_b32 v56, 16, v62
    v_and_b32 v57, 0xffff0000, v62
    v_mul_f32 v56, v152, v56
    v_mul_f32 v57, v153, v57
    v_cvt_pk_bf16_f32 v68, v56, v57
    v_mul_f32 v56, -abs(v154), s32
    v_mul_f32 v57, -abs(v155), s32
    v_exp_f32 v56, v56
    v_exp_f32 v57, v57
    v_max_f32 v60, 0, v154
    v_max_f32 v61, 0, v155
    v_cvt_pk_bf16_f32 v62, v56, v57
    v_lshlrev_b32 v56, 16, v62
    v_and_b32 v57, 0xffff0000, v62
    v_add_f32 v58, 1.0, v56
    v_add_f32 v59, 1.0, v57
    v_log_f32 v58, v58
    v_log_f32 v59, v59
    v_cmp_gt_f32 s[38:39], s35, v56
    v_cmp_gt_f32 s[40:41], s35, v57
    v_mul_f32 v58, s33, v58
    v_mul_f32 v59, s33, v59
    v_cndmask_b32 v58, v58, v56, s[38:39]
    v_cndmask_b32 v59, v59, v57, s[40:41]
    v_cvt_pk_bf16_f32 v62, v58, v59
    v_lshlrev_b32 v58, 16, v62
    v_and_b32 v59, 0xffff0000, v62
    v_add_f32 v60, v60, v58
    v_add_f32 v61, v61, v59
    v_cvt_pk_bf16_f32 v62, v60, v61
    v_lshlrev_b32 v60, 16, v62
    v_and_b32 v61, 0xffff0000, v62
    v_mul_f32 v56, s34, v60
    v_mul_f32 v57, s34, v61
    v_exp_f32 v56, v56
    v_exp_f32 v57, v57
    v_cmp_gt_f32 s[38:39], s36, v60
    v_cmp_gt_f32 s[40:41], s36, v61
    v_add_f32 v62, 1.0, v56
    v_add_f32 v63, 1.0, v57
    v_rcp_f32 v62, v62
    v_rcp_f32 v63, v63
    v_sub_f32 v56, 1.0, v56
    v_sub_f32 v57, 1.0, v57
    v_mul_f32 v56, v56, v62
    v_mul_f32 v57, v57, v63
    v_cndmask_b32 v56, v56, v60, s[38:39]
    v_cndmask_b32 v57, v57, v61, s[40:41]
    v_cvt_pk_bf16_f32 v62, v56, v57
    v_lshlrev_b32 v56, 16, v62
    v_and_b32 v57, 0xffff0000, v62
    v_mul_f32 v56, v154, v56
    v_mul_f32 v57, v155, v57
    v_cvt_pk_bf16_f32 v69, v56, v57
    v_mul_f32 v56, -abs(v156), s32
    v_mul_f32 v57, -abs(v157), s32
    v_exp_f32 v56, v56
    v_exp_f32 v57, v57
    v_max_f32 v60, 0, v156
    v_max_f32 v61, 0, v157
    v_cvt_pk_bf16_f32 v62, v56, v57
    v_lshlrev_b32 v56, 16, v62
    v_and_b32 v57, 0xffff0000, v62
    v_add_f32 v58, 1.0, v56
    v_add_f32 v59, 1.0, v57
    v_log_f32 v58, v58
    v_log_f32 v59, v59
    v_cmp_gt_f32 s[38:39], s35, v56
    v_cmp_gt_f32 s[40:41], s35, v57
    v_mul_f32 v58, s33, v58
    v_mul_f32 v59, s33, v59
    v_cndmask_b32 v58, v58, v56, s[38:39]
    v_cndmask_b32 v59, v59, v57, s[40:41]
    v_cvt_pk_bf16_f32 v62, v58, v59
    v_lshlrev_b32 v58, 16, v62
    v_and_b32 v59, 0xffff0000, v62
    v_add_f32 v60, v60, v58
    v_add_f32 v61, v61, v59
    v_cvt_pk_bf16_f32 v62, v60, v61
    v_lshlrev_b32 v60, 16, v62
    v_and_b32 v61, 0xffff0000, v62
    v_mul_f32 v56, s34, v60
    v_mul_f32 v57, s34, v61
    v_exp_f32 v56, v56
    v_exp_f32 v57, v57
    v_cmp_gt_f32 s[38:39], s36, v60
    v_cmp_gt_f32 s[40:41], s36, v61
    v_add_f32 v62, 1.0, v56
    v_add_f32 v63, 1.0, v57
    v_rcp_f32 v62, v62
    v_rcp_f32 v63, v63
    v_sub_f32 v56, 1.0, v56
    v_sub_f32 v57, 1.0, v57
    v_mul_f32 v56, v56, v62
    v_mul_f32 v57, v57, v63
    v_cndmask_b32 v56, v56, v60, s[38:39]
    v_cndmask_b32 v57, v57, v61, s[40:41]
    v_cvt_pk_bf16_f32 v62, v56, v57
    v_lshlrev_b32 v56, 16, v62
    v_and_b32 v57, 0xffff0000, v62
    v_mul_f32 v56, v156, v56
    v_mul_f32 v57, v157, v57
    v_cvt_pk_bf16_f32 v70, v56, v57
    v_mul_f32 v56, -abs(v158), s32
    v_mul_f32 v57, -abs(v159), s32
    v_exp_f32 v56, v56
    v_exp_f32 v57, v57
    v_max_f32 v60, 0, v158
    v_max_f32 v61, 0, v159
    v_cvt_pk_bf16_f32 v62, v56, v57
    v_lshlrev_b32 v56, 16, v62
    v_and_b32 v57, 0xffff0000, v62
    v_add_f32 v58, 1.0, v56
    v_add_f32 v59, 1.0, v57
    v_log_f32 v58, v58
    v_log_f32 v59, v59
    v_cmp_gt_f32 s[38:39], s35, v56
    v_cmp_gt_f32 s[40:41], s35, v57
    v_mul_f32 v58, s33, v58
    v_mul_f32 v59, s33, v59
    v_cndmask_b32 v58, v58, v56, s[38:39]
    v_cndmask_b32 v59, v59, v57, s[40:41]
    v_cvt_pk_bf16_f32 v62, v58, v59
    v_lshlrev_b32 v58, 16, v62
    v_and_b32 v59, 0xffff0000, v62
    v_add_f32 v60, v60, v58
    v_add_f32 v61, v61, v59
    v_cvt_pk_bf16_f32 v62, v60, v61
    v_lshlrev_b32 v60, 16, v62
    v_and_b32 v61, 0xffff0000, v62
    v_mul_f32 v56, s34, v60
    v_mul_f32 v57, s34, v61
    v_exp_f32 v56, v56
    v_exp_f32 v57, v57
    v_cmp_gt_f32 s[38:39], s36, v60
    v_cmp_gt_f32 s[40:41], s36, v61
    v_add_f32 v62, 1.0, v56
    v_add_f32 v63, 1.0, v57
    v_rcp_f32 v62, v62
    v_rcp_f32 v63, v63
    v_sub_f32 v56, 1.0, v56
    v_sub_f32 v57, 1.0, v57
    v_mul_f32 v56, v56, v62
    v_mul_f32 v57, v57, v63
    v_cndmask_b32 v56, v56, v60, s[38:39]
    v_cndmask_b32 v57, v57, v61, s[40:41]
    v_cvt_pk_bf16_f32 v62, v56, v57
    v_lshlrev_b32 v56, 16, v62
    v_and_b32 v57, 0xffff0000, v62
    v_mul_f32 v56, v158, v56
    v_mul_f32 v57, v159, v57
    v_cvt_pk_bf16_f32 v71, v56, v57
    s_add_u32 s30, s31, 4608
    buffer_store_dwordx4 v[68:71], v74, s[20:23], s30 offen sc1
    v_mul_f32 v56, -abs(v160), s32
    v_mul_f32 v57, -abs(v161), s32
    v_exp_f32 v56, v56
    v_exp_f32 v57, v57
    v_max_f32 v60, 0, v160
    v_max_f32 v61, 0, v161
    v_cvt_pk_bf16_f32 v62, v56, v57
    v_lshlrev_b32 v56, 16, v62
    v_and_b32 v57, 0xffff0000, v62
    v_add_f32 v58, 1.0, v56
    v_add_f32 v59, 1.0, v57
    v_log_f32 v58, v58
    v_log_f32 v59, v59
    v_cmp_gt_f32 s[38:39], s35, v56
    v_cmp_gt_f32 s[40:41], s35, v57
    v_mul_f32 v58, s33, v58
    v_mul_f32 v59, s33, v59
    v_cndmask_b32 v58, v58, v56, s[38:39]
    v_cndmask_b32 v59, v59, v57, s[40:41]
    v_cvt_pk_bf16_f32 v62, v58, v59
    v_lshlrev_b32 v58, 16, v62
    v_and_b32 v59, 0xffff0000, v62
    v_add_f32 v60, v60, v58
    v_add_f32 v61, v61, v59
    v_cvt_pk_bf16_f32 v62, v60, v61
    v_lshlrev_b32 v60, 16, v62
    v_and_b32 v61, 0xffff0000, v62
    v_mul_f32 v56, s34, v60
    v_mul_f32 v57, s34, v61
    v_exp_f32 v56, v56
    v_exp_f32 v57, v57
    v_cmp_gt_f32 s[38:39], s36, v60
    v_cmp_gt_f32 s[40:41], s36, v61
    v_add_f32 v62, 1.0, v56
    v_add_f32 v63, 1.0, v57
    v_rcp_f32 v62, v62
    v_rcp_f32 v63, v63
    v_sub_f32 v56, 1.0, v56
    v_sub_f32 v57, 1.0, v57
    v_mul_f32 v56, v56, v62
    v_mul_f32 v57, v57, v63
    v_cndmask_b32 v56, v56, v60, s[38:39]
    v_cndmask_b32 v57, v57, v61, s[40:41]
    v_cvt_pk_bf16_f32 v62, v56, v57
    v_lshlrev_b32 v56, 16, v62
    v_and_b32 v57, 0xffff0000, v62
    v_mul_f32 v56, v160, v56
    v_mul_f32 v57, v161, v57
    v_cvt_pk_bf16_f32 v64, v56, v57
    v_mul_f32 v56, -abs(v162), s32
    v_mul_f32 v57, -abs(v163), s32
    v_exp_f32 v56, v56
    v_exp_f32 v57, v57
    v_max_f32 v60, 0, v162
    v_max_f32 v61, 0, v163
    v_cvt_pk_bf16_f32 v62, v56, v57
    v_lshlrev_b32 v56, 16, v62
    v_and_b32 v57, 0xffff0000, v62
    v_add_f32 v58, 1.0, v56
    v_add_f32 v59, 1.0, v57
    v_log_f32 v58, v58
    v_log_f32 v59, v59
    v_cmp_gt_f32 s[38:39], s35, v56
    v_cmp_gt_f32 s[40:41], s35, v57
    v_mul_f32 v58, s33, v58
    v_mul_f32 v59, s33, v59
    v_cndmask_b32 v58, v58, v56, s[38:39]
    v_cndmask_b32 v59, v59, v57, s[40:41]
    v_cvt_pk_bf16_f32 v62, v58, v59
    v_lshlrev_b32 v58, 16, v62
    v_and_b32 v59, 0xffff0000, v62
    v_add_f32 v60, v60, v58
    v_add_f32 v61, v61, v59
    v_cvt_pk_bf16_f32 v62, v60, v61
    v_lshlrev_b32 v60, 16, v62
    v_and_b32 v61, 0xffff0000, v62
    v_mul_f32 v56, s34, v60
    v_mul_f32 v57, s34, v61
    v_exp_f32 v56, v56
    v_exp_f32 v57, v57
    v_cmp_gt_f32 s[38:39], s36, v60
    v_cmp_gt_f32 s[40:41], s36, v61
    v_add_f32 v62, 1.0, v56
    v_add_f32 v63, 1.0, v57
    v_rcp_f32 v62, v62
    v_rcp_f32 v63, v63
    v_sub_f32 v56, 1.0, v56
    v_sub_f32 v57, 1.0, v57
    v_mul_f32 v56, v56, v62
    v_mul_f32 v57, v57, v63
    v_cndmask_b32 v56, v56, v60, s[38:39]
    v_cndmask_b32 v57, v57, v61, s[40:41]
    v_cvt_pk_bf16_f32 v62, v56, v57
    v_lshlrev_b32 v56, 16, v62
    v_and_b32 v57, 0xffff0000, v62
    v_mul_f32 v56, v162, v56
    v_mul_f32 v57, v163, v57
    v_cvt_pk_bf16_f32 v65, v56, v57
    v_mul_f32 v56, -abs(v164), s32
    v_mul_f32 v57, -abs(v165), s32
    v_exp_f32 v56, v56
    v_exp_f32 v57, v57
    v_max_f32 v60, 0, v164
    v_max_f32 v61, 0, v165
    v_cvt_pk_bf16_f32 v62, v56, v57
    v_lshlrev_b32 v56, 16, v62
    v_and_b32 v57, 0xffff0000, v62
    v_add_f32 v58, 1.0, v56
    v_add_f32 v59, 1.0, v57
    v_log_f32 v58, v58
    v_log_f32 v59, v59
    v_cmp_gt_f32 s[38:39], s35, v56
    v_cmp_gt_f32 s[40:41], s35, v57
    v_mul_f32 v58, s33, v58
    v_mul_f32 v59, s33, v59
    v_cndmask_b32 v58, v58, v56, s[38:39]
    v_cndmask_b32 v59, v59, v57, s[40:41]
    v_cvt_pk_bf16_f32 v62, v58, v59
    v_lshlrev_b32 v58, 16, v62
    v_and_b32 v59, 0xffff0000, v62
    v_add_f32 v60, v60, v58
    v_add_f32 v61, v61, v59
    v_cvt_pk_bf16_f32 v62, v60, v61
    v_lshlrev_b32 v60, 16, v62
    v_and_b32 v61, 0xffff0000, v62
    v_mul_f32 v56, s34, v60
    v_mul_f32 v57, s34, v61
    v_exp_f32 v56, v56
    v_exp_f32 v57, v57
    v_cmp_gt_f32 s[38:39], s36, v60
    v_cmp_gt_f32 s[40:41], s36, v61
    v_add_f32 v62, 1.0, v56
    v_add_f32 v63, 1.0, v57
    v_rcp_f32 v62, v62
    v_rcp_f32 v63, v63
    v_sub_f32 v56, 1.0, v56
    v_sub_f32 v57, 1.0, v57
    v_mul_f32 v56, v56, v62
    v_mul_f32 v57, v57, v63
    v_cndmask_b32 v56, v56, v60, s[38:39]
    v_cndmask_b32 v57, v57, v61, s[40:41]
    v_cvt_pk_bf16_f32 v62, v56, v57
    v_lshlrev_b32 v56, 16, v62
    v_and_b32 v57, 0xffff0000, v62
    v_mul_f32 v56, v164, v56
    v_mul_f32 v57, v165, v57
    v_cvt_pk_bf16_f32 v66, v56, v57
    v_mul_f32 v56, -abs(v166), s32
    v_mul_f32 v57, -abs(v167), s32
    v_exp_f32 v56, v56
    v_exp_f32 v57, v57
    v_max_f32 v60, 0, v166
    v_max_f32 v61, 0, v167
    v_cvt_pk_bf16_f32 v62, v56, v57
    v_lshlrev_b32 v56, 16, v62
    v_and_b32 v57, 0xffff0000, v62
    v_add_f32 v58, 1.0, v56
    v_add_f32 v59, 1.0, v57
    v_log_f32 v58, v58
    v_log_f32 v59, v59
    v_cmp_gt_f32 s[38:39], s35, v56
    v_cmp_gt_f32 s[40:41], s35, v57
    v_mul_f32 v58, s33, v58
    v_mul_f32 v59, s33, v59
    v_cndmask_b32 v58, v58, v56, s[38:39]
    v_cndmask_b32 v59, v59, v57, s[40:41]
    v_cvt_pk_bf16_f32 v62, v58, v59
    v_lshlrev_b32 v58, 16, v62
    v_and_b32 v59, 0xffff0000, v62
    v_add_f32 v60, v60, v58
    v_add_f32 v61, v61, v59
    v_cvt_pk_bf16_f32 v62, v60, v61
    v_lshlrev_b32 v60, 16, v62
    v_and_b32 v61, 0xffff0000, v62
    v_mul_f32 v56, s34, v60
    v_mul_f32 v57, s34, v61
    v_exp_f32 v56, v56
    v_exp_f32 v57, v57
    v_cmp_gt_f32 s[38:39], s36, v60
    v_cmp_gt_f32 s[40:41], s36, v61
    v_add_f32 v62, 1.0, v56
    v_add_f32 v63, 1.0, v57
    v_rcp_f32 v62, v62
    v_rcp_f32 v63, v63
    v_sub_f32 v56, 1.0, v56
    v_sub_f32 v57, 1.0, v57
    v_mul_f32 v56, v56, v62
    v_mul_f32 v57, v57, v63
    v_cndmask_b32 v56, v56, v60, s[38:39]
    v_cndmask_b32 v57, v57, v61, s[40:41]
    v_cvt_pk_bf16_f32 v62, v56, v57
    v_lshlrev_b32 v56, 16, v62
    v_and_b32 v57, 0xffff0000, v62
    v_mul_f32 v56, v166, v56
    v_mul_f32 v57, v167, v57
    v_cvt_pk_bf16_f32 v67, v56, v57
    s_add_u32 s30, s31, 2048
    buffer_store_dwordx4 v[64:67], v74, s[20:23], s30 offen sc1
    v_mul_f32 v56, -abs(v168), s32
    v_mul_f32 v57, -abs(v169), s32
    v_exp_f32 v56, v56
    v_exp_f32 v57, v57
    v_max_f32 v60, 0, v168
    v_max_f32 v61, 0, v169
    v_cvt_pk_bf16_f32 v62, v56, v57
    v_lshlrev_b32 v56, 16, v62
    v_and_b32 v57, 0xffff0000, v62
    v_add_f32 v58, 1.0, v56
    v_add_f32 v59, 1.0, v57
    v_log_f32 v58, v58
    v_log_f32 v59, v59
    v_cmp_gt_f32 s[38:39], s35, v56
    v_cmp_gt_f32 s[40:41], s35, v57
    v_mul_f32 v58, s33, v58
    v_mul_f32 v59, s33, v59
    v_cndmask_b32 v58, v58, v56, s[38:39]
    v_cndmask_b32 v59, v59, v57, s[40:41]
    v_cvt_pk_bf16_f32 v62, v58, v59
    v_lshlrev_b32 v58, 16, v62
    v_and_b32 v59, 0xffff0000, v62
    v_add_f32 v60, v60, v58
    v_add_f32 v61, v61, v59
    v_cvt_pk_bf16_f32 v62, v60, v61
    v_lshlrev_b32 v60, 16, v62
    v_and_b32 v61, 0xffff0000, v62
    v_mul_f32 v56, s34, v60
    v_mul_f32 v57, s34, v61
    v_exp_f32 v56, v56
    v_exp_f32 v57, v57
    v_cmp_gt_f32 s[38:39], s36, v60
    v_cmp_gt_f32 s[40:41], s36, v61
    v_add_f32 v62, 1.0, v56
    v_add_f32 v63, 1.0, v57
    v_rcp_f32 v62, v62
    v_rcp_f32 v63, v63
    v_sub_f32 v56, 1.0, v56
    v_sub_f32 v57, 1.0, v57
    v_mul_f32 v56, v56, v62
    v_mul_f32 v57, v57, v63
    v_cndmask_b32 v56, v56, v60, s[38:39]
    v_cndmask_b32 v57, v57, v61, s[40:41]
    v_cvt_pk_bf16_f32 v62, v56, v57
    v_lshlrev_b32 v56, 16, v62
    v_and_b32 v57, 0xffff0000, v62
    v_mul_f32 v56, v168, v56
    v_mul_f32 v57, v169, v57
    v_cvt_pk_bf16_f32 v68, v56, v57
    v_mul_f32 v56, -abs(v170), s32
    v_mul_f32 v57, -abs(v171), s32
    v_exp_f32 v56, v56
    v_exp_f32 v57, v57
    v_max_f32 v60, 0, v170
    v_max_f32 v61, 0, v171
    v_cvt_pk_bf16_f32 v62, v56, v57
    v_lshlrev_b32 v56, 16, v62
    v_and_b32 v57, 0xffff0000, v62
    v_add_f32 v58, 1.0, v56
    v_add_f32 v59, 1.0, v57
    v_log_f32 v58, v58
    v_log_f32 v59, v59
    v_cmp_gt_f32 s[38:39], s35, v56
    v_cmp_gt_f32 s[40:41], s35, v57
    v_mul_f32 v58, s33, v58
    v_mul_f32 v59, s33, v59
    v_cndmask_b32 v58, v58, v56, s[38:39]
    v_cndmask_b32 v59, v59, v57, s[40:41]
    v_cvt_pk_bf16_f32 v62, v58, v59
    v_lshlrev_b32 v58, 16, v62
    v_and_b32 v59, 0xffff0000, v62
    v_add_f32 v60, v60, v58
    v_add_f32 v61, v61, v59
    v_cvt_pk_bf16_f32 v62, v60, v61
    v_lshlrev_b32 v60, 16, v62
    v_and_b32 v61, 0xffff0000, v62
    v_mul_f32 v56, s34, v60
    v_mul_f32 v57, s34, v61
    v_exp_f32 v56, v56
    v_exp_f32 v57, v57
    v_cmp_gt_f32 s[38:39], s36, v60
    v_cmp_gt_f32 s[40:41], s36, v61
    v_add_f32 v62, 1.0, v56
    v_add_f32 v63, 1.0, v57
    v_rcp_f32 v62, v62
    v_rcp_f32 v63, v63
    v_sub_f32 v56, 1.0, v56
    v_sub_f32 v57, 1.0, v57
    v_mul_f32 v56, v56, v62
    v_mul_f32 v57, v57, v63
    v_cndmask_b32 v56, v56, v60, s[38:39]
    v_cndmask_b32 v57, v57, v61, s[40:41]
    v_cvt_pk_bf16_f32 v62, v56, v57
    v_lshlrev_b32 v56, 16, v62
    v_and_b32 v57, 0xffff0000, v62
    v_mul_f32 v56, v170, v56
    v_mul_f32 v57, v171, v57
    v_cvt_pk_bf16_f32 v69, v56, v57
    v_mul_f32 v56, -abs(v172), s32
    v_mul_f32 v57, -abs(v173), s32
    v_exp_f32 v56, v56
    v_exp_f32 v57, v57
    v_max_f32 v60, 0, v172
    v_max_f32 v61, 0, v173
    v_cvt_pk_bf16_f32 v62, v56, v57
    v_lshlrev_b32 v56, 16, v62
    v_and_b32 v57, 0xffff0000, v62
    v_add_f32 v58, 1.0, v56
    v_add_f32 v59, 1.0, v57
    v_log_f32 v58, v58
    v_log_f32 v59, v59
    v_cmp_gt_f32 s[38:39], s35, v56
    v_cmp_gt_f32 s[40:41], s35, v57
    v_mul_f32 v58, s33, v58
    v_mul_f32 v59, s33, v59
    v_cndmask_b32 v58, v58, v56, s[38:39]
    v_cndmask_b32 v59, v59, v57, s[40:41]
    v_cvt_pk_bf16_f32 v62, v58, v59
    v_lshlrev_b32 v58, 16, v62
    v_and_b32 v59, 0xffff0000, v62
    v_add_f32 v60, v60, v58
    v_add_f32 v61, v61, v59
    v_cvt_pk_bf16_f32 v62, v60, v61
    v_lshlrev_b32 v60, 16, v62
    v_and_b32 v61, 0xffff0000, v62
    v_mul_f32 v56, s34, v60
    v_mul_f32 v57, s34, v61
    v_exp_f32 v56, v56
    v_exp_f32 v57, v57
    v_cmp_gt_f32 s[38:39], s36, v60
    v_cmp_gt_f32 s[40:41], s36, v61
    v_add_f32 v62, 1.0, v56
    v_add_f32 v63, 1.0, v57
    v_rcp_f32 v62, v62
    v_rcp_f32 v63, v63
    v_sub_f32 v56, 1.0, v56
    v_sub_f32 v57, 1.0, v57
    v_mul_f32 v56, v56, v62
    v_mul_f32 v57, v57, v63
    v_cndmask_b32 v56, v56, v60, s[38:39]
    v_cndmask_b32 v57, v57, v61, s[40:41]
    v_cvt_pk_bf16_f32 v62, v56, v57
    v_lshlrev_b32 v56, 16, v62
    v_and_b32 v57, 0xffff0000, v62
    v_mul_f32 v56, v172, v56
    v_mul_f32 v57, v173, v57
    v_cvt_pk_bf16_f32 v70, v56, v57
    v_mul_f32 v56, -abs(v174), s32
    v_mul_f32 v57, -abs(v175), s32
    v_exp_f32 v56, v56
    v_exp_f32 v57, v57
    v_max_f32 v60, 0, v174
    v_max_f32 v61, 0, v175
    v_cvt_pk_bf16_f32 v62, v56, v57
    v_lshlrev_b32 v56, 16, v62
    v_and_b32 v57, 0xffff0000, v62
    v_add_f32 v58, 1.0, v56
    v_add_f32 v59, 1.0, v57
    v_log_f32 v58, v58
    v_log_f32 v59, v59
    v_cmp_gt_f32 s[38:39], s35, v56
    v_cmp_gt_f32 s[40:41], s35, v57
    v_mul_f32 v58, s33, v58
    v_mul_f32 v59, s33, v59
    v_cndmask_b32 v58, v58, v56, s[38:39]
    v_cndmask_b32 v59, v59, v57, s[40:41]
    v_cvt_pk_bf16_f32 v62, v58, v59
    v_lshlrev_b32 v58, 16, v62
    v_and_b32 v59, 0xffff0000, v62
    v_add_f32 v60, v60, v58
    v_add_f32 v61, v61, v59
    v_cvt_pk_bf16_f32 v62, v60, v61
    v_lshlrev_b32 v60, 16, v62
    v_and_b32 v61, 0xffff0000, v62
    v_mul_f32 v56, s34, v60
    v_mul_f32 v57, s34, v61
    v_exp_f32 v56, v56
    v_exp_f32 v57, v57
    v_cmp_gt_f32 s[38:39], s36, v60
    v_cmp_gt_f32 s[40:41], s36, v61
    v_add_f32 v62, 1.0, v56
    v_add_f32 v63, 1.0, v57
    v_rcp_f32 v62, v62
    v_rcp_f32 v63, v63
    v_sub_f32 v56, 1.0, v56
    v_sub_f32 v57, 1.0, v57
    v_mul_f32 v56, v56, v62
    v_mul_f32 v57, v57, v63
    v_cndmask_b32 v56, v56, v60, s[38:39]
    v_cndmask_b32 v57, v57, v61, s[40:41]
    v_cvt_pk_bf16_f32 v62, v56, v57
    v_lshlrev_b32 v56, 16, v62
    v_and_b32 v57, 0xffff0000, v62
    v_mul_f32 v56, v174, v56
    v_mul_f32 v57, v175, v57
    v_cvt_pk_bf16_f32 v71, v56, v57
    s_add_u32 s30, s31, 2560
    buffer_store_dwordx4 v[68:71], v74, s[20:23], s30 offen sc1
    v_mul_f32 v56, -abs(v176), s32
    v_mul_f32 v57, -abs(v177), s32
    v_exp_f32 v56, v56
    v_exp_f32 v57, v57
    v_max_f32 v60, 0, v176
    v_max_f32 v61, 0, v177
    v_cvt_pk_bf16_f32 v62, v56, v57
    v_lshlrev_b32 v56, 16, v62
    v_and_b32 v57, 0xffff0000, v62
    v_add_f32 v58, 1.0, v56
    v_add_f32 v59, 1.0, v57
    v_log_f32 v58, v58
    v_log_f32 v59, v59
    v_cmp_gt_f32 s[38:39], s35, v56
    v_cmp_gt_f32 s[40:41], s35, v57
    v_mul_f32 v58, s33, v58
    v_mul_f32 v59, s33, v59
    v_cndmask_b32 v58, v58, v56, s[38:39]
    v_cndmask_b32 v59, v59, v57, s[40:41]
    v_cvt_pk_bf16_f32 v62, v58, v59
    v_lshlrev_b32 v58, 16, v62
    v_and_b32 v59, 0xffff0000, v62
    v_add_f32 v60, v60, v58
    v_add_f32 v61, v61, v59
    v_cvt_pk_bf16_f32 v62, v60, v61
    v_lshlrev_b32 v60, 16, v62
    v_and_b32 v61, 0xffff0000, v62
    v_mul_f32 v56, s34, v60
    v_mul_f32 v57, s34, v61
    v_exp_f32 v56, v56
    v_exp_f32 v57, v57
    v_cmp_gt_f32 s[38:39], s36, v60
    v_cmp_gt_f32 s[40:41], s36, v61
    v_add_f32 v62, 1.0, v56
    v_add_f32 v63, 1.0, v57
    v_rcp_f32 v62, v62
    v_rcp_f32 v63, v63
    v_sub_f32 v56, 1.0, v56
    v_sub_f32 v57, 1.0, v57
    v_mul_f32 v56, v56, v62
    v_mul_f32 v57, v57, v63
    v_cndmask_b32 v56, v56, v60, s[38:39]
    v_cndmask_b32 v57, v57, v61, s[40:41]
    v_cvt_pk_bf16_f32 v62, v56, v57
    v_lshlrev_b32 v56, 16, v62
    v_and_b32 v57, 0xffff0000, v62
    v_mul_f32 v56, v176, v56
    v_mul_f32 v57, v177, v57
    v_cvt_pk_bf16_f32 v64, v56, v57
    v_mul_f32 v56, -abs(v178), s32
    v_mul_f32 v57, -abs(v179), s32
    v_exp_f32 v56, v56
    v_exp_f32 v57, v57
    v_max_f32 v60, 0, v178
    v_max_f32 v61, 0, v179
    v_cvt_pk_bf16_f32 v62, v56, v57
    v_lshlrev_b32 v56, 16, v62
    v_and_b32 v57, 0xffff0000, v62
    v_add_f32 v58, 1.0, v56
    v_add_f32 v59, 1.0, v57
    v_log_f32 v58, v58
    v_log_f32 v59, v59
    v_cmp_gt_f32 s[38:39], s35, v56
    v_cmp_gt_f32 s[40:41], s35, v57
    v_mul_f32 v58, s33, v58
    v_mul_f32 v59, s33, v59
    v_cndmask_b32 v58, v58, v56, s[38:39]
    v_cndmask_b32 v59, v59, v57, s[40:41]
    v_cvt_pk_bf16_f32 v62, v58, v59
    v_lshlrev_b32 v58, 16, v62
    v_and_b32 v59, 0xffff0000, v62
    v_add_f32 v60, v60, v58
    v_add_f32 v61, v61, v59
    v_cvt_pk_bf16_f32 v62, v60, v61
    v_lshlrev_b32 v60, 16, v62
    v_and_b32 v61, 0xffff0000, v62
    v_mul_f32 v56, s34, v60
    v_mul_f32 v57, s34, v61
    v_exp_f32 v56, v56
    v_exp_f32 v57, v57
    v_cmp_gt_f32 s[38:39], s36, v60
    v_cmp_gt_f32 s[40:41], s36, v61
    v_add_f32 v62, 1.0, v56
    v_add_f32 v63, 1.0, v57
    v_rcp_f32 v62, v62
    v_rcp_f32 v63, v63
    v_sub_f32 v56, 1.0, v56
    v_sub_f32 v57, 1.0, v57
    v_mul_f32 v56, v56, v62
    v_mul_f32 v57, v57, v63
    v_cndmask_b32 v56, v56, v60, s[38:39]
    v_cndmask_b32 v57, v57, v61, s[40:41]
    v_cvt_pk_bf16_f32 v62, v56, v57
    v_lshlrev_b32 v56, 16, v62
    v_and_b32 v57, 0xffff0000, v62
    v_mul_f32 v56, v178, v56
    v_mul_f32 v57, v179, v57
    v_cvt_pk_bf16_f32 v65, v56, v57
    v_mul_f32 v56, -abs(v180), s32
    v_mul_f32 v57, -abs(v181), s32
    v_exp_f32 v56, v56
    v_exp_f32 v57, v57
    v_max_f32 v60, 0, v180
    v_max_f32 v61, 0, v181
    v_cvt_pk_bf16_f32 v62, v56, v57
    v_lshlrev_b32 v56, 16, v62
    v_and_b32 v57, 0xffff0000, v62
    v_add_f32 v58, 1.0, v56
    v_add_f32 v59, 1.0, v57
    v_log_f32 v58, v58
    v_log_f32 v59, v59
    v_cmp_gt_f32 s[38:39], s35, v56
    v_cmp_gt_f32 s[40:41], s35, v57
    v_mul_f32 v58, s33, v58
    v_mul_f32 v59, s33, v59
    v_cndmask_b32 v58, v58, v56, s[38:39]
    v_cndmask_b32 v59, v59, v57, s[40:41]
    v_cvt_pk_bf16_f32 v62, v58, v59
    v_lshlrev_b32 v58, 16, v62
    v_and_b32 v59, 0xffff0000, v62
    v_add_f32 v60, v60, v58
    v_add_f32 v61, v61, v59
    v_cvt_pk_bf16_f32 v62, v60, v61
    v_lshlrev_b32 v60, 16, v62
    v_and_b32 v61, 0xffff0000, v62
    v_mul_f32 v56, s34, v60
    v_mul_f32 v57, s34, v61
    v_exp_f32 v56, v56
    v_exp_f32 v57, v57
    v_cmp_gt_f32 s[38:39], s36, v60
    v_cmp_gt_f32 s[40:41], s36, v61
    v_add_f32 v62, 1.0, v56
    v_add_f32 v63, 1.0, v57
    v_rcp_f32 v62, v62
    v_rcp_f32 v63, v63
    v_sub_f32 v56, 1.0, v56
    v_sub_f32 v57, 1.0, v57
    v_mul_f32 v56, v56, v62
    v_mul_f32 v57, v57, v63
    v_cndmask_b32 v56, v56, v60, s[38:39]
    v_cndmask_b32 v57, v57, v61, s[40:41]
    v_cvt_pk_bf16_f32 v62, v56, v57
    v_lshlrev_b32 v56, 16, v62
    v_and_b32 v57, 0xffff0000, v62
    v_mul_f32 v56, v180, v56
    v_mul_f32 v57, v181, v57
    v_cvt_pk_bf16_f32 v66, v56, v57
    v_mul_f32 v56, -abs(v182), s32
    v_mul_f32 v57, -abs(v183), s32
    v_exp_f32 v56, v56
    v_exp_f32 v57, v57
    v_max_f32 v60, 0, v182
    v_max_f32 v61, 0, v183
    v_cvt_pk_bf16_f32 v62, v56, v57
    v_lshlrev_b32 v56, 16, v62
    v_and_b32 v57, 0xffff0000, v62
    v_add_f32 v58, 1.0, v56
    v_add_f32 v59, 1.0, v57
    v_log_f32 v58, v58
    v_log_f32 v59, v59
    v_cmp_gt_f32 s[38:39], s35, v56
    v_cmp_gt_f32 s[40:41], s35, v57
    v_mul_f32 v58, s33, v58
    v_mul_f32 v59, s33, v59
    v_cndmask_b32 v58, v58, v56, s[38:39]
    v_cndmask_b32 v59, v59, v57, s[40:41]
    v_cvt_pk_bf16_f32 v62, v58, v59
    v_lshlrev_b32 v58, 16, v62
    v_and_b32 v59, 0xffff0000, v62
    v_add_f32 v60, v60, v58
    v_add_f32 v61, v61, v59
    v_cvt_pk_bf16_f32 v62, v60, v61
    v_lshlrev_b32 v60, 16, v62
    v_and_b32 v61, 0xffff0000, v62
    v_mul_f32 v56, s34, v60
    v_mul_f32 v57, s34, v61
    v_exp_f32 v56, v56
    v_exp_f32 v57, v57
    v_cmp_gt_f32 s[38:39], s36, v60
    v_cmp_gt_f32 s[40:41], s36, v61
    v_add_f32 v62, 1.0, v56
    v_add_f32 v63, 1.0, v57
    v_rcp_f32 v62, v62
    v_rcp_f32 v63, v63
    v_sub_f32 v56, 1.0, v56
    v_sub_f32 v57, 1.0, v57
    v_mul_f32 v56, v56, v62
    v_mul_f32 v57, v57, v63
    v_cndmask_b32 v56, v56, v60, s[38:39]
    v_cndmask_b32 v57, v57, v61, s[40:41]
    v_cvt_pk_bf16_f32 v62, v56, v57
    v_lshlrev_b32 v56, 16, v62
    v_and_b32 v57, 0xffff0000, v62
    v_mul_f32 v56, v182, v56
    v_mul_f32 v57, v183, v57
    v_cvt_pk_bf16_f32 v67, v56, v57
    s_add_u32 s30, s31, 6144
    buffer_store_dwordx4 v[64:67], v74, s[20:23], s30 offen sc1
    v_mul_f32 v56, -abs(v184), s32
    v_mul_f32 v57, -abs(v185), s32
    v_exp_f32 v56, v56
    v_exp_f32 v57, v57
    v_max_f32 v60, 0, v184
    v_max_f32 v61, 0, v185
    v_cvt_pk_bf16_f32 v62, v56, v57
    v_lshlrev_b32 v56, 16, v62
    v_and_b32 v57, 0xffff0000, v62
    v_add_f32 v58, 1.0, v56
    v_add_f32 v59, 1.0, v57
    v_log_f32 v58, v58
    v_log_f32 v59, v59
    v_cmp_gt_f32 s[38:39], s35, v56
    v_cmp_gt_f32 s[40:41], s35, v57
    v_mul_f32 v58, s33, v58
    v_mul_f32 v59, s33, v59
    v_cndmask_b32 v58, v58, v56, s[38:39]
    v_cndmask_b32 v59, v59, v57, s[40:41]
    v_cvt_pk_bf16_f32 v62, v58, v59
    v_lshlrev_b32 v58, 16, v62
    v_and_b32 v59, 0xffff0000, v62
    v_add_f32 v60, v60, v58
    v_add_f32 v61, v61, v59
    v_cvt_pk_bf16_f32 v62, v60, v61
    v_lshlrev_b32 v60, 16, v62
    v_and_b32 v61, 0xffff0000, v62
    v_mul_f32 v56, s34, v60
    v_mul_f32 v57, s34, v61
    v_exp_f32 v56, v56
    v_exp_f32 v57, v57
    v_cmp_gt_f32 s[38:39], s36, v60
    v_cmp_gt_f32 s[40:41], s36, v61
    v_add_f32 v62, 1.0, v56
    v_add_f32 v63, 1.0, v57
    v_rcp_f32 v62, v62
    v_rcp_f32 v63, v63
    v_sub_f32 v56, 1.0, v56
    v_sub_f32 v57, 1.0, v57
    v_mul_f32 v56, v56, v62
    v_mul_f32 v57, v57, v63
    v_cndmask_b32 v56, v56, v60, s[38:39]
    v_cndmask_b32 v57, v57, v61, s[40:41]
    v_cvt_pk_bf16_f32 v62, v56, v57
    v_lshlrev_b32 v56, 16, v62
    v_and_b32 v57, 0xffff0000, v62
    v_mul_f32 v56, v184, v56
    v_mul_f32 v57, v185, v57
    v_cvt_pk_bf16_f32 v68, v56, v57
    v_mul_f32 v56, -abs(v186), s32
    v_mul_f32 v57, -abs(v187), s32
    v_exp_f32 v56, v56
    v_exp_f32 v57, v57
    v_max_f32 v60, 0, v186
    v_max_f32 v61, 0, v187
    v_cvt_pk_bf16_f32 v62, v56, v57
    v_lshlrev_b32 v56, 16, v62
    v_and_b32 v57, 0xffff0000, v62
    v_add_f32 v58, 1.0, v56
    v_add_f32 v59, 1.0, v57
    v_log_f32 v58, v58
    v_log_f32 v59, v59
    v_cmp_gt_f32 s[38:39], s35, v56
    v_cmp_gt_f32 s[40:41], s35, v57
    v_mul_f32 v58, s33, v58
    v_mul_f32 v59, s33, v59
    v_cndmask_b32 v58, v58, v56, s[38:39]
    v_cndmask_b32 v59, v59, v57, s[40:41]
    v_cvt_pk_bf16_f32 v62, v58, v59
    v_lshlrev_b32 v58, 16, v62
    v_and_b32 v59, 0xffff0000, v62
    v_add_f32 v60, v60, v58
    v_add_f32 v61, v61, v59
    v_cvt_pk_bf16_f32 v62, v60, v61
    v_lshlrev_b32 v60, 16, v62
    v_and_b32 v61, 0xffff0000, v62
    v_mul_f32 v56, s34, v60
    v_mul_f32 v57, s34, v61
    v_exp_f32 v56, v56
    v_exp_f32 v57, v57
    v_cmp_gt_f32 s[38:39], s36, v60
    v_cmp_gt_f32 s[40:41], s36, v61
    v_add_f32 v62, 1.0, v56
    v_add_f32 v63, 1.0, v57
    v_rcp_f32 v62, v62
    v_rcp_f32 v63, v63
    v_sub_f32 v56, 1.0, v56
    v_sub_f32 v57, 1.0, v57
    v_mul_f32 v56, v56, v62
    v_mul_f32 v57, v57, v63
    v_cndmask_b32 v56, v56, v60, s[38:39]
    v_cndmask_b32 v57, v57, v61, s[40:41]
    v_cvt_pk_bf16_f32 v62, v56, v57
    v_lshlrev_b32 v56, 16, v62
    v_and_b32 v57, 0xffff0000, v62
    v_mul_f32 v56, v186, v56
    v_mul_f32 v57, v187, v57
    v_cvt_pk_bf16_f32 v69, v56, v57
    v_mul_f32 v56, -abs(v188), s32
    v_mul_f32 v57, -abs(v189), s32
    v_exp_f32 v56, v56
    v_exp_f32 v57, v57
    v_max_f32 v60, 0, v188
    v_max_f32 v61, 0, v189
    v_cvt_pk_bf16_f32 v62, v56, v57
    v_lshlrev_b32 v56, 16, v62
    v_and_b32 v57, 0xffff0000, v62
    v_add_f32 v58, 1.0, v56
    v_add_f32 v59, 1.0, v57
    v_log_f32 v58, v58
    v_log_f32 v59, v59
    v_cmp_gt_f32 s[38:39], s35, v56
    v_cmp_gt_f32 s[40:41], s35, v57
    v_mul_f32 v58, s33, v58
    v_mul_f32 v59, s33, v59
    v_cndmask_b32 v58, v58, v56, s[38:39]
    v_cndmask_b32 v59, v59, v57, s[40:41]
    v_cvt_pk_bf16_f32 v62, v58, v59
    v_lshlrev_b32 v58, 16, v62
    v_and_b32 v59, 0xffff0000, v62
    v_add_f32 v60, v60, v58
    v_add_f32 v61, v61, v59
    v_cvt_pk_bf16_f32 v62, v60, v61
    v_lshlrev_b32 v60, 16, v62
    v_and_b32 v61, 0xffff0000, v62
    v_mul_f32 v56, s34, v60
    v_mul_f32 v57, s34, v61
    v_exp_f32 v56, v56
    v_exp_f32 v57, v57
    v_cmp_gt_f32 s[38:39], s36, v60
    v_cmp_gt_f32 s[40:41], s36, v61
    v_add_f32 v62, 1.0, v56
    v_add_f32 v63, 1.0, v57
    v_rcp_f32 v62, v62
    v_rcp_f32 v63, v63
    v_sub_f32 v56, 1.0, v56
    v_sub_f32 v57, 1.0, v57
    v_mul_f32 v56, v56, v62
    v_mul_f32 v57, v57, v63
    v_cndmask_b32 v56, v56, v60, s[38:39]
    v_cndmask_b32 v57, v57, v61, s[40:41]
    v_cvt_pk_bf16_f32 v62, v56, v57
    v_lshlrev_b32 v56, 16, v62
    v_and_b32 v57, 0xffff0000, v62
    v_mul_f32 v56, v188, v56
    v_mul_f32 v57, v189, v57
    v_cvt_pk_bf16_f32 v70, v56, v57
    v_mul_f32 v56, -abs(v190), s32
    v_mul_f32 v57, -abs(v191), s32
    v_exp_f32 v56, v56
    v_exp_f32 v57, v57
    v_max_f32 v60, 0, v190
    v_max_f32 v61, 0, v191
    v_cvt_pk_bf16_f32 v62, v56, v57
    v_lshlrev_b32 v56, 16, v62
    v_and_b32 v57, 0xffff0000, v62
    v_add_f32 v58, 1.0, v56
    v_add_f32 v59, 1.0, v57
    v_log_f32 v58, v58
    v_log_f32 v59, v59
    v_cmp_gt_f32 s[38:39], s35, v56
    v_cmp_gt_f32 s[40:41], s35, v57
    v_mul_f32 v58, s33, v58
    v_mul_f32 v59, s33, v59
    v_cndmask_b32 v58, v58, v56, s[38:39]
    v_cndmask_b32 v59, v59, v57, s[40:41]
    v_cvt_pk_bf16_f32 v62, v58, v59
    v_lshlrev_b32 v58, 16, v62
    v_and_b32 v59, 0xffff0000, v62
    v_add_f32 v60, v60, v58
    v_add_f32 v61, v61, v59
    v_cvt_pk_bf16_f32 v62, v60, v61
    v_lshlrev_b32 v60, 16, v62
    v_and_b32 v61, 0xffff0000, v62
    v_mul_f32 v56, s34, v60
    v_mul_f32 v57, s34, v61
    v_exp_f32 v56, v56
    v_exp_f32 v57, v57
    v_cmp_gt_f32 s[38:39], s36, v60
    v_cmp_gt_f32 s[40:41], s36, v61
    v_add_f32 v62, 1.0, v56
    v_add_f32 v63, 1.0, v57
    v_rcp_f32 v62, v62
    v_rcp_f32 v63, v63
    v_sub_f32 v56, 1.0, v56
    v_sub_f32 v57, 1.0, v57
    v_mul_f32 v56, v56, v62
    v_mul_f32 v57, v57, v63
    v_cndmask_b32 v56, v56, v60, s[38:39]
    v_cndmask_b32 v57, v57, v61, s[40:41]
    v_cvt_pk_bf16_f32 v62, v56, v57
    v_lshlrev_b32 v56, 16, v62
    v_and_b32 v57, 0xffff0000, v62
    v_mul_f32 v56, v190, v56
    v_mul_f32 v57, v191, v57
    v_cvt_pk_bf16_f32 v71, v56, v57
    s_add_u32 s30, s31, 6656
    buffer_store_dwordx4 v[68:71], v74, s[20:23], s30 offen sc1
K1_MLP_DONEC:
K1_END:
    s_endpgm
.p2align 8
k3_kernel:
    s_cmp_ge_u32 s2, 256
    s_cbranch_scc1 K3_END
    s_load_dwordx2 s[6:7], s[0:1], 128
    s_load_dwordx2 s[4:5], s[0:1], 0
    s_load_dwordx2 s[32:33], s[0:1], 64
    s_load_dwordx2 s[34:35], s[0:1], 112
    v_lshrrev_b32 v2, 6, v0
    v_and_b32 v1, 63, v0
    v_readfirstlane_b32 s3, v2
    s_and_b32 s24, s2, 31
    s_lshr_b32 s25, s2, 5
    v_lshlrev_b32 v2, 4, v1
    v_add_u32 v3, 4096, v2
    s_lshl_b32 s30, s24, 6
    s_lshl_b32 s31, s3, 4
    s_add_u32 s30, s30, s31
    v_lshrrev_b32 v5, 4, v1
    v_lshlrev_b32 v5, 2, v5
    v_add_u32 v5, s30, v5
    v_lshlrev_b32 v6, 3, v5
    v_add_u32 v6, 34603008, v6
    s_mul_i32 s30, s25, 80
    v_and_b32 v8, 15, v1
    v_add_u32 v8, s30, v8
    v_lshlrev_b32 v9, 1, v8
    s_movk_i32 s30, 1280
    v_mul_lo_u32 v10, v5, s30
    v_add_u32 v10, v10, v9
    v_lshlrev_b32 v11, 1, v10
    s_waitcnt lgkmcnt(0)
    s_mov_b32 s20, s6
    s_and_b32 s21, s7, 0xffff
    s_mov_b32 s22, 67108864
    s_mov_b32 s23, 0x00020000
    s_mov_b32 s8, s4
    s_and_b32 s9, s5, 0xffff
    s_mov_b32 s10, 2621440
    s_mov_b32 s11, 0x00020000
    s_mov_b32 s12, s34
    s_and_b32 s13, s35, 0xffff
    s_mov_b32 s14, 5242880
    s_mov_b32 s15, 0x00020000
    buffer_load_dwordx4 v[196:199], v6, s[20:23], 0 offen
    buffer_load_dwordx4 v[200:203], v6, s[20:23], 0 offen offset:16
    global_load_ushort v204, v9, s[32:33] offset:0
    global_load_ushort v205, v9, s[32:33] offset:32
    global_load_ushort v206, v9, s[32:33] offset:64
    global_load_ushort v207, v9, s[32:33] offset:96
    global_load_ushort v208, v9, s[32:33] offset:128
    s_mov_b32 s30, 0
    buffer_load_ushort v210, v10, s[8:11], s30 offen offset:0
    buffer_load_ushort v214, v10, s[8:11], s30 offen offset:32
    buffer_load_ushort v218, v10, s[8:11], s30 offen offset:64
    buffer_load_ushort v222, v10, s[8:11], s30 offen offset:96
    buffer_load_ushort v226, v10, s[8:11], s30 offen offset:128
    s_mov_b32 s30, 1280
    buffer_load_ushort v211, v10, s[8:11], s30 offen offset:0
    buffer_load_ushort v215, v10, s[8:11], s30 offen offset:32
    buffer_load_ushort v219, v10, s[8:11], s30 offen offset:64
    buffer_load_ushort v223, v10, s[8:11], s30 offen offset:96
    buffer_load_ushort v227, v10, s[8:11], s30 offen offset:128
    s_mov_b32 s30, 2560
    buffer_load_ushort v212, v10, s[8:11], s30 offen offset:0
    buffer_load_ushort v216, v10, s[8:11], s30 offen offset:32
    buffer_load_ushort v220, v10, s[8:11], s30 offen offset:64
    buffer_load_ushort v224, v10, s[8:11], s30 offen offset:96
    buffer_load_ushort v228, v10, s[8:11], s30 offen offset:128
    s_mov_b32 s30, 3840
    buffer_load_ushort v213, v10, s[8:11], s30 offen offset:0
    buffer_load_ushort v217, v10, s[8:11], s30 offen offset:32
    buffer_load_ushort v221, v10, s[8:11], s30 offen offset:64
    buffer_load_ushort v225, v10, s[8:11], s30 offen offset:96
    buffer_load_ushort v229, v10, s[8:11], s30 offen offset:128
    s_and_b32 s31, s3, 1
    s_cmp_ge_u32 s3, 2
    s_cbranch_scc1 K3_H
    s_mul_i32 s26, s24, 48
    s_mul_i32 s30, s31, 24
    s_add_u32 s26, s26, s30
    s_lshl_b32 s26, s26, 12
    s_add_u32 s26, s26, 0
    s_mul_i32 s27, s25, 48
    s_add_u32 s27, s27, s30
    s_mul_i32 s27, s27, 5120
    s_add_u32 s27, s27, 16777216
    buffer_load_dwordx4 v[16:19], v2, s[20:23], s26 offen offset:0
    buffer_load_dwordx4 v[20:23], v2, s[20:23], s26 offen offset:1024
    buffer_load_dwordx4 v[24:27], v2, s[20:23], s26 offen offset:2048
    buffer_load_dwordx4 v[28:31], v2, s[20:23], s26 offen offset:3072
    buffer_load_dwordx4 v[32:35], v2, s[20:23], s27 offen offset:0
    buffer_load_dwordx4 v[36:39], v2, s[20:23], s27 offen offset:1024
    buffer_load_dwordx4 v[40:43], v2, s[20:23], s27 offen offset:2048
    buffer_load_dwordx4 v[44:47], v2, s[20:23], s27 offen offset:3072
    buffer_load_dwordx4 v[48:51], v3, s[20:23], s27 offen
    s_add_u32 s26, s26, 4096
    s_add_u32 s27, s27, 5120
    buffer_load_dwordx4 v[52:55], v2, s[20:23], s26 offen offset:0
    buffer_load_dwordx4 v[56:59], v2, s[20:23], s26 offen offset:1024
    buffer_load_dwordx4 v[60:63], v2, s[20:23], s26 offen offset:2048
    buffer_load_dwordx4 v[64:67], v2, s[20:23], s26 offen offset:3072
    buffer_load_dwordx4 v[68:71], v2, s[20:23], s27 offen offset:0
    buffer_load_dwordx4 v[72:75], v2, s[20:23], s27 offen offset:1024
    buffer_load_dwordx4 v[76:79], v2, s[20:23], s27 offen offset:2048
    buffer_load_dwordx4 v[80:83], v2, s[20:23], s27 offen offset:3072
    buffer_load_dwordx4 v[84:87], v3, s[20:23], s27 offen
    s_add_u32 s26, s26, 4096
    s_add_u32 s27, s27, 5120
    buffer_load_dwordx4 v[88:91], v2, s[20:23], s26 offen offset:0
    buffer_load_dwordx4 v[92:95], v2, s[20:23], s26 offen offset:1024
    buffer_load_dwordx4 v[96:99], v2, s[20:23], s26 offen offset:2048
    buffer_load_dwordx4 v[100:103], v2, s[20:23], s26 offen offset:3072
    buffer_load_dwordx4 v[104:107], v2, s[20:23], s27 offen offset:0
    buffer_load_dwordx4 v[108:111], v2, s[20:23], s27 offen offset:1024
    buffer_load_dwordx4 v[112:115], v2, s[20:23], s27 offen offset:2048
    buffer_load_dwordx4 v[116:119], v2, s[20:23], s27 offen offset:3072
    buffer_load_dwordx4 v[120:123], v3, s[20:23], s27 offen
    s_add_u32 s26, s26, 4096
    s_add_u32 s27, s27, 5120
    buffer_load_dwordx4 v[124:127], v2, s[20:23], s26 offen offset:0
    buffer_load_dwordx4 v[128:131], v2, s[20:23], s26 offen offset:1024
    buffer_load_dwordx4 v[132:135], v2, s[20:23], s26 offen offset:2048
    buffer_load_dwordx4 v[136:139], v2, s[20:23], s26 offen offset:3072
    buffer_load_dwordx4 v[140:143], v2, s[20:23], s27 offen offset:0
    buffer_load_dwordx4 v[144:147], v2, s[20:23], s27 offen offset:1024
    buffer_load_dwordx4 v[148:151], v2, s[20:23], s27 offen offset:2048
    buffer_load_dwordx4 v[152:155], v2, s[20:23], s27 offen offset:3072
    buffer_load_dwordx4 v[156:159], v3, s[20:23], s27 offen
    s_add_u32 s26, s26, 4096
    s_add_u32 s27, s27, 5120
    buffer_load_dwordx4 v[160:163], v2, s[20:23], s26 offen offset:0
    buffer_load_dwordx4 v[164:167], v2, s[20:23], s26 offen offset:1024
    buffer_load_dwordx4 v[168:171], v2, s[20:23], s26 offen offset:2048
    buffer_load_dwordx4 v[172:175], v2, s[20:23], s26 offen offset:3072
    buffer_load_dwordx4 v[176:179], v2, s[20:23], s27 offen offset:0
    buffer_load_dwordx4 v[180:183], v2, s[20:23], s27 offen offset:1024
    buffer_load_dwordx4 v[184:187], v2, s[20:23], s27 offen offset:2048
    buffer_load_dwordx4 v[188:191], v2, s[20:23], s27 offen offset:3072
    buffer_load_dwordx4 v[192:195], v3, s[20:23], s27 offen
    s_add_u32 s26, s26, 4096
    s_add_u32 s27, s27, 5120
    v_accvgpr_write_b32 a0, 0
    v_accvgpr_write_b32 a1, 0
    v_accvgpr_write_b32 a2, 0
    v_accvgpr_write_b32 a3, 0
    v_accvgpr_write_b32 a4, 0
    v_accvgpr_write_b32 a5, 0
    v_accvgpr_write_b32 a6, 0
    v_accvgpr_write_b32 a7, 0
    v_accvgpr_write_b32 a8, 0
    v_accvgpr_write_b32 a9, 0
    v_accvgpr_write_b32 a10, 0
    v_accvgpr_write_b32 a11, 0
    v_accvgpr_write_b32 a12, 0
    v_accvgpr_write_b32 a13, 0
    v_accvgpr_write_b32 a14, 0
    v_accvgpr_write_b32 a15, 0
    v_accvgpr_write_b32 a16, 0
    v_accvgpr_write_b32 a17, 0
    v_accvgpr_write_b32 a18, 0
    v_accvgpr_write_b32 a19, 0
    v_accvgpr_write_b32 a20, 0
    v_accvgpr_write_b32 a21, 0
    v_accvgpr_write_b32 a22, 0
    v_accvgpr_write_b32 a23, 0
    v_accvgpr_write_b32 a24, 0
    v_accvgpr_write_b32 a25, 0
    v_accvgpr_write_b32 a26, 0
    v_accvgpr_write_b32 a27, 0
    v_accvgpr_write_b32 a28, 0
    v_accvgpr_write_b32 a29, 0
    v_accvgpr_write_b32 a30, 0
    v_accvgpr_write_b32 a31, 0
    v_accvgpr_write_b32 a32, 0
    v_accvgpr_write_b32 a33, 0
    v_accvgpr_write_b32 a34, 0
    v_accvgpr_write_b32 a35, 0
    v_accvgpr_write_b32 a36, 0
    v_accvgpr_write_b32 a37, 0
    v_accvgpr_write_b32 a38, 0
    v_accvgpr_write_b32 a39, 0
    v_accvgpr_write_b32 a40, 0
    v_accvgpr_write_b32 a41, 0
    v_accvgpr_write_b32 a42, 0
    v_accvgpr_write_b32 a43, 0
    v_accvgpr_write_b32 a44, 0
    v_accvgpr_write_b32 a45, 0
    v_accvgpr_write_b32 a46, 0
    v_accvgpr_write_b32 a47, 0
    v_accvgpr_write_b32 a48, 0
    v_accvgpr_write_b32 a49, 0
    v_accvgpr_write_b32 a50, 0
    v_accvgpr_write_b32 a51, 0
    v_accvgpr_write_b32 a52, 0
    v_accvgpr_write_b32 a53, 0
    v_accvgpr_write_b32 a54, 0
    v_accvgpr_write_b32 a55, 0
    v_accvgpr_write_b32 a56, 0
    v_accvgpr_write_b32 a57, 0
    v_accvgpr_write_b32 a58, 0
    v_accvgpr_write_b32 a59, 0
    v_accvgpr_write_b32 a60, 0
    v_accvgpr_write_b32 a61, 0
    v_accvgpr_write_b32 a62, 0
    v_accvgpr_write_b32 a63, 0
    v_accvgpr_write_b32 a64, 0
    v_accvgpr_write_b32 a65, 0
    v_accvgpr_write_b32 a66, 0
    v_accvgpr_write_b32 a67, 0
    v_accvgpr_write_b32 a68, 0
    v_accvgpr_write_b32 a69, 0
    v_accvgpr_write_b32 a70, 0
    v_accvgpr_write_b32 a71, 0
    v_accvgpr_write_b32 a72, 0
    v_accvgpr_write_b32 a73, 0
    v_accvgpr_write_b32 a74, 0
    v_accvgpr_write_b32 a75, 0
    v_accvgpr_write_b32 a76, 0
    v_accvgpr_write_b32 a77, 0
    v_accvgpr_write_b32 a78, 0
    v_accvgpr_write_b32 a79, 0
    s_waitcnt vmcnt(36)
    v_mfma_f32_16x16x32_bf16 a[0:3], v[16:19], v[32:35], a[0:3]
    v_mfma_f32_16x16x32_bf16 a[4:7], v[16:19], v[36:39], a[4:7]
    v_mfma_f32_16x16x32_bf16 a[8:11], v[16:19], v[40:43], a[8:11]
    v_mfma_f32_16x16x32_bf16 a[12:15], v[16:19], v[44:47], a[12:15]
    v_mfma_f32_16x16x32_bf16 a[16:19], v[16:19], v[48:51], a[16:19]
    v_mfma_f32_16x16x32_bf16 a[20:23], v[20:23], v[32:35], a[20:23]
    v_mfma_f32_16x16x32_bf16 a[24:27], v[20:23], v[36:39], a[24:27]
    v_mfma_f32_16x16x32_bf16 a[28:31], v[20:23], v[40:43], a[28:31]
    v_mfma_f32_16x16x32_bf16 a[32:35], v[20:23], v[44:47], a[32:35]
    v_mfma_f32_16x16x32_bf16 a[36:39], v[20:23], v[48:51], a[36:39]
    v_mfma_f32_16x16x32_bf16 a[40:43], v[24:27], v[32:35], a[40:43]
    v_mfma_f32_16x16x32_bf16 a[44:47], v[24:27], v[36:39], a[44:47]
    v_mfma_f32_16x16x32_bf16 a[48:51], v[24:27], v[40:43], a[48:51]
    v_mfma_f32_16x16x32_bf16 a[52:55], v[24:27], v[44:47], a[52:55]
    v_mfma_f32_16x16x32_bf16 a[56:59], v[24:27], v[48:51], a[56:59]
    v_mfma_f32_16x16x32_bf16 a[60:63], v[28:31], v[32:35], a[60:63]
    v_mfma_f32_16x16x32_bf16 a[64:67], v[28:31], v[36:39], a[64:67]
    v_mfma_f32_16x16x32_bf16 a[68:71], v[28:31], v[40:43], a[68:71]
    v_mfma_f32_16x16x32_bf16 a[72:75], v[28:31], v[44:47], a[72:75]
    v_mfma_f32_16x16x32_bf16 a[76:79], v[28:31], v[48:51], a[76:79]
    buffer_load_dwordx4 v[16:19], v2, s[20:23], s26 offen offset:0
    buffer_load_dwordx4 v[20:23], v2, s[20:23], s26 offen offset:1024
    buffer_load_dwordx4 v[24:27], v2, s[20:23], s26 offen offset:2048
    buffer_load_dwordx4 v[28:31], v2, s[20:23], s26 offen offset:3072
    buffer_load_dwordx4 v[32:35], v2, s[20:23], s27 offen offset:0
    buffer_load_dwordx4 v[36:39], v2, s[20:23], s27 offen offset:1024
    buffer_load_dwordx4 v[40:43], v2, s[20:23], s27 offen offset:2048
    buffer_load_dwordx4 v[44:47], v2, s[20:23], s27 offen offset:3072
    buffer_load_dwordx4 v[48:51], v3, s[20:23], s27 offen
    s_add_u32 s26, s26, 4096
    s_add_u32 s27, s27, 5120
    s_waitcnt vmcnt(36)
    v_mfma_f32_16x16x32_bf16 a[0:3], v[52:55], v[68:71], a[0:3]
    v_mfma_f32_16x16x32_bf16 a[4:7], v[52:55], v[72:75], a[4:7]
    v_mfma_f32_16x16x32_bf16 a[8:11], v[52:55], v[76:79], a[8:11]
    v_mfma_f32_16x16x32_bf16 a[12:15], v[52:55], v[80:83], a[12:15]
    v_mfma_f32_16x16x32_bf16 a[16:19], v[52:55], v[84:87], a[16:19]
    v_mfma_f32_16x16x32_bf16 a[20:23], v[56:59], v[68:71], a[20:23]
    v_mfma_f32_16x16x32_bf16 a[24:27], v[56:59], v[72:75], a[24:27]
    v_mfma_f32_16x16x32_bf16 a[28:31], v[56:59], v[76:79], a[28:31]
    v_mfma_f32_16x16x32_bf16 a[32:35], v[56:59], v[80:83], a[32:35]
    v_mfma_f32_16x16x32_bf16 a[36:39], v[56:59], v[84:87], a[36:39]
    v_mfma_f32_16x16x32_bf16 a[40:43], v[60:63], v[68:71], a[40:43]
    v_mfma_f32_16x16x32_bf16 a[44:47], v[60:63], v[72:75], a[44:47]
    v_mfma_f32_16x16x32_bf16 a[48:51], v[60:63], v[76:79], a[48:51]
    v_mfma_f32_16x16x32_bf16 a[52:55], v[60:63], v[80:83], a[52:55]
    v_mfma_f32_16x16x32_bf16 a[56:59], v[60:63], v[84:87], a[56:59]
    v_mfma_f32_16x16x32_bf16 a[60:63], v[64:67], v[68:71], a[60:63]
    v_mfma_f32_16x16x32_bf16 a[64:67], v[64:67], v[72:75], a[64:67]
    v_mfma_f32_16x16x32_bf16 a[68:71], v[64:67], v[76:79], a[68:71]
    v_mfma_f32_16x16x32_bf16 a[72:75], v[64:67], v[80:83], a[72:75]
    v_mfma_f32_16x16x32_bf16 a[76:79], v[64:67], v[84:87], a[76:79]
    buffer_load_dwordx4 v[52:55], v2, s[20:23], s26 offen offset:0
    buffer_load_dwordx4 v[56:59], v2, s[20:23], s26 offen offset:1024
    buffer_load_dwordx4 v[60:63], v2, s[20:23], s26 offen offset:2048
    buffer_load_dwordx4 v[64:67], v2, s[20:23], s26 offen offset:3072
    buffer_load_dwordx4 v[68:71], v2, s[20:23], s27 offen offset:0
    buffer_load_dwordx4 v[72:75], v2, s[20:23], s27 offen offset:1024
    buffer_load_dwordx4 v[76:79], v2, s[20:23], s27 offen offset:2048
    buffer_load_dwordx4 v[80:83], v2, s[20:23], s27 offen offset:3072
    buffer_load_dwordx4 v[84:87], v3, s[20:23], s27 offen
    s_add_u32 s26, s26, 4096
    s_add_u32 s27, s27, 5120
    s_waitcnt vmcnt(36)
    v_mfma_f32_16x16x32_bf16 a[0:3], v[88:91], v[104:107], a[0:3]
    v_mfma_f32_16x16x32_bf16 a[4:7], v[88:91], v[108:111], a[4:7]
    v_mfma_f32_16x16x32_bf16 a[8:11], v[88:91], v[112:115], a[8:11]
    v_mfma_f32_16x16x32_bf16 a[12:15], v[88:91], v[116:119], a[12:15]
    v_mfma_f32_16x16x32_bf16 a[16:19], v[88:91], v[120:123], a[16:19]
    v_mfma_f32_16x16x32_bf16 a[20:23], v[92:95], v[104:107], a[20:23]
    v_mfma_f32_16x16x32_bf16 a[24:27], v[92:95], v[108:111], a[24:27]
    v_mfma_f32_16x16x32_bf16 a[28:31], v[92:95], v[112:115], a[28:31]
    v_mfma_f32_16x16x32_bf16 a[32:35], v[92:95], v[116:119], a[32:35]
    v_mfma_f32_16x16x32_bf16 a[36:39], v[92:95], v[120:123], a[36:39]
    v_mfma_f32_16x16x32_bf16 a[40:43], v[96:99], v[104:107], a[40:43]
    v_mfma_f32_16x16x32_bf16 a[44:47], v[96:99], v[108:111], a[44:47]
    v_mfma_f32_16x16x32_bf16 a[48:51], v[96:99], v[112:115], a[48:51]
    v_mfma_f32_16x16x32_bf16 a[52:55], v[96:99], v[116:119], a[52:55]
    v_mfma_f32_16x16x32_bf16 a[56:59], v[96:99], v[120:123], a[56:59]
    v_mfma_f32_16x16x32_bf16 a[60:63], v[100:103], v[104:107], a[60:63]
    v_mfma_f32_16x16x32_bf16 a[64:67], v[100:103], v[108:111], a[64:67]
    v_mfma_f32_16x16x32_bf16 a[68:71], v[100:103], v[112:115], a[68:71]
    v_mfma_f32_16x16x32_bf16 a[72:75], v[100:103], v[116:119], a[72:75]
    v_mfma_f32_16x16x32_bf16 a[76:79], v[100:103], v[120:123], a[76:79]
    buffer_load_dwordx4 v[88:91], v2, s[20:23], s26 offen offset:0
    buffer_load_dwordx4 v[92:95], v2, s[20:23], s26 offen offset:1024
    buffer_load_dwordx4 v[96:99], v2, s[20:23], s26 offen offset:2048
    buffer_load_dwordx4 v[100:103], v2, s[20:23], s26 offen offset:3072
    buffer_load_dwordx4 v[104:107], v2, s[20:23], s27 offen offset:0
    buffer_load_dwordx4 v[108:111], v2, s[20:23], s27 offen offset:1024
    buffer_load_dwordx4 v[112:115], v2, s[20:23], s27 offen offset:2048
    buffer_load_dwordx4 v[116:119], v2, s[20:23], s27 offen offset:3072
    buffer_load_dwordx4 v[120:123], v3, s[20:23], s27 offen
    s_add_u32 s26, s26, 4096
    s_add_u32 s27, s27, 5120
    s_waitcnt vmcnt(36)
    v_mfma_f32_16x16x32_bf16 a[0:3], v[124:127], v[140:143], a[0:3]
    v_mfma_f32_16x16x32_bf16 a[4:7], v[124:127], v[144:147], a[4:7]
    v_mfma_f32_16x16x32_bf16 a[8:11], v[124:127], v[148:151], a[8:11]
    v_mfma_f32_16x16x32_bf16 a[12:15], v[124:127], v[152:155], a[12:15]
    v_mfma_f32_16x16x32_bf16 a[16:19], v[124:127], v[156:159], a[16:19]
    v_mfma_f32_16x16x32_bf16 a[20:23], v[128:131], v[140:143], a[20:23]
    v_mfma_f32_16x16x32_bf16 a[24:27], v[128:131], v[144:147], a[24:27]
    v_mfma_f32_16x16x32_bf16 a[28:31], v[128:131], v[148:151], a[28:31]
    v_mfma_f32_16x16x32_bf16 a[32:35], v[128:131], v[152:155], a[32:35]
    v_mfma_f32_16x16x32_bf16 a[36:39], v[128:131], v[156:159], a[36:39]
    v_mfma_f32_16x16x32_bf16 a[40:43], v[132:135], v[140:143], a[40:43]
    v_mfma_f32_16x16x32_bf16 a[44:47], v[132:135], v[144:147], a[44:47]
    v_mfma_f32_16x16x32_bf16 a[48:51], v[132:135], v[148:151], a[48:51]
    v_mfma_f32_16x16x32_bf16 a[52:55], v[132:135], v[152:155], a[52:55]
    v_mfma_f32_16x16x32_bf16 a[56:59], v[132:135], v[156:159], a[56:59]
    v_mfma_f32_16x16x32_bf16 a[60:63], v[136:139], v[140:143], a[60:63]
    v_mfma_f32_16x16x32_bf16 a[64:67], v[136:139], v[144:147], a[64:67]
    v_mfma_f32_16x16x32_bf16 a[68:71], v[136:139], v[148:151], a[68:71]
    v_mfma_f32_16x16x32_bf16 a[72:75], v[136:139], v[152:155], a[72:75]
    v_mfma_f32_16x16x32_bf16 a[76:79], v[136:139], v[156:159], a[76:79]
    buffer_load_dwordx4 v[124:127], v2, s[20:23], s26 offen offset:0
    buffer_load_dwordx4 v[128:131], v2, s[20:23], s26 offen offset:1024
    buffer_load_dwordx4 v[132:135], v2, s[20:23], s26 offen offset:2048
    buffer_load_dwordx4 v[136:139], v2, s[20:23], s26 offen offset:3072
    buffer_load_dwordx4 v[140:143], v2, s[20:23], s27 offen offset:0
    buffer_load_dwordx4 v[144:147], v2, s[20:23], s27 offen offset:1024
    buffer_load_dwordx4 v[148:151], v2, s[20:23], s27 offen offset:2048
    buffer_load_dwordx4 v[152:155], v2, s[20:23], s27 offen offset:3072
    buffer_load_dwordx4 v[156:159], v3, s[20:23], s27 offen
    s_add_u32 s26, s26, 4096
    s_add_u32 s27, s27, 5120
    s_waitcnt vmcnt(36)
    v_mfma_f32_16x16x32_bf16 a[0:3], v[160:163], v[176:179], a[0:3]
    v_mfma_f32_16x16x32_bf16 a[4:7], v[160:163], v[180:183], a[4:7]
    v_mfma_f32_16x16x32_bf16 a[8:11], v[160:163], v[184:187], a[8:11]
    v_mfma_f32_16x16x32_bf16 a[12:15], v[160:163], v[188:191], a[12:15]
    v_mfma_f32_16x16x32_bf16 a[16:19], v[160:163], v[192:195], a[16:19]
    v_mfma_f32_16x16x32_bf16 a[20:23], v[164:167], v[176:179], a[20:23]
    v_mfma_f32_16x16x32_bf16 a[24:27], v[164:167], v[180:183], a[24:27]
    v_mfma_f32_16x16x32_bf16 a[28:31], v[164:167], v[184:187], a[28:31]
    v_mfma_f32_16x16x32_bf16 a[32:35], v[164:167], v[188:191], a[32:35]
    v_mfma_f32_16x16x32_bf16 a[36:39], v[164:167], v[192:195], a[36:39]
    v_mfma_f32_16x16x32_bf16 a[40:43], v[168:171], v[176:179], a[40:43]
    v_mfma_f32_16x16x32_bf16 a[44:47], v[168:171], v[180:183], a[44:47]
    v_mfma_f32_16x16x32_bf16 a[48:51], v[168:171], v[184:187], a[48:51]
    v_mfma_f32_16x16x32_bf16 a[52:55], v[168:171], v[188:191], a[52:55]
    v_mfma_f32_16x16x32_bf16 a[56:59], v[168:171], v[192:195], a[56:59]
    v_mfma_f32_16x16x32_bf16 a[60:63], v[172:175], v[176:179], a[60:63]
    v_mfma_f32_16x16x32_bf16 a[64:67], v[172:175], v[180:183], a[64:67]
    v_mfma_f32_16x16x32_bf16 a[68:71], v[172:175], v[184:187], a[68:71]
    v_mfma_f32_16x16x32_bf16 a[72:75], v[172:175], v[188:191], a[72:75]
    v_mfma_f32_16x16x32_bf16 a[76:79], v[172:175], v[192:195], a[76:79]
    buffer_load_dwordx4 v[160:163], v2, s[20:23], s26 offen offset:0
    buffer_load_dwordx4 v[164:167], v2, s[20:23], s26 offen offset:1024
    buffer_load_dwordx4 v[168:171], v2, s[20:23], s26 offen offset:2048
    buffer_load_dwordx4 v[172:175], v2, s[20:23], s26 offen offset:3072
    buffer_load_dwordx4 v[176:179], v2, s[20:23], s27 offen offset:0
    buffer_load_dwordx4 v[180:183], v2, s[20:23], s27 offen offset:1024
    buffer_load_dwordx4 v[184:187], v2, s[20:23], s27 offen offset:2048
    buffer_load_dwordx4 v[188:191], v2, s[20:23], s27 offen offset:3072
    buffer_load_dwordx4 v[192:195], v3, s[20:23], s27 offen
    s_add_u32 s26, s26, 4096
    s_add_u32 s27, s27, 5120
    s_waitcnt vmcnt(36)
    v_mfma_f32_16x16x32_bf16 a[0:3], v[16:19], v[32:35], a[0:3]
    v_mfma_f32_16x16x32_bf16 a[4:7], v[16:19], v[36:39], a[4:7]
    v_mfma_f32_16x16x32_bf16 a[8:11], v[16:19], v[40:43], a[8:11]
    v_mfma_f32_16x16x32_bf16 a[12:15], v[16:19], v[44:47], a[12:15]
    v_mfma_f32_16x16x32_bf16 a[16:19], v[16:19], v[48:51], a[16:19]
    v_mfma_f32_16x16x32_bf16 a[20:23], v[20:23], v[32:35], a[20:23]
    v_mfma_f32_16x16x32_bf16 a[24:27], v[20:23], v[36:39], a[24:27]
    v_mfma_f32_16x16x32_bf16 a[28:31], v[20:23], v[40:43], a[28:31]
    v_mfma_f32_16x16x32_bf16 a[32:35], v[20:23], v[44:47], a[32:35]
    v_mfma_f32_16x16x32_bf16 a[36:39], v[20:23], v[48:51], a[36:39]
    v_mfma_f32_16x16x32_bf16 a[40:43], v[24:27], v[32:35], a[40:43]
    v_mfma_f32_16x16x32_bf16 a[44:47], v[24:27], v[36:39], a[44:47]
    v_mfma_f32_16x16x32_bf16 a[48:51], v[24:27], v[40:43], a[48:51]
    v_mfma_f32_16x16x32_bf16 a[52:55], v[24:27], v[44:47], a[52:55]
    v_mfma_f32_16x16x32_bf16 a[56:59], v[24:27], v[48:51], a[56:59]
    v_mfma_f32_16x16x32_bf16 a[60:63], v[28:31], v[32:35], a[60:63]
    v_mfma_f32_16x16x32_bf16 a[64:67], v[28:31], v[36:39], a[64:67]
    v_mfma_f32_16x16x32_bf16 a[68:71], v[28:31], v[40:43], a[68:71]
    v_mfma_f32_16x16x32_bf16 a[72:75], v[28:31], v[44:47], a[72:75]
    v_mfma_f32_16x16x32_bf16 a[76:79], v[28:31], v[48:51], a[76:79]
    buffer_load_dwordx4 v[16:19], v2, s[20:23], s26 offen offset:0
    buffer_load_dwordx4 v[20:23], v2, s[20:23], s26 offen offset:1024
    buffer_load_dwordx4 v[24:27], v2, s[20:23], s26 offen offset:2048
    buffer_load_dwordx4 v[28:31], v2, s[20:23], s26 offen offset:3072
    buffer_load_dwordx4 v[32:35], v2, s[20:23], s27 offen offset:0
    buffer_load_dwordx4 v[36:39], v2, s[20:23], s27 offen offset:1024
    buffer_load_dwordx4 v[40:43], v2, s[20:23], s27 offen offset:2048
    buffer_load_dwordx4 v[44:47], v2, s[20:23], s27 offen offset:3072
    buffer_load_dwordx4 v[48:51], v3, s[20:23], s27 offen
    s_add_u32 s26, s26, 4096
    s_add_u32 s27, s27, 5120
    s_waitcnt vmcnt(36)
    v_mfma_f32_16x16x32_bf16 a[0:3], v[52:55], v[68:71], a[0:3]
    v_mfma_f32_16x16x32_bf16 a[4:7], v[52:55], v[72:75], a[4:7]
    v_mfma_f32_16x16x32_bf16 a[8:11], v[52:55], v[76:79], a[8:11]
    v_mfma_f32_16x16x32_bf16 a[12:15], v[52:55], v[80:83], a[12:15]
    v_mfma_f32_16x16x32_bf16 a[16:19], v[52:55], v[84:87], a[16:19]
    v_mfma_f32_16x16x32_bf16 a[20:23], v[56:59], v[68:71], a[20:23]
    v_mfma_f32_16x16x32_bf16 a[24:27], v[56:59], v[72:75], a[24:27]
    v_mfma_f32_16x16x32_bf16 a[28:31], v[56:59], v[76:79], a[28:31]
    v_mfma_f32_16x16x32_bf16 a[32:35], v[56:59], v[80:83], a[32:35]
    v_mfma_f32_16x16x32_bf16 a[36:39], v[56:59], v[84:87], a[36:39]
    v_mfma_f32_16x16x32_bf16 a[40:43], v[60:63], v[68:71], a[40:43]
    v_mfma_f32_16x16x32_bf16 a[44:47], v[60:63], v[72:75], a[44:47]
    v_mfma_f32_16x16x32_bf16 a[48:51], v[60:63], v[76:79], a[48:51]
    v_mfma_f32_16x16x32_bf16 a[52:55], v[60:63], v[80:83], a[52:55]
    v_mfma_f32_16x16x32_bf16 a[56:59], v[60:63], v[84:87], a[56:59]
    v_mfma_f32_16x16x32_bf16 a[60:63], v[64:67], v[68:71], a[60:63]
    v_mfma_f32_16x16x32_bf16 a[64:67], v[64:67], v[72:75], a[64:67]
    v_mfma_f32_16x16x32_bf16 a[68:71], v[64:67], v[76:79], a[68:71]
    v_mfma_f32_16x16x32_bf16 a[72:75], v[64:67], v[80:83], a[72:75]
    v_mfma_f32_16x16x32_bf16 a[76:79], v[64:67], v[84:87], a[76:79]
    buffer_load_dwordx4 v[52:55], v2, s[20:23], s26 offen offset:0
    buffer_load_dwordx4 v[56:59], v2, s[20:23], s26 offen offset:1024
    buffer_load_dwordx4 v[60:63], v2, s[20:23], s26 offen offset:2048
    buffer_load_dwordx4 v[64:67], v2, s[20:23], s26 offen offset:3072
    buffer_load_dwordx4 v[68:71], v2, s[20:23], s27 offen offset:0
    buffer_load_dwordx4 v[72:75], v2, s[20:23], s27 offen offset:1024
    buffer_load_dwordx4 v[76:79], v2, s[20:23], s27 offen offset:2048
    buffer_load_dwordx4 v[80:83], v2, s[20:23], s27 offen offset:3072
    buffer_load_dwordx4 v[84:87], v3, s[20:23], s27 offen
    s_add_u32 s26, s26, 4096
    s_add_u32 s27, s27, 5120
    s_waitcnt vmcnt(36)
    v_mfma_f32_16x16x32_bf16 a[0:3], v[88:91], v[104:107], a[0:3]
    v_mfma_f32_16x16x32_bf16 a[4:7], v[88:91], v[108:111], a[4:7]
    v_mfma_f32_16x16x32_bf16 a[8:11], v[88:91], v[112:115], a[8:11]
    v_mfma_f32_16x16x32_bf16 a[12:15], v[88:91], v[116:119], a[12:15]
    v_mfma_f32_16x16x32_bf16 a[16:19], v[88:91], v[120:123], a[16:19]
    v_mfma_f32_16x16x32_bf16 a[20:23], v[92:95], v[104:107], a[20:23]
    v_mfma_f32_16x16x32_bf16 a[24:27], v[92:95], v[108:111], a[24:27]
    v_mfma_f32_16x16x32_bf16 a[28:31], v[92:95], v[112:115], a[28:31]
    v_mfma_f32_16x16x32_bf16 a[32:35], v[92:95], v[116:119], a[32:35]
    v_mfma_f32_16x16x32_bf16 a[36:39], v[92:95], v[120:123], a[36:39]
    v_mfma_f32_16x16x32_bf16 a[40:43], v[96:99], v[104:107], a[40:43]
    v_mfma_f32_16x16x32_bf16 a[44:47], v[96:99], v[108:111], a[44:47]
    v_mfma_f32_16x16x32_bf16 a[48:51], v[96:99], v[112:115], a[48:51]
    v_mfma_f32_16x16x32_bf16 a[52:55], v[96:99], v[116:119], a[52:55]
    v_mfma_f32_16x16x32_bf16 a[56:59], v[96:99], v[120:123], a[56:59]
    v_mfma_f32_16x16x32_bf16 a[60:63], v[100:103], v[104:107], a[60:63]
    v_mfma_f32_16x16x32_bf16 a[64:67], v[100:103], v[108:111], a[64:67]
    v_mfma_f32_16x16x32_bf16 a[68:71], v[100:103], v[112:115], a[68:71]
    v_mfma_f32_16x16x32_bf16 a[72:75], v[100:103], v[116:119], a[72:75]
    v_mfma_f32_16x16x32_bf16 a[76:79], v[100:103], v[120:123], a[76:79]
    buffer_load_dwordx4 v[88:91], v2, s[20:23], s26 offen offset:0
    buffer_load_dwordx4 v[92:95], v2, s[20:23], s26 offen offset:1024
    buffer_load_dwordx4 v[96:99], v2, s[20:23], s26 offen offset:2048
    buffer_load_dwordx4 v[100:103], v2, s[20:23], s26 offen offset:3072
    buffer_load_dwordx4 v[104:107], v2, s[20:23], s27 offen offset:0
    buffer_load_dwordx4 v[108:111], v2, s[20:23], s27 offen offset:1024
    buffer_load_dwordx4 v[112:115], v2, s[20:23], s27 offen offset:2048
    buffer_load_dwordx4 v[116:119], v2, s[20:23], s27 offen offset:3072
    buffer_load_dwordx4 v[120:123], v3, s[20:23], s27 offen
    s_add_u32 s26, s26, 4096
    s_add_u32 s27, s27, 5120
    s_waitcnt vmcnt(36)
    v_mfma_f32_16x16x32_bf16 a[0:3], v[124:127], v[140:143], a[0:3]
    v_mfma_f32_16x16x32_bf16 a[4:7], v[124:127], v[144:147], a[4:7]
    v_mfma_f32_16x16x32_bf16 a[8:11], v[124:127], v[148:151], a[8:11]
    v_mfma_f32_16x16x32_bf16 a[12:15], v[124:127], v[152:155], a[12:15]
    v_mfma_f32_16x16x32_bf16 a[16:19], v[124:127], v[156:159], a[16:19]
    v_mfma_f32_16x16x32_bf16 a[20:23], v[128:131], v[140:143], a[20:23]
    v_mfma_f32_16x16x32_bf16 a[24:27], v[128:131], v[144:147], a[24:27]
    v_mfma_f32_16x16x32_bf16 a[28:31], v[128:131], v[148:151], a[28:31]
    v_mfma_f32_16x16x32_bf16 a[32:35], v[128:131], v[152:155], a[32:35]
    v_mfma_f32_16x16x32_bf16 a[36:39], v[128:131], v[156:159], a[36:39]
    v_mfma_f32_16x16x32_bf16 a[40:43], v[132:135], v[140:143], a[40:43]
    v_mfma_f32_16x16x32_bf16 a[44:47], v[132:135], v[144:147], a[44:47]
    v_mfma_f32_16x16x32_bf16 a[48:51], v[132:135], v[148:151], a[48:51]
    v_mfma_f32_16x16x32_bf16 a[52:55], v[132:135], v[152:155], a[52:55]
    v_mfma_f32_16x16x32_bf16 a[56:59], v[132:135], v[156:159], a[56:59]
    v_mfma_f32_16x16x32_bf16 a[60:63], v[136:139], v[140:143], a[60:63]
    v_mfma_f32_16x16x32_bf16 a[64:67], v[136:139], v[144:147], a[64:67]
    v_mfma_f32_16x16x32_bf16 a[68:71], v[136:139], v[148:151], a[68:71]
    v_mfma_f32_16x16x32_bf16 a[72:75], v[136:139], v[152:155], a[72:75]
    v_mfma_f32_16x16x32_bf16 a[76:79], v[136:139], v[156:159], a[76:79]
    buffer_load_dwordx4 v[124:127], v2, s[20:23], s26 offen offset:0
    buffer_load_dwordx4 v[128:131], v2, s[20:23], s26 offen offset:1024
    buffer_load_dwordx4 v[132:135], v2, s[20:23], s26 offen offset:2048
    buffer_load_dwordx4 v[136:139], v2, s[20:23], s26 offen offset:3072
    buffer_load_dwordx4 v[140:143], v2, s[20:23], s27 offen offset:0
    buffer_load_dwordx4 v[144:147], v2, s[20:23], s27 offen offset:1024
    buffer_load_dwordx4 v[148:151], v2, s[20:23], s27 offen offset:2048
    buffer_load_dwordx4 v[152:155], v2, s[20:23], s27 offen offset:3072
    buffer_load_dwordx4 v[156:159], v3, s[20:23], s27 offen
    s_add_u32 s26, s26, 4096
    s_add_u32 s27, s27, 5120
    s_waitcnt vmcnt(36)
    v_mfma_f32_16x16x32_bf16 a[0:3], v[160:163], v[176:179], a[0:3]
    v_mfma_f32_16x16x32_bf16 a[4:7], v[160:163], v[180:183], a[4:7]
    v_mfma_f32_16x16x32_bf16 a[8:11], v[160:163], v[184:187], a[8:11]
    v_mfma_f32_16x16x32_bf16 a[12:15], v[160:163], v[188:191], a[12:15]
    v_mfma_f32_16x16x32_bf16 a[16:19], v[160:163], v[192:195], a[16:19]
    v_mfma_f32_16x16x32_bf16 a[20:23], v[164:167], v[176:179], a[20:23]
    v_mfma_f32_16x16x32_bf16 a[24:27], v[164:167], v[180:183], a[24:27]
    v_mfma_f32_16x16x32_bf16 a[28:31], v[164:167], v[184:187], a[28:31]
    v_mfma_f32_16x16x32_bf16 a[32:35], v[164:167], v[188:191], a[32:35]
    v_mfma_f32_16x16x32_bf16 a[36:39], v[164:167], v[192:195], a[36:39]
    v_mfma_f32_16x16x32_bf16 a[40:43], v[168:171], v[176:179], a[40:43]
    v_mfma_f32_16x16x32_bf16 a[44:47], v[168:171], v[180:183], a[44:47]
    v_mfma_f32_16x16x32_bf16 a[48:51], v[168:171], v[184:187], a[48:51]
    v_mfma_f32_16x16x32_bf16 a[52:55], v[168:171], v[188:191], a[52:55]
    v_mfma_f32_16x16x32_bf16 a[56:59], v[168:171], v[192:195], a[56:59]
    v_mfma_f32_16x16x32_bf16 a[60:63], v[172:175], v[176:179], a[60:63]
    v_mfma_f32_16x16x32_bf16 a[64:67], v[172:175], v[180:183], a[64:67]
    v_mfma_f32_16x16x32_bf16 a[68:71], v[172:175], v[184:187], a[68:71]
    v_mfma_f32_16x16x32_bf16 a[72:75], v[172:175], v[188:191], a[72:75]
    v_mfma_f32_16x16x32_bf16 a[76:79], v[172:175], v[192:195], a[76:79]
    buffer_load_dwordx4 v[160:163], v2, s[20:23], s26 offen offset:0
    buffer_load_dwordx4 v[164:167], v2, s[20:23], s26 offen offset:1024
    buffer_load_dwordx4 v[168:171], v2, s[20:23], s26 offen offset:2048
    buffer_load_dwordx4 v[172:175], v2, s[20:23], s26 offen offset:3072
    buffer_load_dwordx4 v[176:179], v2, s[20:23], s27 offen offset:0
    buffer_load_dwordx4 v[180:183], v2, s[20:23], s27 offen offset:1024
    buffer_load_dwordx4 v[184:187], v2, s[20:23], s27 offen offset:2048
    buffer_load_dwordx4 v[188:191], v2, s[20:23], s27 offen offset:3072
    buffer_load_dwordx4 v[192:195], v3, s[20:23], s27 offen
    s_add_u32 s26, s26, 4096
    s_add_u32 s27, s27, 5120
    s_waitcnt vmcnt(36)
    v_mfma_f32_16x16x32_bf16 a[0:3], v[16:19], v[32:35], a[0:3]
    v_mfma_f32_16x16x32_bf16 a[4:7], v[16:19], v[36:39], a[4:7]
    v_mfma_f32_16x16x32_bf16 a[8:11], v[16:19], v[40:43], a[8:11]
    v_mfma_f32_16x16x32_bf16 a[12:15], v[16:19], v[44:47], a[12:15]
    v_mfma_f32_16x16x32_bf16 a[16:19], v[16:19], v[48:51], a[16:19]
    v_mfma_f32_16x16x32_bf16 a[20:23], v[20:23], v[32:35], a[20:23]
    v_mfma_f32_16x16x32_bf16 a[24:27], v[20:23], v[36:39], a[24:27]
    v_mfma_f32_16x16x32_bf16 a[28:31], v[20:23], v[40:43], a[28:31]
    v_mfma_f32_16x16x32_bf16 a[32:35], v[20:23], v[44:47], a[32:35]
    v_mfma_f32_16x16x32_bf16 a[36:39], v[20:23], v[48:51], a[36:39]
    v_mfma_f32_16x16x32_bf16 a[40:43], v[24:27], v[32:35], a[40:43]
    v_mfma_f32_16x16x32_bf16 a[44:47], v[24:27], v[36:39], a[44:47]
    v_mfma_f32_16x16x32_bf16 a[48:51], v[24:27], v[40:43], a[48:51]
    v_mfma_f32_16x16x32_bf16 a[52:55], v[24:27], v[44:47], a[52:55]
    v_mfma_f32_16x16x32_bf16 a[56:59], v[24:27], v[48:51], a[56:59]
    v_mfma_f32_16x16x32_bf16 a[60:63], v[28:31], v[32:35], a[60:63]
    v_mfma_f32_16x16x32_bf16 a[64:67], v[28:31], v[36:39], a[64:67]
    v_mfma_f32_16x16x32_bf16 a[68:71], v[28:31], v[40:43], a[68:71]
    v_mfma_f32_16x16x32_bf16 a[72:75], v[28:31], v[44:47], a[72:75]
    v_mfma_f32_16x16x32_bf16 a[76:79], v[28:31], v[48:51], a[76:79]
    buffer_load_dwordx4 v[16:19], v2, s[20:23], s26 offen offset:0
    buffer_load_dwordx4 v[20:23], v2, s[20:23], s26 offen offset:1024
    buffer_load_dwordx4 v[24:27], v2, s[20:23], s26 offen offset:2048
    buffer_load_dwordx4 v[28:31], v2, s[20:23], s26 offen offset:3072
    buffer_load_dwordx4 v[32:35], v2, s[20:23], s27 offen offset:0
    buffer_load_dwordx4 v[36:39], v2, s[20:23], s27 offen offset:1024
    buffer_load_dwordx4 v[40:43], v2, s[20:23], s27 offen offset:2048
    buffer_load_dwordx4 v[44:47], v2, s[20:23], s27 offen offset:3072
    buffer_load_dwordx4 v[48:51], v3, s[20:23], s27 offen
    s_add_u32 s26, s26, 4096
    s_add_u32 s27, s27, 5120
    s_waitcnt vmcnt(36)
    v_mfma_f32_16x16x32_bf16 a[0:3], v[52:55], v[68:71], a[0:3]
    v_mfma_f32_16x16x32_bf16 a[4:7], v[52:55], v[72:75], a[4:7]
    v_mfma_f32_16x16x32_bf16 a[8:11], v[52:55], v[76:79], a[8:11]
    v_mfma_f32_16x16x32_bf16 a[12:15], v[52:55], v[80:83], a[12:15]
    v_mfma_f32_16x16x32_bf16 a[16:19], v[52:55], v[84:87], a[16:19]
    v_mfma_f32_16x16x32_bf16 a[20:23], v[56:59], v[68:71], a[20:23]
    v_mfma_f32_16x16x32_bf16 a[24:27], v[56:59], v[72:75], a[24:27]
    v_mfma_f32_16x16x32_bf16 a[28:31], v[56:59], v[76:79], a[28:31]
    v_mfma_f32_16x16x32_bf16 a[32:35], v[56:59], v[80:83], a[32:35]
    v_mfma_f32_16x16x32_bf16 a[36:39], v[56:59], v[84:87], a[36:39]
    v_mfma_f32_16x16x32_bf16 a[40:43], v[60:63], v[68:71], a[40:43]
    v_mfma_f32_16x16x32_bf16 a[44:47], v[60:63], v[72:75], a[44:47]
    v_mfma_f32_16x16x32_bf16 a[48:51], v[60:63], v[76:79], a[48:51]
    v_mfma_f32_16x16x32_bf16 a[52:55], v[60:63], v[80:83], a[52:55]
    v_mfma_f32_16x16x32_bf16 a[56:59], v[60:63], v[84:87], a[56:59]
    v_mfma_f32_16x16x32_bf16 a[60:63], v[64:67], v[68:71], a[60:63]
    v_mfma_f32_16x16x32_bf16 a[64:67], v[64:67], v[72:75], a[64:67]
    v_mfma_f32_16x16x32_bf16 a[68:71], v[64:67], v[76:79], a[68:71]
    v_mfma_f32_16x16x32_bf16 a[72:75], v[64:67], v[80:83], a[72:75]
    v_mfma_f32_16x16x32_bf16 a[76:79], v[64:67], v[84:87], a[76:79]
    buffer_load_dwordx4 v[52:55], v2, s[20:23], s26 offen offset:0
    buffer_load_dwordx4 v[56:59], v2, s[20:23], s26 offen offset:1024
    buffer_load_dwordx4 v[60:63], v2, s[20:23], s26 offen offset:2048
    buffer_load_dwordx4 v[64:67], v2, s[20:23], s26 offen offset:3072
    buffer_load_dwordx4 v[68:71], v2, s[20:23], s27 offen offset:0
    buffer_load_dwordx4 v[72:75], v2, s[20:23], s27 offen offset:1024
    buffer_load_dwordx4 v[76:79], v2, s[20:23], s27 offen offset:2048
    buffer_load_dwordx4 v[80:83], v2, s[20:23], s27 offen offset:3072
    buffer_load_dwordx4 v[84:87], v3, s[20:23], s27 offen
    s_add_u32 s26, s26, 4096
    s_add_u32 s27, s27, 5120
    s_waitcnt vmcnt(36)
    v_mfma_f32_16x16x32_bf16 a[0:3], v[88:91], v[104:107], a[0:3]
    v_mfma_f32_16x16x32_bf16 a[4:7], v[88:91], v[108:111], a[4:7]
    v_mfma_f32_16x16x32_bf16 a[8:11], v[88:91], v[112:115], a[8:11]
    v_mfma_f32_16x16x32_bf16 a[12:15], v[88:91], v[116:119], a[12:15]
    v_mfma_f32_16x16x32_bf16 a[16:19], v[88:91], v[120:123], a[16:19]
    v_mfma_f32_16x16x32_bf16 a[20:23], v[92:95], v[104:107], a[20:23]
    v_mfma_f32_16x16x32_bf16 a[24:27], v[92:95], v[108:111], a[24:27]
    v_mfma_f32_16x16x32_bf16 a[28:31], v[92:95], v[112:115], a[28:31]
    v_mfma_f32_16x16x32_bf16 a[32:35], v[92:95], v[116:119], a[32:35]
    v_mfma_f32_16x16x32_bf16 a[36:39], v[92:95], v[120:123], a[36:39]
    v_mfma_f32_16x16x32_bf16 a[40:43], v[96:99], v[104:107], a[40:43]
    v_mfma_f32_16x16x32_bf16 a[44:47], v[96:99], v[108:111], a[44:47]
    v_mfma_f32_16x16x32_bf16 a[48:51], v[96:99], v[112:115], a[48:51]
    v_mfma_f32_16x16x32_bf16 a[52:55], v[96:99], v[116:119], a[52:55]
    v_mfma_f32_16x16x32_bf16 a[56:59], v[96:99], v[120:123], a[56:59]
    v_mfma_f32_16x16x32_bf16 a[60:63], v[100:103], v[104:107], a[60:63]
    v_mfma_f32_16x16x32_bf16 a[64:67], v[100:103], v[108:111], a[64:67]
    v_mfma_f32_16x16x32_bf16 a[68:71], v[100:103], v[112:115], a[68:71]
    v_mfma_f32_16x16x32_bf16 a[72:75], v[100:103], v[116:119], a[72:75]
    v_mfma_f32_16x16x32_bf16 a[76:79], v[100:103], v[120:123], a[76:79]
    buffer_load_dwordx4 v[88:91], v2, s[20:23], s26 offen offset:0
    buffer_load_dwordx4 v[92:95], v2, s[20:23], s26 offen offset:1024
    buffer_load_dwordx4 v[96:99], v2, s[20:23], s26 offen offset:2048
    buffer_load_dwordx4 v[100:103], v2, s[20:23], s26 offen offset:3072
    buffer_load_dwordx4 v[104:107], v2, s[20:23], s27 offen offset:0
    buffer_load_dwordx4 v[108:111], v2, s[20:23], s27 offen offset:1024
    buffer_load_dwordx4 v[112:115], v2, s[20:23], s27 offen offset:2048
    buffer_load_dwordx4 v[116:119], v2, s[20:23], s27 offen offset:3072
    buffer_load_dwordx4 v[120:123], v3, s[20:23], s27 offen
    s_add_u32 s26, s26, 4096
    s_add_u32 s27, s27, 5120
    s_waitcnt vmcnt(36)
    v_mfma_f32_16x16x32_bf16 a[0:3], v[124:127], v[140:143], a[0:3]
    v_mfma_f32_16x16x32_bf16 a[4:7], v[124:127], v[144:147], a[4:7]
    v_mfma_f32_16x16x32_bf16 a[8:11], v[124:127], v[148:151], a[8:11]
    v_mfma_f32_16x16x32_bf16 a[12:15], v[124:127], v[152:155], a[12:15]
    v_mfma_f32_16x16x32_bf16 a[16:19], v[124:127], v[156:159], a[16:19]
    v_mfma_f32_16x16x32_bf16 a[20:23], v[128:131], v[140:143], a[20:23]
    v_mfma_f32_16x16x32_bf16 a[24:27], v[128:131], v[144:147], a[24:27]
    v_mfma_f32_16x16x32_bf16 a[28:31], v[128:131], v[148:151], a[28:31]
    v_mfma_f32_16x16x32_bf16 a[32:35], v[128:131], v[152:155], a[32:35]
    v_mfma_f32_16x16x32_bf16 a[36:39], v[128:131], v[156:159], a[36:39]
    v_mfma_f32_16x16x32_bf16 a[40:43], v[132:135], v[140:143], a[40:43]
    v_mfma_f32_16x16x32_bf16 a[44:47], v[132:135], v[144:147], a[44:47]
    v_mfma_f32_16x16x32_bf16 a[48:51], v[132:135], v[148:151], a[48:51]
    v_mfma_f32_16x16x32_bf16 a[52:55], v[132:135], v[152:155], a[52:55]
    v_mfma_f32_16x16x32_bf16 a[56:59], v[132:135], v[156:159], a[56:59]
    v_mfma_f32_16x16x32_bf16 a[60:63], v[136:139], v[140:143], a[60:63]
    v_mfma_f32_16x16x32_bf16 a[64:67], v[136:139], v[144:147], a[64:67]
    v_mfma_f32_16x16x32_bf16 a[68:71], v[136:139], v[148:151], a[68:71]
    v_mfma_f32_16x16x32_bf16 a[72:75], v[136:139], v[152:155], a[72:75]
    v_mfma_f32_16x16x32_bf16 a[76:79], v[136:139], v[156:159], a[76:79]
    buffer_load_dwordx4 v[124:127], v2, s[20:23], s26 offen offset:0
    buffer_load_dwordx4 v[128:131], v2, s[20:23], s26 offen offset:1024
    buffer_load_dwordx4 v[132:135], v2, s[20:23], s26 offen offset:2048
    buffer_load_dwordx4 v[136:139], v2, s[20:23], s26 offen offset:3072
    buffer_load_dwordx4 v[140:143], v2, s[20:23], s27 offen offset:0
    buffer_load_dwordx4 v[144:147], v2, s[20:23], s27 offen offset:1024
    buffer_load_dwordx4 v[148:151], v2, s[20:23], s27 offen offset:2048
    buffer_load_dwordx4 v[152:155], v2, s[20:23], s27 offen offset:3072
    buffer_load_dwordx4 v[156:159], v3, s[20:23], s27 offen
    s_add_u32 s26, s26, 4096
    s_add_u32 s27, s27, 5120
    s_waitcnt vmcnt(36)
    v_mfma_f32_16x16x32_bf16 a[0:3], v[160:163], v[176:179], a[0:3]
    v_mfma_f32_16x16x32_bf16 a[4:7], v[160:163], v[180:183], a[4:7]
    v_mfma_f32_16x16x32_bf16 a[8:11], v[160:163], v[184:187], a[8:11]
    v_mfma_f32_16x16x32_bf16 a[12:15], v[160:163], v[188:191], a[12:15]
    v_mfma_f32_16x16x32_bf16 a[16:19], v[160:163], v[192:195], a[16:19]
    v_mfma_f32_16x16x32_bf16 a[20:23], v[164:167], v[176:179], a[20:23]
    v_mfma_f32_16x16x32_bf16 a[24:27], v[164:167], v[180:183], a[24:27]
    v_mfma_f32_16x16x32_bf16 a[28:31], v[164:167], v[184:187], a[28:31]
    v_mfma_f32_16x16x32_bf16 a[32:35], v[164:167], v[188:191], a[32:35]
    v_mfma_f32_16x16x32_bf16 a[36:39], v[164:167], v[192:195], a[36:39]
    v_mfma_f32_16x16x32_bf16 a[40:43], v[168:171], v[176:179], a[40:43]
    v_mfma_f32_16x16x32_bf16 a[44:47], v[168:171], v[180:183], a[44:47]
    v_mfma_f32_16x16x32_bf16 a[48:51], v[168:171], v[184:187], a[48:51]
    v_mfma_f32_16x16x32_bf16 a[52:55], v[168:171], v[188:191], a[52:55]
    v_mfma_f32_16x16x32_bf16 a[56:59], v[168:171], v[192:195], a[56:59]
    v_mfma_f32_16x16x32_bf16 a[60:63], v[172:175], v[176:179], a[60:63]
    v_mfma_f32_16x16x32_bf16 a[64:67], v[172:175], v[180:183], a[64:67]
    v_mfma_f32_16x16x32_bf16 a[68:71], v[172:175], v[184:187], a[68:71]
    v_mfma_f32_16x16x32_bf16 a[72:75], v[172:175], v[188:191], a[72:75]
    v_mfma_f32_16x16x32_bf16 a[76:79], v[172:175], v[192:195], a[76:79]
    buffer_load_dwordx4 v[160:163], v2, s[20:23], s26 offen offset:0
    buffer_load_dwordx4 v[164:167], v2, s[20:23], s26 offen offset:1024
    buffer_load_dwordx4 v[168:171], v2, s[20:23], s26 offen offset:2048
    buffer_load_dwordx4 v[172:175], v2, s[20:23], s26 offen offset:3072
    buffer_load_dwordx4 v[176:179], v2, s[20:23], s27 offen offset:0
    buffer_load_dwordx4 v[180:183], v2, s[20:23], s27 offen offset:1024
    buffer_load_dwordx4 v[184:187], v2, s[20:23], s27 offen offset:2048
    buffer_load_dwordx4 v[188:191], v2, s[20:23], s27 offen offset:3072
    buffer_load_dwordx4 v[192:195], v3, s[20:23], s27 offen
    s_add_u32 s26, s26, 4096
    s_add_u32 s27, s27, 5120
    s_waitcnt vmcnt(36)
    v_mfma_f32_16x16x32_bf16 a[0:3], v[16:19], v[32:35], a[0:3]
    v_mfma_f32_16x16x32_bf16 a[4:7], v[16:19], v[36:39], a[4:7]
    v_mfma_f32_16x16x32_bf16 a[8:11], v[16:19], v[40:43], a[8:11]
    v_mfma_f32_16x16x32_bf16 a[12:15], v[16:19], v[44:47], a[12:15]
    v_mfma_f32_16x16x32_bf16 a[16:19], v[16:19], v[48:51], a[16:19]
    v_mfma_f32_16x16x32_bf16 a[20:23], v[20:23], v[32:35], a[20:23]
    v_mfma_f32_16x16x32_bf16 a[24:27], v[20:23], v[36:39], a[24:27]
    v_mfma_f32_16x16x32_bf16 a[28:31], v[20:23], v[40:43], a[28:31]
    v_mfma_f32_16x16x32_bf16 a[32:35], v[20:23], v[44:47], a[32:35]
    v_mfma_f32_16x16x32_bf16 a[36:39], v[20:23], v[48:51], a[36:39]
    v_mfma_f32_16x16x32_bf16 a[40:43], v[24:27], v[32:35], a[40:43]
    v_mfma_f32_16x16x32_bf16 a[44:47], v[24:27], v[36:39], a[44:47]
    v_mfma_f32_16x16x32_bf16 a[48:51], v[24:27], v[40:43], a[48:51]
    v_mfma_f32_16x16x32_bf16 a[52:55], v[24:27], v[44:47], a[52:55]
    v_mfma_f32_16x16x32_bf16 a[56:59], v[24:27], v[48:51], a[56:59]
    v_mfma_f32_16x16x32_bf16 a[60:63], v[28:31], v[32:35], a[60:63]
    v_mfma_f32_16x16x32_bf16 a[64:67], v[28:31], v[36:39], a[64:67]
    v_mfma_f32_16x16x32_bf16 a[68:71], v[28:31], v[40:43], a[68:71]
    v_mfma_f32_16x16x32_bf16 a[72:75], v[28:31], v[44:47], a[72:75]
    v_mfma_f32_16x16x32_bf16 a[76:79], v[28:31], v[48:51], a[76:79]
    buffer_load_dwordx4 v[16:19], v2, s[20:23], s26 offen offset:0
    buffer_load_dwordx4 v[20:23], v2, s[20:23], s26 offen offset:1024
    buffer_load_dwordx4 v[24:27], v2, s[20:23], s26 offen offset:2048
    buffer_load_dwordx4 v[28:31], v2, s[20:23], s26 offen offset:3072
    buffer_load_dwordx4 v[32:35], v2, s[20:23], s27 offen offset:0
    buffer_load_dwordx4 v[36:39], v2, s[20:23], s27 offen offset:1024
    buffer_load_dwordx4 v[40:43], v2, s[20:23], s27 offen offset:2048
    buffer_load_dwordx4 v[44:47], v2, s[20:23], s27 offen offset:3072
    buffer_load_dwordx4 v[48:51], v3, s[20:23], s27 offen
    s_add_u32 s26, s26, 4096
    s_add_u32 s27, s27, 5120
    s_waitcnt vmcnt(36)
    v_mfma_f32_16x16x32_bf16 a[0:3], v[52:55], v[68:71], a[0:3]
    v_mfma_f32_16x16x32_bf16 a[4:7], v[52:55], v[72:75], a[4:7]
    v_mfma_f32_16x16x32_bf16 a[8:11], v[52:55], v[76:79], a[8:11]
    v_mfma_f32_16x16x32_bf16 a[12:15], v[52:55], v[80:83], a[12:15]
    v_mfma_f32_16x16x32_bf16 a[16:19], v[52:55], v[84:87], a[16:19]
    v_mfma_f32_16x16x32_bf16 a[20:23], v[56:59], v[68:71], a[20:23]
    v_mfma_f32_16x16x32_bf16 a[24:27], v[56:59], v[72:75], a[24:27]
    v_mfma_f32_16x16x32_bf16 a[28:31], v[56:59], v[76:79], a[28:31]
    v_mfma_f32_16x16x32_bf16 a[32:35], v[56:59], v[80:83], a[32:35]
    v_mfma_f32_16x16x32_bf16 a[36:39], v[56:59], v[84:87], a[36:39]
    v_mfma_f32_16x16x32_bf16 a[40:43], v[60:63], v[68:71], a[40:43]
    v_mfma_f32_16x16x32_bf16 a[44:47], v[60:63], v[72:75], a[44:47]
    v_mfma_f32_16x16x32_bf16 a[48:51], v[60:63], v[76:79], a[48:51]
    v_mfma_f32_16x16x32_bf16 a[52:55], v[60:63], v[80:83], a[52:55]
    v_mfma_f32_16x16x32_bf16 a[56:59], v[60:63], v[84:87], a[56:59]
    v_mfma_f32_16x16x32_bf16 a[60:63], v[64:67], v[68:71], a[60:63]
    v_mfma_f32_16x16x32_bf16 a[64:67], v[64:67], v[72:75], a[64:67]
    v_mfma_f32_16x16x32_bf16 a[68:71], v[64:67], v[76:79], a[68:71]
    v_mfma_f32_16x16x32_bf16 a[72:75], v[64:67], v[80:83], a[72:75]
    v_mfma_f32_16x16x32_bf16 a[76:79], v[64:67], v[84:87], a[76:79]
    buffer_load_dwordx4 v[52:55], v2, s[20:23], s26 offen offset:0
    buffer_load_dwordx4 v[56:59], v2, s[20:23], s26 offen offset:1024
    buffer_load_dwordx4 v[60:63], v2, s[20:23], s26 offen offset:2048
    buffer_load_dwordx4 v[64:67], v2, s[20:23], s26 offen offset:3072
    buffer_load_dwordx4 v[68:71], v2, s[20:23], s27 offen offset:0
    buffer_load_dwordx4 v[72:75], v2, s[20:23], s27 offen offset:1024
    buffer_load_dwordx4 v[76:79], v2, s[20:23], s27 offen offset:2048
    buffer_load_dwordx4 v[80:83], v2, s[20:23], s27 offen offset:3072
    buffer_load_dwordx4 v[84:87], v3, s[20:23], s27 offen
    s_add_u32 s26, s26, 4096
    s_add_u32 s27, s27, 5120
    s_waitcnt vmcnt(36)
    v_mfma_f32_16x16x32_bf16 a[0:3], v[88:91], v[104:107], a[0:3]
    v_mfma_f32_16x16x32_bf16 a[4:7], v[88:91], v[108:111], a[4:7]
    v_mfma_f32_16x16x32_bf16 a[8:11], v[88:91], v[112:115], a[8:11]
    v_mfma_f32_16x16x32_bf16 a[12:15], v[88:91], v[116:119], a[12:15]
    v_mfma_f32_16x16x32_bf16 a[16:19], v[88:91], v[120:123], a[16:19]
    v_mfma_f32_16x16x32_bf16 a[20:23], v[92:95], v[104:107], a[20:23]
    v_mfma_f32_16x16x32_bf16 a[24:27], v[92:95], v[108:111], a[24:27]
    v_mfma_f32_16x16x32_bf16 a[28:31], v[92:95], v[112:115], a[28:31]
    v_mfma_f32_16x16x32_bf16 a[32:35], v[92:95], v[116:119], a[32:35]
    v_mfma_f32_16x16x32_bf16 a[36:39], v[92:95], v[120:123], a[36:39]
    v_mfma_f32_16x16x32_bf16 a[40:43], v[96:99], v[104:107], a[40:43]
    v_mfma_f32_16x16x32_bf16 a[44:47], v[96:99], v[108:111], a[44:47]
    v_mfma_f32_16x16x32_bf16 a[48:51], v[96:99], v[112:115], a[48:51]
    v_mfma_f32_16x16x32_bf16 a[52:55], v[96:99], v[116:119], a[52:55]
    v_mfma_f32_16x16x32_bf16 a[56:59], v[96:99], v[120:123], a[56:59]
    v_mfma_f32_16x16x32_bf16 a[60:63], v[100:103], v[104:107], a[60:63]
    v_mfma_f32_16x16x32_bf16 a[64:67], v[100:103], v[108:111], a[64:67]
    v_mfma_f32_16x16x32_bf16 a[68:71], v[100:103], v[112:115], a[68:71]
    v_mfma_f32_16x16x32_bf16 a[72:75], v[100:103], v[116:119], a[72:75]
    v_mfma_f32_16x16x32_bf16 a[76:79], v[100:103], v[120:123], a[76:79]
    buffer_load_dwordx4 v[88:91], v2, s[20:23], s26 offen offset:0
    buffer_load_dwordx4 v[92:95], v2, s[20:23], s26 offen offset:1024
    buffer_load_dwordx4 v[96:99], v2, s[20:23], s26 offen offset:2048
    buffer_load_dwordx4 v[100:103], v2, s[20:23], s26 offen offset:3072
    buffer_load_dwordx4 v[104:107], v2, s[20:23], s27 offen offset:0
    buffer_load_dwordx4 v[108:111], v2, s[20:23], s27 offen offset:1024
    buffer_load_dwordx4 v[112:115], v2, s[20:23], s27 offen offset:2048
    buffer_load_dwordx4 v[116:119], v2, s[20:23], s27 offen offset:3072
    buffer_load_dwordx4 v[120:123], v3, s[20:23], s27 offen
    s_add_u32 s26, s26, 4096
    s_add_u32 s27, s27, 5120
    s_waitcnt vmcnt(36)
    v_mfma_f32_16x16x32_bf16 a[0:3], v[124:127], v[140:143], a[0:3]
    v_mfma_f32_16x16x32_bf16 a[4:7], v[124:127], v[144:147], a[4:7]
    v_mfma_f32_16x16x32_bf16 a[8:11], v[124:127], v[148:151], a[8:11]
    v_mfma_f32_16x16x32_bf16 a[12:15], v[124:127], v[152:155], a[12:15]
    v_mfma_f32_16x16x32_bf16 a[16:19], v[124:127], v[156:159], a[16:19]
    v_mfma_f32_16x16x32_bf16 a[20:23], v[128:131], v[140:143], a[20:23]
    v_mfma_f32_16x16x32_bf16 a[24:27], v[128:131], v[144:147], a[24:27]
    v_mfma_f32_16x16x32_bf16 a[28:31], v[128:131], v[148:151], a[28:31]
    v_mfma_f32_16x16x32_bf16 a[32:35], v[128:131], v[152:155], a[32:35]
    v_mfma_f32_16x16x32_bf16 a[36:39], v[128:131], v[156:159], a[36:39]
    v_mfma_f32_16x16x32_bf16 a[40:43], v[132:135], v[140:143], a[40:43]
    v_mfma_f32_16x16x32_bf16 a[44:47], v[132:135], v[144:147], a[44:47]
    v_mfma_f32_16x16x32_bf16 a[48:51], v[132:135], v[148:151], a[48:51]
    v_mfma_f32_16x16x32_bf16 a[52:55], v[132:135], v[152:155], a[52:55]
    v_mfma_f32_16x16x32_bf16 a[56:59], v[132:135], v[156:159], a[56:59]
    v_mfma_f32_16x16x32_bf16 a[60:63], v[136:139], v[140:143], a[60:63]
    v_mfma_f32_16x16x32_bf16 a[64:67], v[136:139], v[144:147], a[64:67]
    v_mfma_f32_16x16x32_bf16 a[68:71], v[136:139], v[148:151], a[68:71]
    v_mfma_f32_16x16x32_bf16 a[72:75], v[136:139], v[152:155], a[72:75]
    v_mfma_f32_16x16x32_bf16 a[76:79], v[136:139], v[156:159], a[76:79]
    buffer_load_dwordx4 v[124:127], v2, s[20:23], s26 offen offset:0
    buffer_load_dwordx4 v[128:131], v2, s[20:23], s26 offen offset:1024
    buffer_load_dwordx4 v[132:135], v2, s[20:23], s26 offen offset:2048
    buffer_load_dwordx4 v[136:139], v2, s[20:23], s26 offen offset:3072
    buffer_load_dwordx4 v[140:143], v2, s[20:23], s27 offen offset:0
    buffer_load_dwordx4 v[144:147], v2, s[20:23], s27 offen offset:1024
    buffer_load_dwordx4 v[148:151], v2, s[20:23], s27 offen offset:2048
    buffer_load_dwordx4 v[152:155], v2, s[20:23], s27 offen offset:3072
    buffer_load_dwordx4 v[156:159], v3, s[20:23], s27 offen
    s_add_u32 s26, s26, 4096
    s_add_u32 s27, s27, 5120
    s_waitcnt vmcnt(36)
    v_mfma_f32_16x16x32_bf16 a[0:3], v[160:163], v[176:179], a[0:3]
    v_mfma_f32_16x16x32_bf16 a[4:7], v[160:163], v[180:183], a[4:7]
    v_mfma_f32_16x16x32_bf16 a[8:11], v[160:163], v[184:187], a[8:11]
    v_mfma_f32_16x16x32_bf16 a[12:15], v[160:163], v[188:191], a[12:15]
    v_mfma_f32_16x16x32_bf16 a[16:19], v[160:163], v[192:195], a[16:19]
    v_mfma_f32_16x16x32_bf16 a[20:23], v[164:167], v[176:179], a[20:23]
    v_mfma_f32_16x16x32_bf16 a[24:27], v[164:167], v[180:183], a[24:27]
    v_mfma_f32_16x16x32_bf16 a[28:31], v[164:167], v[184:187], a[28:31]
    v_mfma_f32_16x16x32_bf16 a[32:35], v[164:167], v[188:191], a[32:35]
    v_mfma_f32_16x16x32_bf16 a[36:39], v[164:167], v[192:195], a[36:39]
    v_mfma_f32_16x16x32_bf16 a[40:43], v[168:171], v[176:179], a[40:43]
    v_mfma_f32_16x16x32_bf16 a[44:47], v[168:171], v[180:183], a[44:47]
    v_mfma_f32_16x16x32_bf16 a[48:51], v[168:171], v[184:187], a[48:51]
    v_mfma_f32_16x16x32_bf16 a[52:55], v[168:171], v[188:191], a[52:55]
    v_mfma_f32_16x16x32_bf16 a[56:59], v[168:171], v[192:195], a[56:59]
    v_mfma_f32_16x16x32_bf16 a[60:63], v[172:175], v[176:179], a[60:63]
    v_mfma_f32_16x16x32_bf16 a[64:67], v[172:175], v[180:183], a[64:67]
    v_mfma_f32_16x16x32_bf16 a[68:71], v[172:175], v[184:187], a[68:71]
    v_mfma_f32_16x16x32_bf16 a[72:75], v[172:175], v[188:191], a[72:75]
    v_mfma_f32_16x16x32_bf16 a[76:79], v[172:175], v[192:195], a[76:79]
    s_waitcnt vmcnt(27)
    v_mfma_f32_16x16x32_bf16 a[0:3], v[16:19], v[32:35], a[0:3]
    v_mfma_f32_16x16x32_bf16 a[4:7], v[16:19], v[36:39], a[4:7]
    v_mfma_f32_16x16x32_bf16 a[8:11], v[16:19], v[40:43], a[8:11]
    v_mfma_f32_16x16x32_bf16 a[12:15], v[16:19], v[44:47], a[12:15]
    v_mfma_f32_16x16x32_bf16 a[16:19], v[16:19], v[48:51], a[16:19]
    v_mfma_f32_16x16x32_bf16 a[20:23], v[20:23], v[32:35], a[20:23]
    v_mfma_f32_16x16x32_bf16 a[24:27], v[20:23], v[36:39], a[24:27]
    v_mfma_f32_16x16x32_bf16 a[28:31], v[20:23], v[40:43], a[28:31]
    v_mfma_f32_16x16x32_bf16 a[32:35], v[20:23], v[44:47], a[32:35]
    v_mfma_f32_16x16x32_bf16 a[36:39], v[20:23], v[48:51], a[36:39]
    v_mfma_f32_16x16x32_bf16 a[40:43], v[24:27], v[32:35], a[40:43]
    v_mfma_f32_16x16x32_bf16 a[44:47], v[24:27], v[36:39], a[44:47]
    v_mfma_f32_16x16x32_bf16 a[48:51], v[24:27], v[40:43], a[48:51]
    v_mfma_f32_16x16x32_bf16 a[52:55], v[24:27], v[44:47], a[52:55]
    v_mfma_f32_16x16x32_bf16 a[56:59], v[24:27], v[48:51], a[56:59]
    v_mfma_f32_16x16x32_bf16 a[60:63], v[28:31], v[32:35], a[60:63]
    v_mfma_f32_16x16x32_bf16 a[64:67], v[28:31], v[36:39], a[64:67]
    v_mfma_f32_16x16x32_bf16 a[68:71], v[28:31], v[40:43], a[68:71]
    v_mfma_f32_16x16x32_bf16 a[72:75], v[28:31], v[44:47], a[72:75]
    v_mfma_f32_16x16x32_bf16 a[76:79], v[28:31], v[48:51], a[76:79]
    s_waitcnt vmcnt(18)
    v_mfma_f32_16x16x32_bf16 a[0:3], v[52:55], v[68:71], a[0:3]
    v_mfma_f32_16x16x32_bf16 a[4:7], v[52:55], v[72:75], a[4:7]
    v_mfma_f32_16x16x32_bf16 a[8:11], v[52:55], v[76:79], a[8:11]
    v_mfma_f32_16x16x32_bf16 a[12:15], v[52:55], v[80:83], a[12:15]
    v_mfma_f32_16x16x32_bf16 a[16:19], v[52:55], v[84:87], a[16:19]
    v_mfma_f32_16x16x32_bf16 a[20:23], v[56:59], v[68:71], a[20:23]
    v_mfma_f32_16x16x32_bf16 a[24:27], v[56:59], v[72:75], a[24:27]
    v_mfma_f32_16x16x32_bf16 a[28:31], v[56:59], v[76:79], a[28:31]
    v_mfma_f32_16x16x32_bf16 a[32:35], v[56:59], v[80:83], a[32:35]
    v_mfma_f32_16x16x32_bf16 a[36:39], v[56:59], v[84:87], a[36:39]
    v_mfma_f32_16x16x32_bf16 a[40:43], v[60:63], v[68:71], a[40:43]
    v_mfma_f32_16x16x32_bf16 a[44:47], v[60:63], v[72:75], a[44:47]
    v_mfma_f32_16x16x32_bf16 a[48:51], v[60:63], v[76:79], a[48:51]
    v_mfma_f32_16x16x32_bf16 a[52:55], v[60:63], v[80:83], a[52:55]
    v_mfma_f32_16x16x32_bf16 a[56:59], v[60:63], v[84:87], a[56:59]
    v_mfma_f32_16x16x32_bf16 a[60:63], v[64:67], v[68:71], a[60:63]
    v_mfma_f32_16x16x32_bf16 a[64:67], v[64:67], v[72:75], a[64:67]
    v_mfma_f32_16x16x32_bf16 a[68:71], v[64:67], v[76:79], a[68:71]
    v_mfma_f32_16x16x32_bf16 a[72:75], v[64:67], v[80:83], a[72:75]
    v_mfma_f32_16x16x32_bf16 a[76:79], v[64:67], v[84:87], a[76:79]
    s_waitcnt vmcnt(9)
    v_mfma_f32_16x16x32_bf16 a[0:3], v[88:91], v[104:107], a[0:3]
    v_mfma_f32_16x16x32_bf16 a[4:7], v[88:91], v[108:111], a[4:7]
    v_mfma_f32_16x16x32_bf16 a[8:11], v[88:91], v[112:115], a[8:11]
    v_mfma_f32_16x16x32_bf16 a[12:15], v[88:91], v[116:119], a[12:15]
    v_mfma_f32_16x16x32_bf16 a[16:19], v[88:91], v[120:123], a[16:19]
    v_mfma_f32_16x16x32_bf16 a[20:23], v[92:95], v[104:107], a[20:23]
    v_mfma_f32_16x16x32_bf16 a[24:27], v[92:95], v[108:111], a[24:27]
    v_mfma_f32_16x16x32_bf16 a[28:31], v[92:95], v[112:115], a[28:31]
    v_mfma_f32_16x16x32_bf16 a[32:35], v[92:95], v[116:119], a[32:35]
    v_mfma_f32_16x16x32_bf16 a[36:39], v[92:95], v[120:123], a[36:39]
    v_mfma_f32_16x16x32_bf16 a[40:43], v[96:99], v[104:107], a[40:43]
    v_mfma_f32_16x16x32_bf16 a[44:47], v[96:99], v[108:111], a[44:47]
    v_mfma_f32_16x16x32_bf16 a[48:51], v[96:99], v[112:115], a[48:51]
    v_mfma_f32_16x16x32_bf16 a[52:55], v[96:99], v[116:119], a[52:55]
    v_mfma_f32_16x16x32_bf16 a[56:59], v[96:99], v[120:123], a[56:59]
    v_mfma_f32_16x16x32_bf16 a[60:63], v[100:103], v[104:107], a[60:63]
    v_mfma_f32_16x16x32_bf16 a[64:67], v[100:103], v[108:111], a[64:67]
    v_mfma_f32_16x16x32_bf16 a[68:71], v[100:103], v[112:115], a[68:71]
    v_mfma_f32_16x16x32_bf16 a[72:75], v[100:103], v[116:119], a[72:75]
    v_mfma_f32_16x16x32_bf16 a[76:79], v[100:103], v[120:123], a[76:79]
    s_waitcnt vmcnt(0)
    v_mfma_f32_16x16x32_bf16 a[0:3], v[124:127], v[140:143], a[0:3]
    v_mfma_f32_16x16x32_bf16 a[4:7], v[124:127], v[144:147], a[4:7]
    v_mfma_f32_16x16x32_bf16 a[8:11], v[124:127], v[148:151], a[8:11]
    v_mfma_f32_16x16x32_bf16 a[12:15], v[124:127], v[152:155], a[12:15]
    v_mfma_f32_16x16x32_bf16 a[16:19], v[124:127], v[156:159], a[16:19]
    v_mfma_f32_16x16x32_bf16 a[20:23], v[128:131], v[140:143], a[20:23]
    v_mfma_f32_16x16x32_bf16 a[24:27], v[128:131], v[144:147], a[24:27]
    v_mfma_f32_16x16x32_bf16 a[28:31], v[128:131], v[148:151], a[28:31]
    v_mfma_f32_16x16x32_bf16 a[32:35], v[128:131], v[152:155], a[32:35]
    v_mfma_f32_16x16x32_bf16 a[36:39], v[128:131], v[156:159], a[36:39]
    v_mfma_f32_16x16x32_bf16 a[40:43], v[132:135], v[140:143], a[40:43]
    v_mfma_f32_16x16x32_bf16 a[44:47], v[132:135], v[144:147], a[44:47]
    v_mfma_f32_16x16x32_bf16 a[48:51], v[132:135], v[148:151], a[48:51]
    v_mfma_f32_16x16x32_bf16 a[52:55], v[132:135], v[152:155], a[52:55]
    v_mfma_f32_16x16x32_bf16 a[56:59], v[132:135], v[156:159], a[56:59]
    v_mfma_f32_16x16x32_bf16 a[60:63], v[136:139], v[140:143], a[60:63]
    v_mfma_f32_16x16x32_bf16 a[64:67], v[136:139], v[144:147], a[64:67]
    v_mfma_f32_16x16x32_bf16 a[68:71], v[136:139], v[148:151], a[68:71]
    v_mfma_f32_16x16x32_bf16 a[72:75], v[136:139], v[152:155], a[72:75]
    v_mfma_f32_16x16x32_bf16 a[76:79], v[136:139], v[156:159], a[76:79]
    s_branch K3_RED
K3_H:
    s_mul_i32 s26, s24, 40
    s_mul_i32 s30, s31, 20
    s_add_u32 s26, s26, s30
    s_lshl_b32 s26, s26, 12
    s_add_u32 s26, s26, 8388608
    s_mul_i32 s27, s25, 40
    s_add_u32 s27, s27, s30
    s_mul_i32 s27, s27, 5120
    s_add_u32 s27, s27, 18874368
    buffer_load_dwordx4 v[16:19], v2, s[20:23], s26 offen offset:0
    buffer_load_dwordx4 v[20:23], v2, s[20:23], s26 offen offset:1024
    buffer_load_dwordx4 v[24:27], v2, s[20:23], s26 offen offset:2048
    buffer_load_dwordx4 v[28:31], v2, s[20:23], s26 offen offset:3072
    buffer_load_dwordx4 v[32:35], v2, s[20:23], s27 offen offset:0
    buffer_load_dwordx4 v[36:39], v2, s[20:23], s27 offen offset:1024
    buffer_load_dwordx4 v[40:43], v2, s[20:23], s27 offen offset:2048
    buffer_load_dwordx4 v[44:47], v2, s[20:23], s27 offen offset:3072
    buffer_load_dwordx4 v[48:51], v3, s[20:23], s27 offen
    s_add_u32 s26, s26, 4096
    s_add_u32 s27, s27, 5120
    buffer_load_dwordx4 v[52:55], v2, s[20:23], s26 offen offset:0
    buffer_load_dwordx4 v[56:59], v2, s[20:23], s26 offen offset:1024
    buffer_load_dwordx4 v[60:63], v2, s[20:23], s26 offen offset:2048
    buffer_load_dwordx4 v[64:67], v2, s[20:23], s26 offen offset:3072
    buffer_load_dwordx4 v[68:71], v2, s[20:23], s27 offen offset:0
    buffer_load_dwordx4 v[72:75], v2, s[20:23], s27 offen offset:1024
    buffer_load_dwordx4 v[76:79], v2, s[20:23], s27 offen offset:2048
    buffer_load_dwordx4 v[80:83], v2, s[20:23], s27 offen offset:3072
    buffer_load_dwordx4 v[84:87], v3, s[20:23], s27 offen
    s_add_u32 s26, s26, 4096
    s_add_u32 s27, s27, 5120
    buffer_load_dwordx4 v[88:91], v2, s[20:23], s26 offen offset:0
    buffer_load_dwordx4 v[92:95], v2, s[20:23], s26 offen offset:1024
    buffer_load_dwordx4 v[96:99], v2, s[20:23], s26 offen offset:2048
    buffer_load_dwordx4 v[100:103], v2, s[20:23], s26 offen offset:3072
    buffer_load_dwordx4 v[104:107], v2, s[20:23], s27 offen offset:0
    buffer_load_dwordx4 v[108:111], v2, s[20:23], s27 offen offset:1024
    buffer_load_dwordx4 v[112:115], v2, s[20:23], s27 offen offset:2048
    buffer_load_dwordx4 v[116:119], v2, s[20:23], s27 offen offset:3072
    buffer_load_dwordx4 v[120:123], v3, s[20:23], s27 offen
    s_add_u32 s26, s26, 4096
    s_add_u32 s27, s27, 5120
    buffer_load_dwordx4 v[124:127], v2, s[20:23], s26 offen offset:0
    buffer_load_dwordx4 v[128:131], v2, s[20:23], s26 offen offset:1024
    buffer_load_dwordx4 v[132:135], v2, s[20:23], s26 offen offset:2048
    buffer_load_dwordx4 v[136:139], v2, s[20:23], s26 offen offset:3072
    buffer_load_dwordx4 v[140:143], v2, s[20:23], s27 offen offset:0
    buffer_load_dwordx4 v[144:147], v2, s[20:23], s27 offen offset:1024
    buffer_load_dwordx4 v[148:151], v2, s[20:23], s27 offen offset:2048
    buffer_load_dwordx4 v[152:155], v2, s[20:23], s27 offen offset:3072
    buffer_load_dwordx4 v[156:159], v3, s[20:23], s27 offen
    s_add_u32 s26, s26, 4096
    s_add_u32 s27, s27, 5120
    buffer_load_dwordx4 v[160:163], v2, s[20:23], s26 offen offset:0
    buffer_load_dwordx4 v[164:167], v2, s[20:23], s26 offen offset:1024
    buffer_load_dwordx4 v[168:171], v2, s[20:23], s26 offen offset:2048
    buffer_load_dwordx4 v[172:175], v2, s[20:23], s26 offen offset:3072
    buffer_load_dwordx4 v[176:179], v2, s[20:23], s27 offen offset:0
    buffer_load_dwordx4 v[180:183], v2, s[20:23], s27 offen offset:1024
    buffer_load_dwordx4 v[184:187], v2, s[20:23], s27 offen offset:2048
    buffer_load_dwordx4 v[188:191], v2, s[20:23], s27 offen offset:3072
    buffer_load_dwordx4 v[192:195], v3, s[20:23], s27 offen
    s_add_u32 s26, s26, 4096
    s_add_u32 s27, s27, 5120
    v_accvgpr_write_b32 a0, 0
    v_accvgpr_write_b32 a1, 0
    v_accvgpr_write_b32 a2, 0
    v_accvgpr_write_b32 a3, 0
    v_accvgpr_write_b32 a4, 0
    v_accvgpr_write_b32 a5, 0
    v_accvgpr_write_b32 a6, 0
    v_accvgpr_write_b32 a7, 0
    v_accvgpr_write_b32 a8, 0
    v_accvgpr_write_b32 a9, 0
    v_accvgpr_write_b32 a10, 0
    v_accvgpr_write_b32 a11, 0
    v_accvgpr_write_b32 a12, 0
    v_accvgpr_write_b32 a13, 0
    v_accvgpr_write_b32 a14, 0
    v_accvgpr_write_b32 a15, 0
    v_accvgpr_write_b32 a16, 0
    v_accvgpr_write_b32 a17, 0
    v_accvgpr_write_b32 a18, 0
    v_accvgpr_write_b32 a19, 0
    v_accvgpr_write_b32 a20, 0
    v_accvgpr_write_b32 a21, 0
    v_accvgpr_write_b32 a22, 0
    v_accvgpr_write_b32 a23, 0
    v_accvgpr_write_b32 a24, 0
    v_accvgpr_write_b32 a25, 0
    v_accvgpr_write_b32 a26, 0
    v_accvgpr_write_b32 a27, 0
    v_accvgpr_write_b32 a28, 0
    v_accvgpr_write_b32 a29, 0
    v_accvgpr_write_b32 a30, 0
    v_accvgpr_write_b32 a31, 0
    v_accvgpr_write_b32 a32, 0
    v_accvgpr_write_b32 a33, 0
    v_accvgpr_write_b32 a34, 0
    v_accvgpr_write_b32 a35, 0
    v_accvgpr_write_b32 a36, 0
    v_accvgpr_write_b32 a37, 0
    v_accvgpr_write_b32 a38, 0
    v_accvgpr_write_b32 a39, 0
    v_accvgpr_write_b32 a40, 0
    v_accvgpr_write_b32 a41, 0
    v_accvgpr_write_b32 a42, 0
    v_accvgpr_write_b32 a43, 0
    v_accvgpr_write_b32 a44, 0
    v_accvgpr_write_b32 a45, 0
    v_accvgpr_write_b32 a46, 0
    v_accvgpr_write_b32 a47, 0
    v_accvgpr_write_b32 a48, 0
    v_accvgpr_write_b32 a49, 0
    v_accvgpr_write_b32 a50, 0
    v_accvgpr_write_b32 a51, 0
    v_accvgpr_write_b32 a52, 0
    v_accvgpr_write_b32 a53, 0
    v_accvgpr_write_b32 a54, 0
    v_accvgpr_write_b32 a55, 0
    v_accvgpr_write_b32 a56, 0
    v_accvgpr_write_b32 a57, 0
    v_accvgpr_write_b32 a58, 0
    v_accvgpr_write_b32 a59, 0
    v_accvgpr_write_b32 a60, 0
    v_accvgpr_write_b32 a61, 0
    v_accvgpr_write_b32 a62, 0
    v_accvgpr_write_b32 a63, 0
    v_accvgpr_write_b32 a64, 0
    v_accvgpr_write_b32 a65, 0
    v_accvgpr_write_b32 a66, 0
    v_accvgpr_write_b32 a67, 0
    v_accvgpr_write_b32 a68, 0
    v_accvgpr_write_b32 a69, 0
    v_accvgpr_write_b32 a70, 0
    v_accvgpr_write_b32 a71, 0
    v_accvgpr_write_b32 a72, 0
    v_accvgpr_write_b32 a73, 0
    v_accvgpr_write_b32 a74, 0
    v_accvgpr_write_b32 a75, 0
    v_accvgpr_write_b32 a76, 0
    v_accvgpr_write_b32 a77, 0
    v_accvgpr_write_b32 a78, 0
    v_accvgpr_write_b32 a79, 0
    s_waitcnt vmcnt(36)
    v_mfma_f32_16x16x32_bf16 a[0:3], v[16:19], v[32:35], a[0:3]
    v_mfma_f32_16x16x32_bf16 a[4:7], v[16:19], v[36:39], a[4:7]
    v_mfma_f32_16x16x32_bf16 a[8:11], v[16:19], v[40:43], a[8:11]
    v_mfma_f32_16x16x32_bf16 a[12:15], v[16:19], v[44:47], a[12:15]
    v_mfma_f32_16x16x32_bf16 a[16:19], v[16:19], v[48:51], a[16:19]
    v_mfma_f32_16x16x32_bf16 a[20:23], v[20:23], v[32:35], a[20:23]
    v_mfma_f32_16x16x32_bf16 a[24:27], v[20:23], v[36:39], a[24:27]
    v_mfma_f32_16x16x32_bf16 a[28:31], v[20:23], v[40:43], a[28:31]
    v_mfma_f32_16x16x32_bf16 a[32:35], v[20:23], v[44:47], a[32:35]
    v_mfma_f32_16x16x32_bf16 a[36:39], v[20:23], v[48:51], a[36:39]
    v_mfma_f32_16x16x32_bf16 a[40:43], v[24:27], v[32:35], a[40:43]
    v_mfma_f32_16x16x32_bf16 a[44:47], v[24:27], v[36:39], a[44:47]
    v_mfma_f32_16x16x32_bf16 a[48:51], v[24:27], v[40:43], a[48:51]
    v_mfma_f32_16x16x32_bf16 a[52:55], v[24:27], v[44:47], a[52:55]
    v_mfma_f32_16x16x32_bf16 a[56:59], v[24:27], v[48:51], a[56:59]
    v_mfma_f32_16x16x32_bf16 a[60:63], v[28:31], v[32:35], a[60:63]
    v_mfma_f32_16x16x32_bf16 a[64:67], v[28:31], v[36:39], a[64:67]
    v_mfma_f32_16x16x32_bf16 a[68:71], v[28:31], v[40:43], a[68:71]
    v_mfma_f32_16x16x32_bf16 a[72:75], v[28:31], v[44:47], a[72:75]
    v_mfma_f32_16x16x32_bf16 a[76:79], v[28:31], v[48:51], a[76:79]
    buffer_load_dwordx4 v[16:19], v2, s[20:23], s26 offen offset:0
    buffer_load_dwordx4 v[20:23], v2, s[20:23], s26 offen offset:1024
    buffer_load_dwordx4 v[24:27], v2, s[20:23], s26 offen offset:2048
    buffer_load_dwordx4 v[28:31], v2, s[20:23], s26 offen offset:3072
    buffer_load_dwordx4 v[32:35], v2, s[20:23], s27 offen offset:0
    buffer_load_dwordx4 v[36:39], v2, s[20:23], s27 offen offset:1024
    buffer_load_dwordx4 v[40:43], v2, s[20:23], s27 offen offset:2048
    buffer_load_dwordx4 v[44:47], v2, s[20:23], s27 offen offset:3072
    buffer_load_dwordx4 v[48:51], v3, s[20:23], s27 offen
    s_add_u32 s26, s26, 4096
    s_add_u32 s27, s27, 5120
    s_waitcnt vmcnt(36)
    v_mfma_f32_16x16x32_bf16 a[0:3], v[52:55], v[68:71], a[0:3]
    v_mfma_f32_16x16x32_bf16 a[4:7], v[52:55], v[72:75], a[4:7]
    v_mfma_f32_16x16x32_bf16 a[8:11], v[52:55], v[76:79], a[8:11]
    v_mfma_f32_16x16x32_bf16 a[12:15], v[52:55], v[80:83], a[12:15]
    v_mfma_f32_16x16x32_bf16 a[16:19], v[52:55], v[84:87], a[16:19]
    v_mfma_f32_16x16x32_bf16 a[20:23], v[56:59], v[68:71], a[20:23]
    v_mfma_f32_16x16x32_bf16 a[24:27], v[56:59], v[72:75], a[24:27]
    v_mfma_f32_16x16x32_bf16 a[28:31], v[56:59], v[76:79], a[28:31]
    v_mfma_f32_16x16x32_bf16 a[32:35], v[56:59], v[80:83], a[32:35]
    v_mfma_f32_16x16x32_bf16 a[36:39], v[56:59], v[84:87], a[36:39]
    v_mfma_f32_16x16x32_bf16 a[40:43], v[60:63], v[68:71], a[40:43]
    v_mfma_f32_16x16x32_bf16 a[44:47], v[60:63], v[72:75], a[44:47]
    v_mfma_f32_16x16x32_bf16 a[48:51], v[60:63], v[76:79], a[48:51]
    v_mfma_f32_16x16x32_bf16 a[52:55], v[60:63], v[80:83], a[52:55]
    v_mfma_f32_16x16x32_bf16 a[56:59], v[60:63], v[84:87], a[56:59]
    v_mfma_f32_16x16x32_bf16 a[60:63], v[64:67], v[68:71], a[60:63]
    v_mfma_f32_16x16x32_bf16 a[64:67], v[64:67], v[72:75], a[64:67]
    v_mfma_f32_16x16x32_bf16 a[68:71], v[64:67], v[76:79], a[68:71]
    v_mfma_f32_16x16x32_bf16 a[72:75], v[64:67], v[80:83], a[72:75]
    v_mfma_f32_16x16x32_bf16 a[76:79], v[64:67], v[84:87], a[76:79]
    buffer_load_dwordx4 v[52:55], v2, s[20:23], s26 offen offset:0
    buffer_load_dwordx4 v[56:59], v2, s[20:23], s26 offen offset:1024
    buffer_load_dwordx4 v[60:63], v2, s[20:23], s26 offen offset:2048
    buffer_load_dwordx4 v[64:67], v2, s[20:23], s26 offen offset:3072
    buffer_load_dwordx4 v[68:71], v2, s[20:23], s27 offen offset:0
    buffer_load_dwordx4 v[72:75], v2, s[20:23], s27 offen offset:1024
    buffer_load_dwordx4 v[76:79], v2, s[20:23], s27 offen offset:2048
    buffer_load_dwordx4 v[80:83], v2, s[20:23], s27 offen offset:3072
    buffer_load_dwordx4 v[84:87], v3, s[20:23], s27 offen
    s_add_u32 s26, s26, 4096
    s_add_u32 s27, s27, 5120
    s_waitcnt vmcnt(36)
    v_mfma_f32_16x16x32_bf16 a[0:3], v[88:91], v[104:107], a[0:3]
    v_mfma_f32_16x16x32_bf16 a[4:7], v[88:91], v[108:111], a[4:7]
    v_mfma_f32_16x16x32_bf16 a[8:11], v[88:91], v[112:115], a[8:11]
    v_mfma_f32_16x16x32_bf16 a[12:15], v[88:91], v[116:119], a[12:15]
    v_mfma_f32_16x16x32_bf16 a[16:19], v[88:91], v[120:123], a[16:19]
    v_mfma_f32_16x16x32_bf16 a[20:23], v[92:95], v[104:107], a[20:23]
    v_mfma_f32_16x16x32_bf16 a[24:27], v[92:95], v[108:111], a[24:27]
    v_mfma_f32_16x16x32_bf16 a[28:31], v[92:95], v[112:115], a[28:31]
    v_mfma_f32_16x16x32_bf16 a[32:35], v[92:95], v[116:119], a[32:35]
    v_mfma_f32_16x16x32_bf16 a[36:39], v[92:95], v[120:123], a[36:39]
    v_mfma_f32_16x16x32_bf16 a[40:43], v[96:99], v[104:107], a[40:43]
    v_mfma_f32_16x16x32_bf16 a[44:47], v[96:99], v[108:111], a[44:47]
    v_mfma_f32_16x16x32_bf16 a[48:51], v[96:99], v[112:115], a[48:51]
    v_mfma_f32_16x16x32_bf16 a[52:55], v[96:99], v[116:119], a[52:55]
    v_mfma_f32_16x16x32_bf16 a[56:59], v[96:99], v[120:123], a[56:59]
    v_mfma_f32_16x16x32_bf16 a[60:63], v[100:103], v[104:107], a[60:63]
    v_mfma_f32_16x16x32_bf16 a[64:67], v[100:103], v[108:111], a[64:67]
    v_mfma_f32_16x16x32_bf16 a[68:71], v[100:103], v[112:115], a[68:71]
    v_mfma_f32_16x16x32_bf16 a[72:75], v[100:103], v[116:119], a[72:75]
    v_mfma_f32_16x16x32_bf16 a[76:79], v[100:103], v[120:123], a[76:79]
    buffer_load_dwordx4 v[88:91], v2, s[20:23], s26 offen offset:0
    buffer_load_dwordx4 v[92:95], v2, s[20:23], s26 offen offset:1024
    buffer_load_dwordx4 v[96:99], v2, s[20:23], s26 offen offset:2048
    buffer_load_dwordx4 v[100:103], v2, s[20:23], s26 offen offset:3072
    buffer_load_dwordx4 v[104:107], v2, s[20:23], s27 offen offset:0
    buffer_load_dwordx4 v[108:111], v2, s[20:23], s27 offen offset:1024
    buffer_load_dwordx4 v[112:115], v2, s[20:23], s27 offen offset:2048
    buffer_load_dwordx4 v[116:119], v2, s[20:23], s27 offen offset:3072
    buffer_load_dwordx4 v[120:123], v3, s[20:23], s27 offen
    s_add_u32 s26, s26, 4096
    s_add_u32 s27, s27, 5120
    s_waitcnt vmcnt(36)
    v_mfma_f32_16x16x32_bf16 a[0:3], v[124:127], v[140:143], a[0:3]
    v_mfma_f32_16x16x32_bf16 a[4:7], v[124:127], v[144:147], a[4:7]
    v_mfma_f32_16x16x32_bf16 a[8:11], v[124:127], v[148:151], a[8:11]
    v_mfma_f32_16x16x32_bf16 a[12:15], v[124:127], v[152:155], a[12:15]
    v_mfma_f32_16x16x32_bf16 a[16:19], v[124:127], v[156:159], a[16:19]
    v_mfma_f32_16x16x32_bf16 a[20:23], v[128:131], v[140:143], a[20:23]
    v_mfma_f32_16x16x32_bf16 a[24:27], v[128:131], v[144:147], a[24:27]
    v_mfma_f32_16x16x32_bf16 a[28:31], v[128:131], v[148:151], a[28:31]
    v_mfma_f32_16x16x32_bf16 a[32:35], v[128:131], v[152:155], a[32:35]
    v_mfma_f32_16x16x32_bf16 a[36:39], v[128:131], v[156:159], a[36:39]
    v_mfma_f32_16x16x32_bf16 a[40:43], v[132:135], v[140:143], a[40:43]
    v_mfma_f32_16x16x32_bf16 a[44:47], v[132:135], v[144:147], a[44:47]
    v_mfma_f32_16x16x32_bf16 a[48:51], v[132:135], v[148:151], a[48:51]
    v_mfma_f32_16x16x32_bf16 a[52:55], v[132:135], v[152:155], a[52:55]
    v_mfma_f32_16x16x32_bf16 a[56:59], v[132:135], v[156:159], a[56:59]
    v_mfma_f32_16x16x32_bf16 a[60:63], v[136:139], v[140:143], a[60:63]
    v_mfma_f32_16x16x32_bf16 a[64:67], v[136:139], v[144:147], a[64:67]
    v_mfma_f32_16x16x32_bf16 a[68:71], v[136:139], v[148:151], a[68:71]
    v_mfma_f32_16x16x32_bf16 a[72:75], v[136:139], v[152:155], a[72:75]
    v_mfma_f32_16x16x32_bf16 a[76:79], v[136:139], v[156:159], a[76:79]
    buffer_load_dwordx4 v[124:127], v2, s[20:23], s26 offen offset:0
    buffer_load_dwordx4 v[128:131], v2, s[20:23], s26 offen offset:1024
    buffer_load_dwordx4 v[132:135], v2, s[20:23], s26 offen offset:2048
    buffer_load_dwordx4 v[136:139], v2, s[20:23], s26 offen offset:3072
    buffer_load_dwordx4 v[140:143], v2, s[20:23], s27 offen offset:0
    buffer_load_dwordx4 v[144:147], v2, s[20:23], s27 offen offset:1024
    buffer_load_dwordx4 v[148:151], v2, s[20:23], s27 offen offset:2048
    buffer_load_dwordx4 v[152:155], v2, s[20:23], s27 offen offset:3072
    buffer_load_dwordx4 v[156:159], v3, s[20:23], s27 offen
    s_add_u32 s26, s26, 4096
    s_add_u32 s27, s27, 5120
    s_waitcnt vmcnt(36)
    v_mfma_f32_16x16x32_bf16 a[0:3], v[160:163], v[176:179], a[0:3]
    v_mfma_f32_16x16x32_bf16 a[4:7], v[160:163], v[180:183], a[4:7]
    v_mfma_f32_16x16x32_bf16 a[8:11], v[160:163], v[184:187], a[8:11]
    v_mfma_f32_16x16x32_bf16 a[12:15], v[160:163], v[188:191], a[12:15]
    v_mfma_f32_16x16x32_bf16 a[16:19], v[160:163], v[192:195], a[16:19]
    v_mfma_f32_16x16x32_bf16 a[20:23], v[164:167], v[176:179], a[20:23]
    v_mfma_f32_16x16x32_bf16 a[24:27], v[164:167], v[180:183], a[24:27]
    v_mfma_f32_16x16x32_bf16 a[28:31], v[164:167], v[184:187], a[28:31]
    v_mfma_f32_16x16x32_bf16 a[32:35], v[164:167], v[188:191], a[32:35]
    v_mfma_f32_16x16x32_bf16 a[36:39], v[164:167], v[192:195], a[36:39]
    v_mfma_f32_16x16x32_bf16 a[40:43], v[168:171], v[176:179], a[40:43]
    v_mfma_f32_16x16x32_bf16 a[44:47], v[168:171], v[180:183], a[44:47]
    v_mfma_f32_16x16x32_bf16 a[48:51], v[168:171], v[184:187], a[48:51]
    v_mfma_f32_16x16x32_bf16 a[52:55], v[168:171], v[188:191], a[52:55]
    v_mfma_f32_16x16x32_bf16 a[56:59], v[168:171], v[192:195], a[56:59]
    v_mfma_f32_16x16x32_bf16 a[60:63], v[172:175], v[176:179], a[60:63]
    v_mfma_f32_16x16x32_bf16 a[64:67], v[172:175], v[180:183], a[64:67]
    v_mfma_f32_16x16x32_bf16 a[68:71], v[172:175], v[184:187], a[68:71]
    v_mfma_f32_16x16x32_bf16 a[72:75], v[172:175], v[188:191], a[72:75]
    v_mfma_f32_16x16x32_bf16 a[76:79], v[172:175], v[192:195], a[76:79]
    buffer_load_dwordx4 v[160:163], v2, s[20:23], s26 offen offset:0
    buffer_load_dwordx4 v[164:167], v2, s[20:23], s26 offen offset:1024
    buffer_load_dwordx4 v[168:171], v2, s[20:23], s26 offen offset:2048
    buffer_load_dwordx4 v[172:175], v2, s[20:23], s26 offen offset:3072
    buffer_load_dwordx4 v[176:179], v2, s[20:23], s27 offen offset:0
    buffer_load_dwordx4 v[180:183], v2, s[20:23], s27 offen offset:1024
    buffer_load_dwordx4 v[184:187], v2, s[20:23], s27 offen offset:2048
    buffer_load_dwordx4 v[188:191], v2, s[20:23], s27 offen offset:3072
    buffer_load_dwordx4 v[192:195], v3, s[20:23], s27 offen
    s_add_u32 s26, s26, 4096
    s_add_u32 s27, s27, 5120
    s_waitcnt vmcnt(36)
    v_mfma_f32_16x16x32_bf16 a[0:3], v[16:19], v[32:35], a[0:3]
    v_mfma_f32_16x16x32_bf16 a[4:7], v[16:19], v[36:39], a[4:7]
    v_mfma_f32_16x16x32_bf16 a[8:11], v[16:19], v[40:43], a[8:11]
    v_mfma_f32_16x16x32_bf16 a[12:15], v[16:19], v[44:47], a[12:15]
    v_mfma_f32_16x16x32_bf16 a[16:19], v[16:19], v[48:51], a[16:19]
    v_mfma_f32_16x16x32_bf16 a[20:23], v[20:23], v[32:35], a[20:23]
    v_mfma_f32_16x16x32_bf16 a[24:27], v[20:23], v[36:39], a[24:27]
    v_mfma_f32_16x16x32_bf16 a[28:31], v[20:23], v[40:43], a[28:31]
    v_mfma_f32_16x16x32_bf16 a[32:35], v[20:23], v[44:47], a[32:35]
    v_mfma_f32_16x16x32_bf16 a[36:39], v[20:23], v[48:51], a[36:39]
    v_mfma_f32_16x16x32_bf16 a[40:43], v[24:27], v[32:35], a[40:43]
    v_mfma_f32_16x16x32_bf16 a[44:47], v[24:27], v[36:39], a[44:47]
    v_mfma_f32_16x16x32_bf16 a[48:51], v[24:27], v[40:43], a[48:51]
    v_mfma_f32_16x16x32_bf16 a[52:55], v[24:27], v[44:47], a[52:55]
    v_mfma_f32_16x16x32_bf16 a[56:59], v[24:27], v[48:51], a[56:59]
    v_mfma_f32_16x16x32_bf16 a[60:63], v[28:31], v[32:35], a[60:63]
    v_mfma_f32_16x16x32_bf16 a[64:67], v[28:31], v[36:39], a[64:67]
    v_mfma_f32_16x16x32_bf16 a[68:71], v[28:31], v[40:43], a[68:71]
    v_mfma_f32_16x16x32_bf16 a[72:75], v[28:31], v[44:47], a[72:75]
    v_mfma_f32_16x16x32_bf16 a[76:79], v[28:31], v[48:51], a[76:79]
    buffer_load_dwordx4 v[16:19], v2, s[20:23], s26 offen offset:0
    buffer_load_dwordx4 v[20:23], v2, s[20:23], s26 offen offset:1024
    buffer_load_dwordx4 v[24:27], v2, s[20:23], s26 offen offset:2048
    buffer_load_dwordx4 v[28:31], v2, s[20:23], s26 offen offset:3072
    buffer_load_dwordx4 v[32:35], v2, s[20:23], s27 offen offset:0
    buffer_load_dwordx4 v[36:39], v2, s[20:23], s27 offen offset:1024
    buffer_load_dwordx4 v[40:43], v2, s[20:23], s27 offen offset:2048
    buffer_load_dwordx4 v[44:47], v2, s[20:23], s27 offen offset:3072
    buffer_load_dwordx4 v[48:51], v3, s[20:23], s27 offen
    s_add_u32 s26, s26, 4096
    s_add_u32 s27, s27, 5120
    s_waitcnt vmcnt(36)
    v_mfma_f32_16x16x32_bf16 a[0:3], v[52:55], v[68:71], a[0:3]
    v_mfma_f32_16x16x32_bf16 a[4:7], v[52:55], v[72:75], a[4:7]
    v_mfma_f32_16x16x32_bf16 a[8:11], v[52:55], v[76:79], a[8:11]
    v_mfma_f32_16x16x32_bf16 a[12:15], v[52:55], v[80:83], a[12:15]
    v_mfma_f32_16x16x32_bf16 a[16:19], v[52:55], v[84:87], a[16:19]
    v_mfma_f32_16x16x32_bf16 a[20:23], v[56:59], v[68:71], a[20:23]
    v_mfma_f32_16x16x32_bf16 a[24:27], v[56:59], v[72:75], a[24:27]
    v_mfma_f32_16x16x32_bf16 a[28:31], v[56:59], v[76:79], a[28:31]
    v_mfma_f32_16x16x32_bf16 a[32:35], v[56:59], v[80:83], a[32:35]
    v_mfma_f32_16x16x32_bf16 a[36:39], v[56:59], v[84:87], a[36:39]
    v_mfma_f32_16x16x32_bf16 a[40:43], v[60:63], v[68:71], a[40:43]
    v_mfma_f32_16x16x32_bf16 a[44:47], v[60:63], v[72:75], a[44:47]
    v_mfma_f32_16x16x32_bf16 a[48:51], v[60:63], v[76:79], a[48:51]
    v_mfma_f32_16x16x32_bf16 a[52:55], v[60:63], v[80:83], a[52:55]
    v_mfma_f32_16x16x32_bf16 a[56:59], v[60:63], v[84:87], a[56:59]
    v_mfma_f32_16x16x32_bf16 a[60:63], v[64:67], v[68:71], a[60:63]
    v_mfma_f32_16x16x32_bf16 a[64:67], v[64:67], v[72:75], a[64:67]
    v_mfma_f32_16x16x32_bf16 a[68:71], v[64:67], v[76:79], a[68:71]
    v_mfma_f32_16x16x32_bf16 a[72:75], v[64:67], v[80:83], a[72:75]
    v_mfma_f32_16x16x32_bf16 a[76:79], v[64:67], v[84:87], a[76:79]
    buffer_load_dwordx4 v[52:55], v2, s[20:23], s26 offen offset:0
    buffer_load_dwordx4 v[56:59], v2, s[20:23], s26 offen offset:1024
    buffer_load_dwordx4 v[60:63], v2, s[20:23], s26 offen offset:2048
    buffer_load_dwordx4 v[64:67], v2, s[20:23], s26 offen offset:3072
    buffer_load_dwordx4 v[68:71], v2, s[20:23], s27 offen offset:0
    buffer_load_dwordx4 v[72:75], v2, s[20:23], s27 offen offset:1024
    buffer_load_dwordx4 v[76:79], v2, s[20:23], s27 offen offset:2048
    buffer_load_dwordx4 v[80:83], v2, s[20:23], s27 offen offset:3072
    buffer_load_dwordx4 v[84:87], v3, s[20:23], s27 offen
    s_add_u32 s26, s26, 4096
    s_add_u32 s27, s27, 5120
    s_waitcnt vmcnt(36)
    v_mfma_f32_16x16x32_bf16 a[0:3], v[88:91], v[104:107], a[0:3]
    v_mfma_f32_16x16x32_bf16 a[4:7], v[88:91], v[108:111], a[4:7]
    v_mfma_f32_16x16x32_bf16 a[8:11], v[88:91], v[112:115], a[8:11]
    v_mfma_f32_16x16x32_bf16 a[12:15], v[88:91], v[116:119], a[12:15]
    v_mfma_f32_16x16x32_bf16 a[16:19], v[88:91], v[120:123], a[16:19]
    v_mfma_f32_16x16x32_bf16 a[20:23], v[92:95], v[104:107], a[20:23]
    v_mfma_f32_16x16x32_bf16 a[24:27], v[92:95], v[108:111], a[24:27]
    v_mfma_f32_16x16x32_bf16 a[28:31], v[92:95], v[112:115], a[28:31]
    v_mfma_f32_16x16x32_bf16 a[32:35], v[92:95], v[116:119], a[32:35]
    v_mfma_f32_16x16x32_bf16 a[36:39], v[92:95], v[120:123], a[36:39]
    v_mfma_f32_16x16x32_bf16 a[40:43], v[96:99], v[104:107], a[40:43]
    v_mfma_f32_16x16x32_bf16 a[44:47], v[96:99], v[108:111], a[44:47]
    v_mfma_f32_16x16x32_bf16 a[48:51], v[96:99], v[112:115], a[48:51]
    v_mfma_f32_16x16x32_bf16 a[52:55], v[96:99], v[116:119], a[52:55]
    v_mfma_f32_16x16x32_bf16 a[56:59], v[96:99], v[120:123], a[56:59]
    v_mfma_f32_16x16x32_bf16 a[60:63], v[100:103], v[104:107], a[60:63]
    v_mfma_f32_16x16x32_bf16 a[64:67], v[100:103], v[108:111], a[64:67]
    v_mfma_f32_16x16x32_bf16 a[68:71], v[100:103], v[112:115], a[68:71]
    v_mfma_f32_16x16x32_bf16 a[72:75], v[100:103], v[116:119], a[72:75]
    v_mfma_f32_16x16x32_bf16 a[76:79], v[100:103], v[120:123], a[76:79]
    buffer_load_dwordx4 v[88:91], v2, s[20:23], s26 offen offset:0
    buffer_load_dwordx4 v[92:95], v2, s[20:23], s26 offen offset:1024
    buffer_load_dwordx4 v[96:99], v2, s[20:23], s26 offen offset:2048
    buffer_load_dwordx4 v[100:103], v2, s[20:23], s26 offen offset:3072
    buffer_load_dwordx4 v[104:107], v2, s[20:23], s27 offen offset:0
    buffer_load_dwordx4 v[108:111], v2, s[20:23], s27 offen offset:1024
    buffer_load_dwordx4 v[112:115], v2, s[20:23], s27 offen offset:2048
    buffer_load_dwordx4 v[116:119], v2, s[20:23], s27 offen offset:3072
    buffer_load_dwordx4 v[120:123], v3, s[20:23], s27 offen
    s_add_u32 s26, s26, 4096
    s_add_u32 s27, s27, 5120
    s_waitcnt vmcnt(36)
    v_mfma_f32_16x16x32_bf16 a[0:3], v[124:127], v[140:143], a[0:3]
    v_mfma_f32_16x16x32_bf16 a[4:7], v[124:127], v[144:147], a[4:7]
    v_mfma_f32_16x16x32_bf16 a[8:11], v[124:127], v[148:151], a[8:11]
    v_mfma_f32_16x16x32_bf16 a[12:15], v[124:127], v[152:155], a[12:15]
    v_mfma_f32_16x16x32_bf16 a[16:19], v[124:127], v[156:159], a[16:19]
    v_mfma_f32_16x16x32_bf16 a[20:23], v[128:131], v[140:143], a[20:23]
    v_mfma_f32_16x16x32_bf16 a[24:27], v[128:131], v[144:147], a[24:27]
    v_mfma_f32_16x16x32_bf16 a[28:31], v[128:131], v[148:151], a[28:31]
    v_mfma_f32_16x16x32_bf16 a[32:35], v[128:131], v[152:155], a[32:35]
    v_mfma_f32_16x16x32_bf16 a[36:39], v[128:131], v[156:159], a[36:39]
    v_mfma_f32_16x16x32_bf16 a[40:43], v[132:135], v[140:143], a[40:43]
    v_mfma_f32_16x16x32_bf16 a[44:47], v[132:135], v[144:147], a[44:47]
    v_mfma_f32_16x16x32_bf16 a[48:51], v[132:135], v[148:151], a[48:51]
    v_mfma_f32_16x16x32_bf16 a[52:55], v[132:135], v[152:155], a[52:55]
    v_mfma_f32_16x16x32_bf16 a[56:59], v[132:135], v[156:159], a[56:59]
    v_mfma_f32_16x16x32_bf16 a[60:63], v[136:139], v[140:143], a[60:63]
    v_mfma_f32_16x16x32_bf16 a[64:67], v[136:139], v[144:147], a[64:67]
    v_mfma_f32_16x16x32_bf16 a[68:71], v[136:139], v[148:151], a[68:71]
    v_mfma_f32_16x16x32_bf16 a[72:75], v[136:139], v[152:155], a[72:75]
    v_mfma_f32_16x16x32_bf16 a[76:79], v[136:139], v[156:159], a[76:79]
    buffer_load_dwordx4 v[124:127], v2, s[20:23], s26 offen offset:0
    buffer_load_dwordx4 v[128:131], v2, s[20:23], s26 offen offset:1024
    buffer_load_dwordx4 v[132:135], v2, s[20:23], s26 offen offset:2048
    buffer_load_dwordx4 v[136:139], v2, s[20:23], s26 offen offset:3072
    buffer_load_dwordx4 v[140:143], v2, s[20:23], s27 offen offset:0
    buffer_load_dwordx4 v[144:147], v2, s[20:23], s27 offen offset:1024
    buffer_load_dwordx4 v[148:151], v2, s[20:23], s27 offen offset:2048
    buffer_load_dwordx4 v[152:155], v2, s[20:23], s27 offen offset:3072
    buffer_load_dwordx4 v[156:159], v3, s[20:23], s27 offen
    s_add_u32 s26, s26, 4096
    s_add_u32 s27, s27, 5120
    s_waitcnt vmcnt(36)
    v_mfma_f32_16x16x32_bf16 a[0:3], v[160:163], v[176:179], a[0:3]
    v_mfma_f32_16x16x32_bf16 a[4:7], v[160:163], v[180:183], a[4:7]
    v_mfma_f32_16x16x32_bf16 a[8:11], v[160:163], v[184:187], a[8:11]
    v_mfma_f32_16x16x32_bf16 a[12:15], v[160:163], v[188:191], a[12:15]
    v_mfma_f32_16x16x32_bf16 a[16:19], v[160:163], v[192:195], a[16:19]
    v_mfma_f32_16x16x32_bf16 a[20:23], v[164:167], v[176:179], a[20:23]
    v_mfma_f32_16x16x32_bf16 a[24:27], v[164:167], v[180:183], a[24:27]
    v_mfma_f32_16x16x32_bf16 a[28:31], v[164:167], v[184:187], a[28:31]
    v_mfma_f32_16x16x32_bf16 a[32:35], v[164:167], v[188:191], a[32:35]
    v_mfma_f32_16x16x32_bf16 a[36:39], v[164:167], v[192:195], a[36:39]
    v_mfma_f32_16x16x32_bf16 a[40:43], v[168:171], v[176:179], a[40:43]
    v_mfma_f32_16x16x32_bf16 a[44:47], v[168:171], v[180:183], a[44:47]
    v_mfma_f32_16x16x32_bf16 a[48:51], v[168:171], v[184:187], a[48:51]
    v_mfma_f32_16x16x32_bf16 a[52:55], v[168:171], v[188:191], a[52:55]
    v_mfma_f32_16x16x32_bf16 a[56:59], v[168:171], v[192:195], a[56:59]
    v_mfma_f32_16x16x32_bf16 a[60:63], v[172:175], v[176:179], a[60:63]
    v_mfma_f32_16x16x32_bf16 a[64:67], v[172:175], v[180:183], a[64:67]
    v_mfma_f32_16x16x32_bf16 a[68:71], v[172:175], v[184:187], a[68:71]
    v_mfma_f32_16x16x32_bf16 a[72:75], v[172:175], v[188:191], a[72:75]
    v_mfma_f32_16x16x32_bf16 a[76:79], v[172:175], v[192:195], a[76:79]
    buffer_load_dwordx4 v[160:163], v2, s[20:23], s26 offen offset:0
    buffer_load_dwordx4 v[164:167], v2, s[20:23], s26 offen offset:1024
    buffer_load_dwordx4 v[168:171], v2, s[20:23], s26 offen offset:2048
    buffer_load_dwordx4 v[172:175], v2, s[20:23], s26 offen offset:3072
    buffer_load_dwordx4 v[176:179], v2, s[20:23], s27 offen offset:0
    buffer_load_dwordx4 v[180:183], v2, s[20:23], s27 offen offset:1024
    buffer_load_dwordx4 v[184:187], v2, s[20:23], s27 offen offset:2048
    buffer_load_dwordx4 v[188:191], v2, s[20:23], s27 offen offset:3072
    buffer_load_dwordx4 v[192:195], v3, s[20:23], s27 offen
    s_add_u32 s26, s26, 4096
    s_add_u32 s27, s27, 5120
    s_waitcnt vmcnt(36)
    v_mfma_f32_16x16x32_bf16 a[0:3], v[16:19], v[32:35], a[0:3]
    v_mfma_f32_16x16x32_bf16 a[4:7], v[16:19], v[36:39], a[4:7]
    v_mfma_f32_16x16x32_bf16 a[8:11], v[16:19], v[40:43], a[8:11]
    v_mfma_f32_16x16x32_bf16 a[12:15], v[16:19], v[44:47], a[12:15]
    v_mfma_f32_16x16x32_bf16 a[16:19], v[16:19], v[48:51], a[16:19]
    v_mfma_f32_16x16x32_bf16 a[20:23], v[20:23], v[32:35], a[20:23]
    v_mfma_f32_16x16x32_bf16 a[24:27], v[20:23], v[36:39], a[24:27]
    v_mfma_f32_16x16x32_bf16 a[28:31], v[20:23], v[40:43], a[28:31]
    v_mfma_f32_16x16x32_bf16 a[32:35], v[20:23], v[44:47], a[32:35]
    v_mfma_f32_16x16x32_bf16 a[36:39], v[20:23], v[48:51], a[36:39]
    v_mfma_f32_16x16x32_bf16 a[40:43], v[24:27], v[32:35], a[40:43]
    v_mfma_f32_16x16x32_bf16 a[44:47], v[24:27], v[36:39], a[44:47]
    v_mfma_f32_16x16x32_bf16 a[48:51], v[24:27], v[40:43], a[48:51]
    v_mfma_f32_16x16x32_bf16 a[52:55], v[24:27], v[44:47], a[52:55]
    v_mfma_f32_16x16x32_bf16 a[56:59], v[24:27], v[48:51], a[56:59]
    v_mfma_f32_16x16x32_bf16 a[60:63], v[28:31], v[32:35], a[60:63]
    v_mfma_f32_16x16x32_bf16 a[64:67], v[28:31], v[36:39], a[64:67]
    v_mfma_f32_16x16x32_bf16 a[68:71], v[28:31], v[40:43], a[68:71]
    v_mfma_f32_16x16x32_bf16 a[72:75], v[28:31], v[44:47], a[72:75]
    v_mfma_f32_16x16x32_bf16 a[76:79], v[28:31], v[48:51], a[76:79]
    buffer_load_dwordx4 v[16:19], v2, s[20:23], s26 offen offset:0
    buffer_load_dwordx4 v[20:23], v2, s[20:23], s26 offen offset:1024
    buffer_load_dwordx4 v[24:27], v2, s[20:23], s26 offen offset:2048
    buffer_load_dwordx4 v[28:31], v2, s[20:23], s26 offen offset:3072
    buffer_load_dwordx4 v[32:35], v2, s[20:23], s27 offen offset:0
    buffer_load_dwordx4 v[36:39], v2, s[20:23], s27 offen offset:1024
    buffer_load_dwordx4 v[40:43], v2, s[20:23], s27 offen offset:2048
    buffer_load_dwordx4 v[44:47], v2, s[20:23], s27 offen offset:3072
    buffer_load_dwordx4 v[48:51], v3, s[20:23], s27 offen
    s_add_u32 s26, s26, 4096
    s_add_u32 s27, s27, 5120
    s_waitcnt vmcnt(36)
    v_mfma_f32_16x16x32_bf16 a[0:3], v[52:55], v[68:71], a[0:3]
    v_mfma_f32_16x16x32_bf16 a[4:7], v[52:55], v[72:75], a[4:7]
    v_mfma_f32_16x16x32_bf16 a[8:11], v[52:55], v[76:79], a[8:11]
    v_mfma_f32_16x16x32_bf16 a[12:15], v[52:55], v[80:83], a[12:15]
    v_mfma_f32_16x16x32_bf16 a[16:19], v[52:55], v[84:87], a[16:19]
    v_mfma_f32_16x16x32_bf16 a[20:23], v[56:59], v[68:71], a[20:23]
    v_mfma_f32_16x16x32_bf16 a[24:27], v[56:59], v[72:75], a[24:27]
    v_mfma_f32_16x16x32_bf16 a[28:31], v[56:59], v[76:79], a[28:31]
    v_mfma_f32_16x16x32_bf16 a[32:35], v[56:59], v[80:83], a[32:35]
    v_mfma_f32_16x16x32_bf16 a[36:39], v[56:59], v[84:87], a[36:39]
    v_mfma_f32_16x16x32_bf16 a[40:43], v[60:63], v[68:71], a[40:43]
    v_mfma_f32_16x16x32_bf16 a[44:47], v[60:63], v[72:75], a[44:47]
    v_mfma_f32_16x16x32_bf16 a[48:51], v[60:63], v[76:79], a[48:51]
    v_mfma_f32_16x16x32_bf16 a[52:55], v[60:63], v[80:83], a[52:55]
    v_mfma_f32_16x16x32_bf16 a[56:59], v[60:63], v[84:87], a[56:59]
    v_mfma_f32_16x16x32_bf16 a[60:63], v[64:67], v[68:71], a[60:63]
    v_mfma_f32_16x16x32_bf16 a[64:67], v[64:67], v[72:75], a[64:67]
    v_mfma_f32_16x16x32_bf16 a[68:71], v[64:67], v[76:79], a[68:71]
    v_mfma_f32_16x16x32_bf16 a[72:75], v[64:67], v[80:83], a[72:75]
    v_mfma_f32_16x16x32_bf16 a[76:79], v[64:67], v[84:87], a[76:79]
    buffer_load_dwordx4 v[52:55], v2, s[20:23], s26 offen offset:0
    buffer_load_dwordx4 v[56:59], v2, s[20:23], s26 offen offset:1024
    buffer_load_dwordx4 v[60:63], v2, s[20:23], s26 offen offset:2048
    buffer_load_dwordx4 v[64:67], v2, s[20:23], s26 offen offset:3072
    buffer_load_dwordx4 v[68:71], v2, s[20:23], s27 offen offset:0
    buffer_load_dwordx4 v[72:75], v2, s[20:23], s27 offen offset:1024
    buffer_load_dwordx4 v[76:79], v2, s[20:23], s27 offen offset:2048
    buffer_load_dwordx4 v[80:83], v2, s[20:23], s27 offen offset:3072
    buffer_load_dwordx4 v[84:87], v3, s[20:23], s27 offen
    s_add_u32 s26, s26, 4096
    s_add_u32 s27, s27, 5120
    s_waitcnt vmcnt(36)
    v_mfma_f32_16x16x32_bf16 a[0:3], v[88:91], v[104:107], a[0:3]
    v_mfma_f32_16x16x32_bf16 a[4:7], v[88:91], v[108:111], a[4:7]
    v_mfma_f32_16x16x32_bf16 a[8:11], v[88:91], v[112:115], a[8:11]
    v_mfma_f32_16x16x32_bf16 a[12:15], v[88:91], v[116:119], a[12:15]
    v_mfma_f32_16x16x32_bf16 a[16:19], v[88:91], v[120:123], a[16:19]
    v_mfma_f32_16x16x32_bf16 a[20:23], v[92:95], v[104:107], a[20:23]
    v_mfma_f32_16x16x32_bf16 a[24:27], v[92:95], v[108:111], a[24:27]
    v_mfma_f32_16x16x32_bf16 a[28:31], v[92:95], v[112:115], a[28:31]
    v_mfma_f32_16x16x32_bf16 a[32:35], v[92:95], v[116:119], a[32:35]
    v_mfma_f32_16x16x32_bf16 a[36:39], v[92:95], v[120:123], a[36:39]
    v_mfma_f32_16x16x32_bf16 a[40:43], v[96:99], v[104:107], a[40:43]
    v_mfma_f32_16x16x32_bf16 a[44:47], v[96:99], v[108:111], a[44:47]
    v_mfma_f32_16x16x32_bf16 a[48:51], v[96:99], v[112:115], a[48:51]
    v_mfma_f32_16x16x32_bf16 a[52:55], v[96:99], v[116:119], a[52:55]
    v_mfma_f32_16x16x32_bf16 a[56:59], v[96:99], v[120:123], a[56:59]
    v_mfma_f32_16x16x32_bf16 a[60:63], v[100:103], v[104:107], a[60:63]
    v_mfma_f32_16x16x32_bf16 a[64:67], v[100:103], v[108:111], a[64:67]
    v_mfma_f32_16x16x32_bf16 a[68:71], v[100:103], v[112:115], a[68:71]
    v_mfma_f32_16x16x32_bf16 a[72:75], v[100:103], v[116:119], a[72:75]
    v_mfma_f32_16x16x32_bf16 a[76:79], v[100:103], v[120:123], a[76:79]
    buffer_load_dwordx4 v[88:91], v2, s[20:23], s26 offen offset:0
    buffer_load_dwordx4 v[92:95], v2, s[20:23], s26 offen offset:1024
    buffer_load_dwordx4 v[96:99], v2, s[20:23], s26 offen offset:2048
    buffer_load_dwordx4 v[100:103], v2, s[20:23], s26 offen offset:3072
    buffer_load_dwordx4 v[104:107], v2, s[20:23], s27 offen offset:0
    buffer_load_dwordx4 v[108:111], v2, s[20:23], s27 offen offset:1024
    buffer_load_dwordx4 v[112:115], v2, s[20:23], s27 offen offset:2048
    buffer_load_dwordx4 v[116:119], v2, s[20:23], s27 offen offset:3072
    buffer_load_dwordx4 v[120:123], v3, s[20:23], s27 offen
    s_add_u32 s26, s26, 4096
    s_add_u32 s27, s27, 5120
    s_waitcnt vmcnt(36)
    v_mfma_f32_16x16x32_bf16 a[0:3], v[124:127], v[140:143], a[0:3]
    v_mfma_f32_16x16x32_bf16 a[4:7], v[124:127], v[144:147], a[4:7]
    v_mfma_f32_16x16x32_bf16 a[8:11], v[124:127], v[148:151], a[8:11]
    v_mfma_f32_16x16x32_bf16 a[12:15], v[124:127], v[152:155], a[12:15]
    v_mfma_f32_16x16x32_bf16 a[16:19], v[124:127], v[156:159], a[16:19]
    v_mfma_f32_16x16x32_bf16 a[20:23], v[128:131], v[140:143], a[20:23]
    v_mfma_f32_16x16x32_bf16 a[24:27], v[128:131], v[144:147], a[24:27]
    v_mfma_f32_16x16x32_bf16 a[28:31], v[128:131], v[148:151], a[28:31]
    v_mfma_f32_16x16x32_bf16 a[32:35], v[128:131], v[152:155], a[32:35]
    v_mfma_f32_16x16x32_bf16 a[36:39], v[128:131], v[156:159], a[36:39]
    v_mfma_f32_16x16x32_bf16 a[40:43], v[132:135], v[140:143], a[40:43]
    v_mfma_f32_16x16x32_bf16 a[44:47], v[132:135], v[144:147], a[44:47]
    v_mfma_f32_16x16x32_bf16 a[48:51], v[132:135], v[148:151], a[48:51]
    v_mfma_f32_16x16x32_bf16 a[52:55], v[132:135], v[152:155], a[52:55]
    v_mfma_f32_16x16x32_bf16 a[56:59], v[132:135], v[156:159], a[56:59]
    v_mfma_f32_16x16x32_bf16 a[60:63], v[136:139], v[140:143], a[60:63]
    v_mfma_f32_16x16x32_bf16 a[64:67], v[136:139], v[144:147], a[64:67]
    v_mfma_f32_16x16x32_bf16 a[68:71], v[136:139], v[148:151], a[68:71]
    v_mfma_f32_16x16x32_bf16 a[72:75], v[136:139], v[152:155], a[72:75]
    v_mfma_f32_16x16x32_bf16 a[76:79], v[136:139], v[156:159], a[76:79]
    buffer_load_dwordx4 v[124:127], v2, s[20:23], s26 offen offset:0
    buffer_load_dwordx4 v[128:131], v2, s[20:23], s26 offen offset:1024
    buffer_load_dwordx4 v[132:135], v2, s[20:23], s26 offen offset:2048
    buffer_load_dwordx4 v[136:139], v2, s[20:23], s26 offen offset:3072
    buffer_load_dwordx4 v[140:143], v2, s[20:23], s27 offen offset:0
    buffer_load_dwordx4 v[144:147], v2, s[20:23], s27 offen offset:1024
    buffer_load_dwordx4 v[148:151], v2, s[20:23], s27 offen offset:2048
    buffer_load_dwordx4 v[152:155], v2, s[20:23], s27 offen offset:3072
    buffer_load_dwordx4 v[156:159], v3, s[20:23], s27 offen
    s_add_u32 s26, s26, 4096
    s_add_u32 s27, s27, 5120
    s_waitcnt vmcnt(36)
    v_mfma_f32_16x16x32_bf16 a[0:3], v[160:163], v[176:179], a[0:3]
    v_mfma_f32_16x16x32_bf16 a[4:7], v[160:163], v[180:183], a[4:7]
    v_mfma_f32_16x16x32_bf16 a[8:11], v[160:163], v[184:187], a[8:11]
    v_mfma_f32_16x16x32_bf16 a[12:15], v[160:163], v[188:191], a[12:15]
    v_mfma_f32_16x16x32_bf16 a[16:19], v[160:163], v[192:195], a[16:19]
    v_mfma_f32_16x16x32_bf16 a[20:23], v[164:167], v[176:179], a[20:23]
    v_mfma_f32_16x16x32_bf16 a[24:27], v[164:167], v[180:183], a[24:27]
    v_mfma_f32_16x16x32_bf16 a[28:31], v[164:167], v[184:187], a[28:31]
    v_mfma_f32_16x16x32_bf16 a[32:35], v[164:167], v[188:191], a[32:35]
    v_mfma_f32_16x16x32_bf16 a[36:39], v[164:167], v[192:195], a[36:39]
    v_mfma_f32_16x16x32_bf16 a[40:43], v[168:171], v[176:179], a[40:43]
    v_mfma_f32_16x16x32_bf16 a[44:47], v[168:171], v[180:183], a[44:47]
    v_mfma_f32_16x16x32_bf16 a[48:51], v[168:171], v[184:187], a[48:51]
    v_mfma_f32_16x16x32_bf16 a[52:55], v[168:171], v[188:191], a[52:55]
    v_mfma_f32_16x16x32_bf16 a[56:59], v[168:171], v[192:195], a[56:59]
    v_mfma_f32_16x16x32_bf16 a[60:63], v[172:175], v[176:179], a[60:63]
    v_mfma_f32_16x16x32_bf16 a[64:67], v[172:175], v[180:183], a[64:67]
    v_mfma_f32_16x16x32_bf16 a[68:71], v[172:175], v[184:187], a[68:71]
    v_mfma_f32_16x16x32_bf16 a[72:75], v[172:175], v[188:191], a[72:75]
    v_mfma_f32_16x16x32_bf16 a[76:79], v[172:175], v[192:195], a[76:79]
    buffer_load_dwordx4 v[160:163], v2, s[20:23], s26 offen offset:0
    buffer_load_dwordx4 v[164:167], v2, s[20:23], s26 offen offset:1024
    buffer_load_dwordx4 v[168:171], v2, s[20:23], s26 offen offset:2048
    buffer_load_dwordx4 v[172:175], v2, s[20:23], s26 offen offset:3072
    buffer_load_dwordx4 v[176:179], v2, s[20:23], s27 offen offset:0
    buffer_load_dwordx4 v[180:183], v2, s[20:23], s27 offen offset:1024
    buffer_load_dwordx4 v[184:187], v2, s[20:23], s27 offen offset:2048
    buffer_load_dwordx4 v[188:191], v2, s[20:23], s27 offen offset:3072
    buffer_load_dwordx4 v[192:195], v3, s[20:23], s27 offen
    s_add_u32 s26, s26, 4096
    s_add_u32 s27, s27, 5120
    s_waitcnt vmcnt(36)
    v_mfma_f32_16x16x32_bf16 a[0:3], v[16:19], v[32:35], a[0:3]
    v_mfma_f32_16x16x32_bf16 a[4:7], v[16:19], v[36:39], a[4:7]
    v_mfma_f32_16x16x32_bf16 a[8:11], v[16:19], v[40:43], a[8:11]
    v_mfma_f32_16x16x32_bf16 a[12:15], v[16:19], v[44:47], a[12:15]
    v_mfma_f32_16x16x32_bf16 a[16:19], v[16:19], v[48:51], a[16:19]
    v_mfma_f32_16x16x32_bf16 a[20:23], v[20:23], v[32:35], a[20:23]
    v_mfma_f32_16x16x32_bf16 a[24:27], v[20:23], v[36:39], a[24:27]
    v_mfma_f32_16x16x32_bf16 a[28:31], v[20:23], v[40:43], a[28:31]
    v_mfma_f32_16x16x32_bf16 a[32:35], v[20:23], v[44:47], a[32:35]
    v_mfma_f32_16x16x32_bf16 a[36:39], v[20:23], v[48:51], a[36:39]
    v_mfma_f32_16x16x32_bf16 a[40:43], v[24:27], v[32:35], a[40:43]
    v_mfma_f32_16x16x32_bf16 a[44:47], v[24:27], v[36:39], a[44:47]
    v_mfma_f32_16x16x32_bf16 a[48:51], v[24:27], v[40:43], a[48:51]
    v_mfma_f32_16x16x32_bf16 a[52:55], v[24:27], v[44:47], a[52:55]
    v_mfma_f32_16x16x32_bf16 a[56:59], v[24:27], v[48:51], a[56:59]
    v_mfma_f32_16x16x32_bf16 a[60:63], v[28:31], v[32:35], a[60:63]
    v_mfma_f32_16x16x32_bf16 a[64:67], v[28:31], v[36:39], a[64:67]
    v_mfma_f32_16x16x32_bf16 a[68:71], v[28:31], v[40:43], a[68:71]
    v_mfma_f32_16x16x32_bf16 a[72:75], v[28:31], v[44:47], a[72:75]
    v_mfma_f32_16x16x32_bf16 a[76:79], v[28:31], v[48:51], a[76:79]
    s_waitcnt vmcnt(27)
    v_mfma_f32_16x16x32_bf16 a[0:3], v[52:55], v[68:71], a[0:3]
    v_mfma_f32_16x16x32_bf16 a[4:7], v[52:55], v[72:75], a[4:7]
    v_mfma_f32_16x16x32_bf16 a[8:11], v[52:55], v[76:79], a[8:11]
    v_mfma_f32_16x16x32_bf16 a[12:15], v[52:55], v[80:83], a[12:15]
    v_mfma_f32_16x16x32_bf16 a[16:19], v[52:55], v[84:87], a[16:19]
    v_mfma_f32_16x16x32_bf16 a[20:23], v[56:59], v[68:71], a[20:23]
    v_mfma_f32_16x16x32_bf16 a[24:27], v[56:59], v[72:75], a[24:27]
    v_mfma_f32_16x16x32_bf16 a[28:31], v[56:59], v[76:79], a[28:31]
    v_mfma_f32_16x16x32_bf16 a[32:35], v[56:59], v[80:83], a[32:35]
    v_mfma_f32_16x16x32_bf16 a[36:39], v[56:59], v[84:87], a[36:39]
    v_mfma_f32_16x16x32_bf16 a[40:43], v[60:63], v[68:71], a[40:43]
    v_mfma_f32_16x16x32_bf16 a[44:47], v[60:63], v[72:75], a[44:47]
    v_mfma_f32_16x16x32_bf16 a[48:51], v[60:63], v[76:79], a[48:51]
    v_mfma_f32_16x16x32_bf16 a[52:55], v[60:63], v[80:83], a[52:55]
    v_mfma_f32_16x16x32_bf16 a[56:59], v[60:63], v[84:87], a[56:59]
    v_mfma_f32_16x16x32_bf16 a[60:63], v[64:67], v[68:71], a[60:63]
    v_mfma_f32_16x16x32_bf16 a[64:67], v[64:67], v[72:75], a[64:67]
    v_mfma_f32_16x16x32_bf16 a[68:71], v[64:67], v[76:79], a[68:71]
    v_mfma_f32_16x16x32_bf16 a[72:75], v[64:67], v[80:83], a[72:75]
    v_mfma_f32_16x16x32_bf16 a[76:79], v[64:67], v[84:87], a[76:79]
    s_waitcnt vmcnt(18)
    v_mfma_f32_16x16x32_bf16 a[0:3], v[88:91], v[104:107], a[0:3]
    v_mfma_f32_16x16x32_bf16 a[4:7], v[88:91], v[108:111], a[4:7]
    v_mfma_f32_16x16x32_bf16 a[8:11], v[88:91], v[112:115], a[8:11]
    v_mfma_f32_16x16x32_bf16 a[12:15], v[88:91], v[116:119], a[12:15]
    v_mfma_f32_16x16x32_bf16 a[16:19], v[88:91], v[120:123], a[16:19]
    v_mfma_f32_16x16x32_bf16 a[20:23], v[92:95], v[104:107], a[20:23]
    v_mfma_f32_16x16x32_bf16 a[24:27], v[92:95], v[108:111], a[24:27]
    v_mfma_f32_16x16x32_bf16 a[28:31], v[92:95], v[112:115], a[28:31]
    v_mfma_f32_16x16x32_bf16 a[32:35], v[92:95], v[116:119], a[32:35]
    v_mfma_f32_16x16x32_bf16 a[36:39], v[92:95], v[120:123], a[36:39]
    v_mfma_f32_16x16x32_bf16 a[40:43], v[96:99], v[104:107], a[40:43]
    v_mfma_f32_16x16x32_bf16 a[44:47], v[96:99], v[108:111], a[44:47]
    v_mfma_f32_16x16x32_bf16 a[48:51], v[96:99], v[112:115], a[48:51]
    v_mfma_f32_16x16x32_bf16 a[52:55], v[96:99], v[116:119], a[52:55]
    v_mfma_f32_16x16x32_bf16 a[56:59], v[96:99], v[120:123], a[56:59]
    v_mfma_f32_16x16x32_bf16 a[60:63], v[100:103], v[104:107], a[60:63]
    v_mfma_f32_16x16x32_bf16 a[64:67], v[100:103], v[108:111], a[64:67]
    v_mfma_f32_16x16x32_bf16 a[68:71], v[100:103], v[112:115], a[68:71]
    v_mfma_f32_16x16x32_bf16 a[72:75], v[100:103], v[116:119], a[72:75]
    v_mfma_f32_16x16x32_bf16 a[76:79], v[100:103], v[120:123], a[76:79]
    s_waitcnt vmcnt(9)
    v_mfma_f32_16x16x32_bf16 a[0:3], v[124:127], v[140:143], a[0:3]
    v_mfma_f32_16x16x32_bf16 a[4:7], v[124:127], v[144:147], a[4:7]
    v_mfma_f32_16x16x32_bf16 a[8:11], v[124:127], v[148:151], a[8:11]
    v_mfma_f32_16x16x32_bf16 a[12:15], v[124:127], v[152:155], a[12:15]
    v_mfma_f32_16x16x32_bf16 a[16:19], v[124:127], v[156:159], a[16:19]
    v_mfma_f32_16x16x32_bf16 a[20:23], v[128:131], v[140:143], a[20:23]
    v_mfma_f32_16x16x32_bf16 a[24:27], v[128:131], v[144:147], a[24:27]
    v_mfma_f32_16x16x32_bf16 a[28:31], v[128:131], v[148:151], a[28:31]
    v_mfma_f32_16x16x32_bf16 a[32:35], v[128:131], v[152:155], a[32:35]
    v_mfma_f32_16x16x32_bf16 a[36:39], v[128:131], v[156:159], a[36:39]
    v_mfma_f32_16x16x32_bf16 a[40:43], v[132:135], v[140:143], a[40:43]
    v_mfma_f32_16x16x32_bf16 a[44:47], v[132:135], v[144:147], a[44:47]
    v_mfma_f32_16x16x32_bf16 a[48:51], v[132:135], v[148:151], a[48:51]
    v_mfma_f32_16x16x32_bf16 a[52:55], v[132:135], v[152:155], a[52:55]
    v_mfma_f32_16x16x32_bf16 a[56:59], v[132:135], v[156:159], a[56:59]
    v_mfma_f32_16x16x32_bf16 a[60:63], v[136:139], v[140:143], a[60:63]
    v_mfma_f32_16x16x32_bf16 a[64:67], v[136:139], v[144:147], a[64:67]
    v_mfma_f32_16x16x32_bf16 a[68:71], v[136:139], v[148:151], a[68:71]
    v_mfma_f32_16x16x32_bf16 a[72:75], v[136:139], v[152:155], a[72:75]
    v_mfma_f32_16x16x32_bf16 a[76:79], v[136:139], v[156:159], a[76:79]
    s_waitcnt vmcnt(0)
    v_mfma_f32_16x16x32_bf16 a[0:3], v[160:163], v[176:179], a[0:3]
    v_mfma_f32_16x16x32_bf16 a[4:7], v[160:163], v[180:183], a[4:7]
    v_mfma_f32_16x16x32_bf16 a[8:11], v[160:163], v[184:187], a[8:11]
    v_mfma_f32_16x16x32_bf16 a[12:15], v[160:163], v[188:191], a[12:15]
    v_mfma_f32_16x16x32_bf16 a[16:19], v[160:163], v[192:195], a[16:19]
    v_mfma_f32_16x16x32_bf16 a[20:23], v[164:167], v[176:179], a[20:23]
    v_mfma_f32_16x16x32_bf16 a[24:27], v[164:167], v[180:183], a[24:27]
    v_mfma_f32_16x16x32_bf16 a[28:31], v[164:167], v[184:187], a[28:31]
    v_mfma_f32_16x16x32_bf16 a[32:35], v[164:167], v[188:191], a[32:35]
    v_mfma_f32_16x16x32_bf16 a[36:39], v[164:167], v[192:195], a[36:39]
    v_mfma_f32_16x16x32_bf16 a[40:43], v[168:171], v[176:179], a[40:43]
    v_mfma_f32_16x16x32_bf16 a[44:47], v[168:171], v[180:183], a[44:47]
    v_mfma_f32_16x16x32_bf16 a[48:51], v[168:171], v[184:187], a[48:51]
    v_mfma_f32_16x16x32_bf16 a[52:55], v[168:171], v[188:191], a[52:55]
    v_mfma_f32_16x16x32_bf16 a[56:59], v[168:171], v[192:195], a[56:59]
    v_mfma_f32_16x16x32_bf16 a[60:63], v[172:175], v[176:179], a[60:63]
    v_mfma_f32_16x16x32_bf16 a[64:67], v[172:175], v[180:183], a[64:67]
    v_mfma_f32_16x16x32_bf16 a[68:71], v[172:175], v[184:187], a[68:71]
    v_mfma_f32_16x16x32_bf16 a[72:75], v[172:175], v[188:191], a[72:75]
    v_mfma_f32_16x16x32_bf16 a[76:79], v[172:175], v[192:195], a[76:79]
K3_RED:
    s_nop 7
    s_mul_i32 s30, s3, 20480
    v_add_u32 v4, s30, v2
    ds_write_b128 v4, a[0:3] offset:0
    ds_write_b128 v4, a[4:7] offset:1024
    ds_write_b128 v4, a[8:11] offset:2048
    ds_write_b128 v4, a[12:15] offset:3072
    ds_write_b128 v4, a[16:19] offset:4096
    ds_write_b128 v4, a[20:23] offset:5120
    ds_write_b128 v4, a[24:27] offset:6144
    ds_write_b128 v4, a[28:31] offset:7168
    ds_write_b128 v4, a[32:35] offset:8192
    ds_write_b128 v4, a[36:39] offset:9216
    ds_write_b128 v4, a[40:43] offset:10240
    ds_write_b128 v4, a[44:47] offset:11264
    ds_write_b128 v4, a[48:51] offset:12288
    ds_write_b128 v4, a[52:55] offset:13312
    ds_write_b128 v4, a[56:59] offset:14336
    ds_write_b128 v4, a[60:63] offset:15360
    ds_write_b128 v4, a[64:67] offset:16384
    ds_write_b128 v4, a[68:71] offset:17408
    ds_write_b128 v4, a[72:75] offset:18432
    ds_write_b128 v4, a[76:79] offset:19456
    v_lshlrev_b32 v204, 16, v204
    v_lshlrev_b32 v210, 16, v210
    v_mul_f32 v210, v210, v204
    v_lshlrev_b32 v211, 16, v211
    v_mul_f32 v211, v211, v204
    v_lshlrev_b32 v212, 16, v212
    v_mul_f32 v212, v212, v204
    v_lshlrev_b32 v213, 16, v213
    v_mul_f32 v213, v213, v204
    v_cvt_pk_bf16_f32 v12, v210, v211
    v_lshlrev_b32 v210, 16, v12
    v_and_b32 v211, 0xffff0000, v12
    v_cvt_pk_bf16_f32 v12, v212, v213
    v_lshlrev_b32 v212, 16, v12
    v_and_b32 v213, 0xffff0000, v12
    v_lshlrev_b32 v205, 16, v205
    v_lshlrev_b32 v214, 16, v214
    v_mul_f32 v214, v214, v205
    v_lshlrev_b32 v215, 16, v215
    v_mul_f32 v215, v215, v205
    v_lshlrev_b32 v216, 16, v216
    v_mul_f32 v216, v216, v205
    v_lshlrev_b32 v217, 16, v217
    v_mul_f32 v217, v217, v205
    v_cvt_pk_bf16_f32 v12, v214, v215
    v_lshlrev_b32 v214, 16, v12
    v_and_b32 v215, 0xffff0000, v12
    v_cvt_pk_bf16_f32 v12, v216, v217
    v_lshlrev_b32 v216, 16, v12
    v_and_b32 v217, 0xffff0000, v12
    v_lshlrev_b32 v206, 16, v206
    v_lshlrev_b32 v218, 16, v218
    v_mul_f32 v218, v218, v206
    v_lshlrev_b32 v219, 16, v219
    v_mul_f32 v219, v219, v206
    v_lshlrev_b32 v220, 16, v220
    v_mul_f32 v220, v220, v206
    v_lshlrev_b32 v221, 16, v221
    v_mul_f32 v221, v221, v206
    v_cvt_pk_bf16_f32 v12, v218, v219
    v_lshlrev_b32 v218, 16, v12
    v_and_b32 v219, 0xffff0000, v12
    v_cvt_pk_bf16_f32 v12, v220, v221
    v_lshlrev_b32 v220, 16, v12
    v_and_b32 v221, 0xffff0000, v12
    v_lshlrev_b32 v207, 16, v207
    v_lshlrev_b32 v222, 16, v222
    v_mul_f32 v222, v222, v207
    v_lshlrev_b32 v223, 16, v223
    v_mul_f32 v223, v223, v207
    v_lshlrev_b32 v224, 16, v224
    v_mul_f32 v224, v224, v207
    v_lshlrev_b32 v225, 16, v225
    v_mul_f32 v225, v225, v207
    v_cvt_pk_bf16_f32 v12, v222, v223
    v_lshlrev_b32 v222, 16, v12
    v_and_b32 v223, 0xffff0000, v12
    v_cvt_pk_bf16_f32 v12, v224, v225
    v_lshlrev_b32 v224, 16, v12
    v_and_b32 v225, 0xffff0000, v12
    v_lshlrev_b32 v208, 16, v208
    v_lshlrev_b32 v226, 16, v226
    v_mul_f32 v226, v226, v208
    v_lshlrev_b32 v227, 16, v227
    v_mul_f32 v227, v227, v208
    v_lshlrev_b32 v228, 16, v228
    v_mul_f32 v228, v228, v208
    v_lshlrev_b32 v229, 16, v229
    v_mul_f32 v229, v229, v208
    v_cvt_pk_bf16_f32 v12, v226, v227
    v_lshlrev_b32 v226, 16, v12
    v_and_b32 v227, 0xffff0000, v12
    v_cvt_pk_bf16_f32 v12, v228, v229
    v_lshlrev_b32 v228, 16, v12
    v_and_b32 v229, 0xffff0000, v12
    s_waitcnt lgkmcnt(0)
    s_barrier
    s_mul_i32 s30, s3, 5120
    v_add_u32 v4, s30, v2
    v_add_u32 v7, 40960, v4
    ds_read_b128 v[16:19], v4 offset:0
    ds_read_b128 v[20:23], v4 offset:1024
    ds_read_b128 v[24:27], v4 offset:2048
    ds_read_b128 v[28:31], v4 offset:3072
    ds_read_b128 v[32:35], v4 offset:4096
    ds_read_b128 v[36:39], v4 offset:20480
    ds_read_b128 v[40:43], v4 offset:21504
    ds_read_b128 v[44:47], v4 offset:22528
    ds_read_b128 v[48:51], v4 offset:23552
    ds_read_b128 v[52:55], v4 offset:24576
    ds_read_b128 v[56:59], v7 offset:0
    ds_read_b128 v[60:63], v7 offset:1024
    ds_read_b128 v[64:67], v7 offset:2048
    ds_read_b128 v[68:71], v7 offset:3072
    ds_read_b128 v[72:75], v7 offset:4096
    ds_read_b128 v[76:79], v7 offset:20480
    ds_read_b128 v[80:83], v7 offset:21504
    ds_read_b128 v[84:87], v7 offset:22528
    ds_read_b128 v[88:91], v7 offset:23552
    ds_read_b128 v[92:95], v7 offset:24576
    s_waitcnt lgkmcnt(0)
    v_add_f32 v16, v16, v36
    v_add_f32 v56, v56, v76
    v_add_f32 v17, v17, v37
    v_add_f32 v57, v57, v77
    v_add_f32 v18, v18, v38
    v_add_f32 v58, v58, v78
    v_add_f32 v19, v19, v39
    v_add_f32 v59, v59, v79
    v_cvt_pk_bf16_f32 v12, v16, v17
    v_lshlrev_b32 v16, 16, v12
    v_and_b32 v17, 0xffff0000, v12
    v_cvt_pk_bf16_f32 v12, v18, v19
    v_lshlrev_b32 v18, 16, v12
    v_and_b32 v19, 0xffff0000, v12
    v_mul_f32 v16, v16, v197
    v_mul_f32 v17, v17, v199
    v_mul_f32 v18, v18, v201
    v_mul_f32 v19, v19, v203
    v_cvt_pk_bf16_f32 v12, v16, v17
    v_lshlrev_b32 v16, 16, v12
    v_and_b32 v17, 0xffff0000, v12
    v_cvt_pk_bf16_f32 v12, v18, v19
    v_lshlrev_b32 v18, 16, v12
    v_and_b32 v19, 0xffff0000, v12
    v_add_f32 v56, v56, v210
    v_mul_f32 v56, v196, v56
    v_add_f32 v56, v56, v16
    v_add_f32 v57, v57, v211
    v_mul_f32 v57, v198, v57
    v_add_f32 v57, v57, v17
    v_add_f32 v58, v58, v212
    v_mul_f32 v58, v200, v58
    v_add_f32 v58, v58, v18
    v_add_f32 v59, v59, v213
    v_mul_f32 v59, v202, v59
    v_add_f32 v59, v59, v19
    v_add_f32 v20, v20, v40
    v_add_f32 v60, v60, v80
    v_add_f32 v21, v21, v41
    v_add_f32 v61, v61, v81
    v_add_f32 v22, v22, v42
    v_add_f32 v62, v62, v82
    v_add_f32 v23, v23, v43
    v_add_f32 v63, v63, v83
    v_cvt_pk_bf16_f32 v12, v20, v21
    v_lshlrev_b32 v20, 16, v12
    v_and_b32 v21, 0xffff0000, v12
    v_cvt_pk_bf16_f32 v12, v22, v23
    v_lshlrev_b32 v22, 16, v12
    v_and_b32 v23, 0xffff0000, v12
    v_mul_f32 v20, v20, v197
    v_mul_f32 v21, v21, v199
    v_mul_f32 v22, v22, v201
    v_mul_f32 v23, v23, v203
    v_cvt_pk_bf16_f32 v12, v20, v21
    v_lshlrev_b32 v20, 16, v12
    v_and_b32 v21, 0xffff0000, v12
    v_cvt_pk_bf16_f32 v12, v22, v23
    v_lshlrev_b32 v22, 16, v12
    v_and_b32 v23, 0xffff0000, v12
    v_add_f32 v60, v60, v214
    v_mul_f32 v60, v196, v60
    v_add_f32 v60, v60, v20
    v_add_f32 v61, v61, v215
    v_mul_f32 v61, v198, v61
    v_add_f32 v61, v61, v21
    v_add_f32 v62, v62, v216
    v_mul_f32 v62, v200, v62
    v_add_f32 v62, v62, v22
    v_add_f32 v63, v63, v217
    v_mul_f32 v63, v202, v63
    v_add_f32 v63, v63, v23
    v_add_f32 v24, v24, v44
    v_add_f32 v64, v64, v84
    v_add_f32 v25, v25, v45
    v_add_f32 v65, v65, v85
    v_add_f32 v26, v26, v46
    v_add_f32 v66, v66, v86
    v_add_f32 v27, v27, v47
    v_add_f32 v67, v67, v87
    v_cvt_pk_bf16_f32 v12, v24, v25
    v_lshlrev_b32 v24, 16, v12
    v_and_b32 v25, 0xffff0000, v12
    v_cvt_pk_bf16_f32 v12, v26, v27
    v_lshlrev_b32 v26, 16, v12
    v_and_b32 v27, 0xffff0000, v12
    v_mul_f32 v24, v24, v197
    v_mul_f32 v25, v25, v199
    v_mul_f32 v26, v26, v201
    v_mul_f32 v27, v27, v203
    v_cvt_pk_bf16_f32 v12, v24, v25
    v_lshlrev_b32 v24, 16, v12
    v_and_b32 v25, 0xffff0000, v12
    v_cvt_pk_bf16_f32 v12, v26, v27
    v_lshlrev_b32 v26, 16, v12
    v_and_b32 v27, 0xffff0000, v12
    v_add_f32 v64, v64, v218
    v_mul_f32 v64, v196, v64
    v_add_f32 v64, v64, v24
    v_add_f32 v65, v65, v219
    v_mul_f32 v65, v198, v65
    v_add_f32 v65, v65, v25
    v_add_f32 v66, v66, v220
    v_mul_f32 v66, v200, v66
    v_add_f32 v66, v66, v26
    v_add_f32 v67, v67, v221
    v_mul_f32 v67, v202, v67
    v_add_f32 v67, v67, v27
    v_add_f32 v28, v28, v48
    v_add_f32 v68, v68, v88
    v_add_f32 v29, v29, v49
    v_add_f32 v69, v69, v89
    v_add_f32 v30, v30, v50
    v_add_f32 v70, v70, v90
    v_add_f32 v31, v31, v51
    v_add_f32 v71, v71, v91
    v_cvt_pk_bf16_f32 v12, v28, v29
    v_lshlrev_b32 v28, 16, v12
    v_and_b32 v29, 0xffff0000, v12
    v_cvt_pk_bf16_f32 v12, v30, v31
    v_lshlrev_b32 v30, 16, v12
    v_and_b32 v31, 0xffff0000, v12
    v_mul_f32 v28, v28, v197
    v_mul_f32 v29, v29, v199
    v_mul_f32 v30, v30, v201
    v_mul_f32 v31, v31, v203
    v_cvt_pk_bf16_f32 v12, v28, v29
    v_lshlrev_b32 v28, 16, v12
    v_and_b32 v29, 0xffff0000, v12
    v_cvt_pk_bf16_f32 v12, v30, v31
    v_lshlrev_b32 v30, 16, v12
    v_and_b32 v31, 0xffff0000, v12
    v_add_f32 v68, v68, v222
    v_mul_f32 v68, v196, v68
    v_add_f32 v68, v68, v28
    v_add_f32 v69, v69, v223
    v_mul_f32 v69, v198, v69
    v_add_f32 v69, v69, v29
    v_add_f32 v70, v70, v224
    v_mul_f32 v70, v200, v70
    v_add_f32 v70, v70, v30
    v_add_f32 v71, v71, v225
    v_mul_f32 v71, v202, v71
    v_add_f32 v71, v71, v31
    v_add_f32 v32, v32, v52
    v_add_f32 v72, v72, v92
    v_add_f32 v33, v33, v53
    v_add_f32 v73, v73, v93
    v_add_f32 v34, v34, v54
    v_add_f32 v74, v74, v94
    v_add_f32 v35, v35, v55
    v_add_f32 v75, v75, v95
    v_cvt_pk_bf16_f32 v12, v32, v33
    v_lshlrev_b32 v32, 16, v12
    v_and_b32 v33, 0xffff0000, v12
    v_cvt_pk_bf16_f32 v12, v34, v35
    v_lshlrev_b32 v34, 16, v12
    v_and_b32 v35, 0xffff0000, v12
    v_mul_f32 v32, v32, v197
    v_mul_f32 v33, v33, v199
    v_mul_f32 v34, v34, v201
    v_mul_f32 v35, v35, v203
    v_cvt_pk_bf16_f32 v12, v32, v33
    v_lshlrev_b32 v32, 16, v12
    v_and_b32 v33, 0xffff0000, v12
    v_cvt_pk_bf16_f32 v12, v34, v35
    v_lshlrev_b32 v34, 16, v12
    v_and_b32 v35, 0xffff0000, v12
    v_add_f32 v72, v72, v226
    v_mul_f32 v72, v196, v72
    v_add_f32 v72, v72, v32
    v_add_f32 v73, v73, v227
    v_mul_f32 v73, v198, v73
    v_add_f32 v73, v73, v33
    v_add_f32 v74, v74, v228
    v_mul_f32 v74, v200, v74
    v_add_f32 v74, v74, v34
    v_add_f32 v75, v75, v229
    v_mul_f32 v75, v202, v75
    v_add_f32 v75, v75, v35
    s_mov_b32 s30, 0
    buffer_store_dword v56, v11, s[12:15], s30 offen offset:0
    buffer_store_dword v60, v11, s[12:15], s30 offen offset:64
    buffer_store_dword v64, v11, s[12:15], s30 offen offset:128
    buffer_store_dword v68, v11, s[12:15], s30 offen offset:192
    buffer_store_dword v72, v11, s[12:15], s30 offen offset:256
    s_mov_b32 s30, 2560
    buffer_store_dword v57, v11, s[12:15], s30 offen offset:0
    buffer_store_dword v61, v11, s[12:15], s30 offen offset:64
    buffer_store_dword v65, v11, s[12:15], s30 offen offset:128
    buffer_store_dword v69, v11, s[12:15], s30 offen offset:192
    buffer_store_dword v73, v11, s[12:15], s30 offen offset:256
    s_mov_b32 s30, 5120
    buffer_store_dword v58, v11, s[12:15], s30 offen offset:0
    buffer_store_dword v62, v11, s[12:15], s30 offen offset:64
    buffer_store_dword v66, v11, s[12:15], s30 offen offset:128
    buffer_store_dword v70, v11, s[12:15], s30 offen offset:192
    buffer_store_dword v74, v11, s[12:15], s30 offen offset:256
    s_mov_b32 s30, 7680
    buffer_store_dword v59, v11, s[12:15], s30 offen offset:0
    buffer_store_dword v63, v11, s[12:15], s30 offen offset:64
    buffer_store_dword v67, v11, s[12:15], s30 offen offset:128
    buffer_store_dword v71, v11, s[12:15], s30 offen offset:192
    buffer_store_dword v75, v11, s[12:15], s30 offen offset:256
K3_END:
    s_endpgm
.section .rodata,"a"
.p2align 6
.amdhsa_kernel k1_kernel
  .amdhsa_next_free_vgpr 256
  .amdhsa_next_free_sgpr 102
  .amdhsa_accum_offset 256
  .amdhsa_group_segment_fixed_size 0
  .amdhsa_kernarg_size 136
  .amdhsa_user_sgpr_count 2
  .amdhsa_user_sgpr_kernarg_segment_ptr 1
  .amdhsa_system_sgpr_workgroup_id_x 1
  .amdhsa_float_denorm_mode_32 3
.end_amdhsa_kernel

.p2align 6
.amdhsa_kernel k3_kernel
  .amdhsa_next_free_vgpr 336
  .amdhsa_next_free_sgpr 102
  .amdhsa_accum_offset 256
  .amdhsa_group_segment_fixed_size 0
  .amdhsa_kernarg_size 136
  .amdhsa_user_sgpr_count 2
  .amdhsa_user_sgpr_kernarg_segment_ptr 1
  .amdhsa_system_sgpr_workgroup_id_x 1
  .amdhsa_float_denorm_mode_32 3
.end_amdhsa_kernel
```
